```python
import torch

def _softmax(x, axis=-1):
    return torch.softmax(x, dim=axis)
def _gelu(x):
    return torch.nn.functional.gelu(x, approximate="tanh")
def _silu(x):
    return torch.nn.functional.silu(x)
def _sigmoid(x):
    return torch.sigmoid(x)
def _layernorm(x, axis=-1, eps=1e-5):
    m = x.mean(dim=axis, keepdim=True)
    v = x.var(dim=axis, keepdim=True, unbiased=False)
    return (x - m) / torch.sqrt(v + eps)
def _scatter_add(tgt, idx, src, axis=0):
    return tgt.clone().index_add_(axis, idx, src)
def _segment_sum(src, seg, n):
    out = torch.zeros((n,) + src.shape[1:], dtype=src.dtype)
    return out.index_add_(0, seg, src)
def _pad(x, pw):
    flat = tuple(v for pair in reversed(pw) for v in pair)
    return torch.nn.functional.pad(x, flat)

kernel_name = 'standalone__gqa_block_cached__near_ridge'

def setup_inputs():

    _w = (lambda a: (lambda t: t.to(torch.bfloat16) if t.is_floating_point() else t)(torch.as_tensor(a)))
    B, Sq, D = 16, 64, 640
    Hq, Hkv, Sk, Dh = 32, 32, 512, 192
    assert Hq % Hkv == 0, (Hq, Hkv)
    return {
        "x": _w((lambda *s: torch.randn(*s, dtype=torch.bfloat16) * 0.8)(B, Sq, D)),
        "k_cache": _w((lambda *s: torch.randn(*s, dtype=torch.bfloat16) * 0.8)(B, Hkv, Sk, Dh)),
        "v_cache": _w((lambda *s: torch.randn(*s, dtype=torch.bfloat16) * 0.05)(B, Hkv, Sk, Dh)),
        "wq": _w((lambda *s: torch.randn(*s, dtype=torch.bfloat16) * 0.8)(D, Hq * Dh) * (D ** -0.5)),
        "wo": _w((lambda *s: torch.randn(*s, dtype=torch.bfloat16) * 0.05)(Hq * Dh, D) * ((Hq * Dh) ** -0.5)),
    }

def reference(x, k_cache, v_cache, wq, wo):
    B, Sq, D = x.shape
    Hq, Dh = 32, 192
    Hkv = k_cache.shape[1]
    rep = Hq // Hkv
    q = (lambda x, *d: x.permute(*d))((x @ wq).reshape(B, Sq, Hq, Dh), 0, 2, 1, 3)
    k = (lambda x, n, axis: torch.repeat_interleave(x, n, dim=axis))(k_cache, rep, axis=1)
    v = (lambda x, n, axis: torch.repeat_interleave(x, n, dim=axis))(v_cache, rep, axis=1)
    scores = torch.einsum("bhqd,bhkd->bhqk", q, k) * (Dh ** -0.5)
    p = _softmax(scores, axis=-1)
    o = torch.einsum("bhqk,bhkd->bhqd", p, v)
    return (lambda x, *d: x.permute(*d))(o, 0, 2, 1, 3).reshape(B, Sq, Hq * Dh) @ wo
```

```asm
; @launch kernel=standalone__gqa_block_cached__near_ridge_kernel grid=(256,1,1) block=(512,1,1) lds=163840
; @launch kernel=gqa_reduce_kernel grid=(320,1,1) block=(256,1,1) lds=0
.amdgcn_target "amdgcn-amd-amdhsa--gfx950"
.text
.globl standalone__gqa_block_cached__near_ridge_kernel
.p2align 8
.type standalone__gqa_block_cached__near_ridge_kernel,@function
standalone__gqa_block_cached__near_ridge_kernel:
    s_cmp_ge_u32 s2, 256
    s_cbranch_scc1 L_exit
    s_load_dwordx16 s[16:31], s[0:1], 0
    v_lshrrev_b32 v1, 6, v0
    s_nop 0
    v_readfirstlane_b32 s3, v1
    v_and_b32 v0, 63, v0
    s_and_b32 s66, s2, 7
    s_lshr_b32 s67, s2, 3
    s_lshr_b32 s68, s67, 4
    s_lshl_b32 s6, s66, 1
    s_add_u32 s6, s6, s68
    s_and_b32 s5, s67, 15
    s_and_b32 s4, s3, 3
    s_mul_i32 s7, s5, 5
    s_lshr_b32 s7, s7, 3
    s_lshl_b32 s7, s7, 1
    s_mul_i32 s68, s68, 10
    s_add_u32 s7, s7, s68
    s_sub_u32 s68, s7, 20
    s_cmp_ge_u32 s7, 20
    s_cselect_b32 s7, s68, s7
    s_and_b32 s13, s5, 3
    s_lshr_b32 s68, s5, 2
    s_cmp_eq_u32 s68, 3
    s_cselect_b32 s68, 0, s68
    s_add_u32 s69, s68, 0
    s_sub_u32 s14, s69, 3
    s_cmp_ge_u32 s69, 3
    s_cselect_b32 s14, s14, s69
    s_lshl_b32 s14, s14, 7
    s_add_u32 s69, s68, 1
    s_sub_u32 s15, s69, 3
    s_cmp_ge_u32 s69, 3
    s_cselect_b32 s15, s15, s69
    s_lshl_b32 s15, s15, 7
    s_add_u32 s69, s68, 2
    s_sub_u32 s98, s69, 3
    s_cmp_ge_u32 s69, 3
    s_cselect_b32 s98, s98, s69
    s_lshl_b32 s98, s98, 7
    s_mul_i32 s60, s4, 3072
    s_lshl_b32 s61, s4, 10
    s_lshl_b32 s62, s4, 11
    s_mul_i32 s63, s4, 5120
    s_mul_i32 s71, s4, 6144
    s_lshl_b32 s73, s4, 6
    s_mul_i32 s64, s6, 768
    s_lshr_b32 s72, s4, 1
    s_mul_i32 s72, s72, 12
    s_mov_b32 s65, 0x3dd53b95
    s_lshl_b32 s66, s5, 4
    s_add_u32 s66, s66, s6
    s_mul_i32 s56, s66, 393216
    s_mul_i32 s57, s66, 81920
    s_mul_i32 s58, s5, 81920
    s_mul_i32 s59, s6, 491520
    s_cmp_ge_u32 s3, 4
    s_cbranch_scc1 L_B
L_A:
    s_waitcnt lgkmcnt(0)
    s_mov_b32 s40, s22
    s_and_b32 s41, s23, 0xffff
    s_mov_b32 s42, 7864320
    s_mov_b32 s43, 0x20000
    s_add_u32 s44, s16, s58
    s_addc_u32 s45, s17, 0
    s_and_b32 s45, s45, 0xffff
    s_mov_b32 s46, 81920
    s_mov_b32 s47, 0x20000
    s_add_u32 s32, s18, s56
    s_addc_u32 s33, s19, 0
    s_and_b32 s33, s33, 0xffff
    s_mov_b32 s34, 393216
    s_mov_b32 s35, 0x20000
    s_add_u32 s36, s20, s56
    s_addc_u32 s37, s21, 0
    s_and_b32 s37, s37, 0xffff
    s_mov_b32 s38, 393216
    s_mov_b32 s39, 0x20000
    s_add_u32 s48, s24, s59
    s_addc_u32 s49, s25, 0
    s_and_b32 s49, s49, 0xffff
    s_mov_b32 s50, 491520
    s_mov_b32 s51, 0x20000
    s_add_u32 s52, s30, s57
    s_addc_u32 s53, s31, 0
    s_and_b32 s53, s53, 0xffff
    s_mov_b32 s54, 81920
    s_mov_b32 s55, 0x20000
    s_mul_i32 s66, s4, 98304
    s_mov_b32 s67, 12288
    v_add_u32 v12, 0, v0
    v_mul_u32_u24 v13, 171, v12
    v_lshrrev_b32 v13, 12, v13
    v_mul_u32_u24 v14, 24, v13
    v_sub_u32 v12, v12, v14
    v_and_b32 v14, 2, v13
    v_lshlrev_b32 v14, 1, v14
    v_xor_b32 v12, v12, v14
    v_lshlrev_b32 v12, 4, v12
    v_mul_lo_u32 v13, v13, s67
    v_add_u32 v12, v12, v13
    v_add_u32 v12, s66, v12
    v_mov_b32 v4, v12
    v_add_u32 v12, 64, v0
    v_mul_u32_u24 v13, 171, v12
    v_lshrrev_b32 v13, 12, v13
    v_mul_u32_u24 v14, 24, v13
    v_sub_u32 v12, v12, v14
    v_and_b32 v14, 2, v13
    v_lshlrev_b32 v14, 1, v14
    v_xor_b32 v12, v12, v14
    v_lshlrev_b32 v12, 4, v12
    v_mul_lo_u32 v13, v13, s67
    v_add_u32 v12, v12, v13
    v_add_u32 v12, s66, v12
    v_subrev_u32 v5, 1024, v12
    v_add_u32 v12, 128, v0
    v_mul_u32_u24 v13, 171, v12
    v_lshrrev_b32 v13, 12, v13
    v_mul_u32_u24 v14, 24, v13
    v_sub_u32 v12, v12, v14
    v_and_b32 v14, 2, v13
    v_lshlrev_b32 v14, 1, v14
    v_xor_b32 v12, v12, v14
    v_lshlrev_b32 v12, 4, v12
    v_mul_lo_u32 v13, v13, s67
    v_add_u32 v12, v12, v13
    v_add_u32 v12, s66, v12
    v_subrev_u32 v6, 2048, v12
    v_lshrrev_b32 v12, 5, v0
    v_lshlrev_b32 v12, 3, v12
    v_bfe_u32 v13, v0, 2, 2
    v_add_u32 v12, v12, v13
    v_mul_u32_u24 v12, 384, v12
    v_and_b32 v14, 1, v0
    v_lshlrev_b32 v14, 3, v14
    v_add_u32 v12, v12, v14
    v_and_b32 v13, 2, v13
    v_lshlrev_b32 v13, 1, v13
    v_bfe_u32 v14, v0, 4, 1
    v_lshlrev_b32 v14, 1, v14
    v_bfe_u32 v15, v0, 1, 1
    v_add_u32 v14, v14, v15
    v_add_u32 v14, s72, v14
    v_add_u32 v15, 0, v14
    v_xor_b32 v15, v15, v13
    v_lshlrev_b32 v15, 4, v15
    v_add_u32 v7, v12, v15
    v_add_u32 v15, 4, v14
    v_xor_b32 v15, v15, v13
    v_lshlrev_b32 v15, 4, v15
    v_add_u32 v8, v12, v15
    v_add_u32 v15, 8, v14
    v_xor_b32 v15, v15, v13
    v_lshlrev_b32 v15, 4, v15
    v_add_u32 v9, v12, v15
    s_and_b32 s66, s4, 1
    s_lshl_b32 s67, s66, 5
    v_and_b32 v12, 31, v0
    v_add_u32 v12, s67, v12
    v_bfe_u32 v13, v12, 1, 3
    v_lshrrev_b32 v14, 5, v0
    v_lshlrev_b32 v12, 7, v12
    v_add_u32 v12, 81920, v12
    v_add_u32 v15, 0, v14
    v_xor_b32 v15, v15, v13
    v_lshlrev_b32 v15, 4, v15
    v_add_u32 v10, v12, v15
    v_add_u32 v15, 2, v14
    v_xor_b32 v15, v15, v13
    v_lshlrev_b32 v15, 4, v15
    v_add_u32 v11, v12, v15
    v_add_u32 v15, 4, v14
    v_xor_b32 v15, v15, v13
    v_lshlrev_b32 v15, 4, v15
    v_add_u32 v90, v12, v15
    v_add_u32 v15, 6, v14
    v_xor_b32 v15, v15, v13
    v_lshlrev_b32 v15, 4, v15
    v_add_u32 v91, v12, v15
    s_barrier
    ds_read_b128 v[96:99], v10 offset:40960
    ds_read_b128 v[100:103], v11 offset:40960
    ds_read_b128 v[104:107], v90 offset:40960
    ds_read_b128 v[108:111], v91 offset:40960
    ds_read_b64_tr_b16 v[16:17], v7 offset:0
    ds_read_b64_tr_b16 v[18:19], v7 offset:1536
    ds_read_b64_tr_b16 v[20:21], v8 offset:0
    ds_read_b64_tr_b16 v[22:23], v8 offset:1536
    ds_read_b64_tr_b16 v[24:25], v9 offset:0
    ds_read_b64_tr_b16 v[26:27], v9 offset:1536
    ds_read_b64_tr_b16 v[28:29], v7 offset:6144
    ds_read_b64_tr_b16 v[30:31], v7 offset:7680
    ds_read_b64_tr_b16 v[80:81], v8 offset:6144
    ds_read_b64_tr_b16 v[82:83], v8 offset:7680
    ds_read_b64_tr_b16 v[84:85], v9 offset:6144
    s_waitcnt lgkmcnt(14)
    ds_read_b64_tr_b16 v[86:87], v9 offset:7680
    s_waitcnt lgkmcnt(10)
    v_mfma_f32_32x32x16_bf16 v[32:47], v[16:19], v[96:99], 0
    ds_read_b64_tr_b16 v[16:17], v7 offset:12288
    ds_read_b64_tr_b16 v[18:19], v7 offset:13824
    s_waitcnt lgkmcnt(10)
    v_mfma_f32_32x32x16_bf16 v[48:63], v[20:23], v[96:99], 0
    ds_read_b64_tr_b16 v[20:21], v8 offset:12288
    ds_read_b64_tr_b16 v[22:23], v8 offset:13824
    s_waitcnt lgkmcnt(10)
    v_mfma_f32_32x32x16_bf16 v[64:79], v[24:27], v[96:99], 0
    ds_read_b64_tr_b16 v[24:25], v9 offset:12288
    ds_read_b64_tr_b16 v[26:27], v9 offset:13824
    s_waitcnt lgkmcnt(10)
    v_mfma_f32_32x32x16_bf16 v[32:47], v[28:31], v[100:103], v[32:47]
    ds_read_b64_tr_b16 v[28:29], v7 offset:18432
    ds_read_b64_tr_b16 v[30:31], v7 offset:19968
    s_waitcnt lgkmcnt(10)
    v_mfma_f32_32x32x16_bf16 v[48:63], v[80:83], v[100:103], v[48:63]
    ds_read_b64_tr_b16 v[80:81], v8 offset:18432
    ds_read_b64_tr_b16 v[82:83], v8 offset:19968
    s_waitcnt lgkmcnt(10)
    v_mfma_f32_32x32x16_bf16 v[64:79], v[84:87], v[100:103], v[64:79]
    ds_read_b64_tr_b16 v[84:85], v9 offset:18432
    ds_read_b64_tr_b16 v[86:87], v9 offset:19968
    s_waitcnt lgkmcnt(10)
    v_mfma_f32_32x32x16_bf16 v[32:47], v[16:19], v[104:107], v[32:47]
    s_waitcnt lgkmcnt(8)
    v_mfma_f32_32x32x16_bf16 v[48:63], v[20:23], v[104:107], v[48:63]
    s_waitcnt lgkmcnt(6)
    v_mfma_f32_32x32x16_bf16 v[64:79], v[24:27], v[104:107], v[64:79]
    s_waitcnt lgkmcnt(4)
    v_mfma_f32_32x32x16_bf16 v[32:47], v[28:31], v[108:111], v[32:47]
    s_waitcnt lgkmcnt(2)
    v_mfma_f32_32x32x16_bf16 v[48:63], v[80:83], v[108:111], v[48:63]
    s_waitcnt lgkmcnt(0)
    v_mfma_f32_32x32x16_bf16 v[64:79], v[84:87], v[108:111], v[64:79]
    s_barrier
    ds_read_b128 v[112:115], v10 offset:49152
    ds_read_b128 v[116:119], v11 offset:49152
    ds_read_b128 v[120:123], v90 offset:49152
    ds_read_b128 v[124:127], v91 offset:49152
    ds_read_b64_tr_b16 v[16:17], v7 offset:24576
    ds_read_b64_tr_b16 v[18:19], v7 offset:26112
    ds_read_b64_tr_b16 v[20:21], v8 offset:24576
    ds_read_b64_tr_b16 v[22:23], v8 offset:26112
    ds_read_b64_tr_b16 v[24:25], v9 offset:24576
    ds_read_b64_tr_b16 v[26:27], v9 offset:26112
    ds_read_b64_tr_b16 v[28:29], v7 offset:30720
    ds_read_b64_tr_b16 v[30:31], v7 offset:32256
    ds_read_b64_tr_b16 v[80:81], v8 offset:30720
    ds_read_b64_tr_b16 v[82:83], v8 offset:32256
    ds_read_b64_tr_b16 v[84:85], v9 offset:30720
    s_waitcnt lgkmcnt(14)
    ds_read_b64_tr_b16 v[86:87], v9 offset:32256
    s_waitcnt lgkmcnt(10)
    v_mfma_f32_32x32x16_bf16 v[32:47], v[16:19], v[112:115], v[32:47]
    ds_read_b64_tr_b16 v[16:17], v7 offset:36864
    ds_read_b64_tr_b16 v[18:19], v7 offset:38400
    s_waitcnt lgkmcnt(10)
    v_mfma_f32_32x32x16_bf16 v[48:63], v[20:23], v[112:115], v[48:63]
    ds_read_b64_tr_b16 v[20:21], v8 offset:36864
    ds_read_b64_tr_b16 v[22:23], v8 offset:38400
    s_waitcnt lgkmcnt(10)
    v_mfma_f32_32x32x16_bf16 v[64:79], v[24:27], v[112:115], v[64:79]
    ds_read_b64_tr_b16 v[24:25], v9 offset:36864
    ds_read_b64_tr_b16 v[26:27], v9 offset:38400
    s_waitcnt lgkmcnt(10)
    v_mfma_f32_32x32x16_bf16 v[32:47], v[28:31], v[116:119], v[32:47]
    ds_read_b64_tr_b16 v[28:29], v7 offset:43008
    ds_read_b64_tr_b16 v[30:31], v7 offset:44544
    s_waitcnt lgkmcnt(10)
    v_mfma_f32_32x32x16_bf16 v[48:63], v[80:83], v[116:119], v[48:63]
    ds_read_b64_tr_b16 v[80:81], v8 offset:43008
    ds_read_b64_tr_b16 v[82:83], v8 offset:44544
    s_waitcnt lgkmcnt(10)
    v_mfma_f32_32x32x16_bf16 v[64:79], v[84:87], v[116:119], v[64:79]
    ds_read_b64_tr_b16 v[84:85], v9 offset:43008
    ds_read_b64_tr_b16 v[86:87], v9 offset:44544
    s_waitcnt lgkmcnt(10)
    v_mfma_f32_32x32x16_bf16 v[32:47], v[16:19], v[120:123], v[32:47]
    s_waitcnt lgkmcnt(8)
    v_mfma_f32_32x32x16_bf16 v[48:63], v[20:23], v[120:123], v[48:63]
    s_waitcnt lgkmcnt(6)
    v_mfma_f32_32x32x16_bf16 v[64:79], v[24:27], v[120:123], v[64:79]
    s_waitcnt lgkmcnt(4)
    v_mfma_f32_32x32x16_bf16 v[32:47], v[28:31], v[124:127], v[32:47]
    s_waitcnt lgkmcnt(2)
    v_mfma_f32_32x32x16_bf16 v[48:63], v[80:83], v[124:127], v[48:63]
    s_waitcnt lgkmcnt(0)
    v_mfma_f32_32x32x16_bf16 v[64:79], v[84:87], v[124:127], v[64:79]
    s_barrier
    v_add_u32 v12, 32768, v7
    v_add_u32 v13, 32768, v8
    v_add_u32 v14, 32768, v9
    ds_read_b128 v[128:131], v10 offset:57344
    ds_read_b128 v[132:135], v11 offset:57344
    ds_read_b128 v[136:139], v90 offset:57344
    ds_read_b128 v[140:143], v91 offset:57344
    ds_read_b64_tr_b16 v[16:17], v7 offset:49152
    ds_read_b64_tr_b16 v[18:19], v7 offset:50688
    ds_read_b64_tr_b16 v[20:21], v8 offset:49152
    ds_read_b64_tr_b16 v[22:23], v8 offset:50688
    ds_read_b64_tr_b16 v[24:25], v9 offset:49152
    ds_read_b64_tr_b16 v[26:27], v9 offset:50688
    ds_read_b64_tr_b16 v[28:29], v7 offset:55296
    ds_read_b64_tr_b16 v[30:31], v7 offset:56832
    ds_read_b64_tr_b16 v[80:81], v8 offset:55296
    ds_read_b64_tr_b16 v[82:83], v8 offset:56832
    ds_read_b64_tr_b16 v[84:85], v9 offset:55296
    s_waitcnt lgkmcnt(14)
    ds_read_b64_tr_b16 v[86:87], v9 offset:56832
    s_waitcnt lgkmcnt(10)
    v_mfma_f32_32x32x16_bf16 v[32:47], v[16:19], v[128:131], v[32:47]
    ds_read_b64_tr_b16 v[16:17], v12 offset:28672
    ds_read_b64_tr_b16 v[18:19], v12 offset:30208
    s_waitcnt lgkmcnt(10)
    v_mfma_f32_32x32x16_bf16 v[48:63], v[20:23], v[128:131], v[48:63]
    ds_read_b64_tr_b16 v[20:21], v13 offset:28672
    ds_read_b64_tr_b16 v[22:23], v13 offset:30208
    s_waitcnt lgkmcnt(10)
    v_mfma_f32_32x32x16_bf16 v[64:79], v[24:27], v[128:131], v[64:79]
    ds_read_b64_tr_b16 v[24:25], v14 offset:28672
    ds_read_b64_tr_b16 v[26:27], v14 offset:30208
    s_waitcnt lgkmcnt(10)
    v_mfma_f32_32x32x16_bf16 v[32:47], v[28:31], v[132:135], v[32:47]
    ds_read_b64_tr_b16 v[28:29], v12 offset:34816
    ds_read_b64_tr_b16 v[30:31], v12 offset:36352
    s_waitcnt lgkmcnt(10)
    v_mfma_f32_32x32x16_bf16 v[48:63], v[80:83], v[132:135], v[48:63]
    ds_read_b64_tr_b16 v[80:81], v13 offset:34816
    ds_read_b64_tr_b16 v[82:83], v13 offset:36352
    s_waitcnt lgkmcnt(10)
    v_mfma_f32_32x32x16_bf16 v[64:79], v[84:87], v[132:135], v[64:79]
    ds_read_b64_tr_b16 v[84:85], v14 offset:34816
    ds_read_b64_tr_b16 v[86:87], v14 offset:36352
    s_waitcnt lgkmcnt(10)
    v_mfma_f32_32x32x16_bf16 v[32:47], v[16:19], v[136:139], v[32:47]
    s_waitcnt lgkmcnt(8)
    v_mfma_f32_32x32x16_bf16 v[48:63], v[20:23], v[136:139], v[48:63]
    s_waitcnt lgkmcnt(6)
    v_mfma_f32_32x32x16_bf16 v[64:79], v[24:27], v[136:139], v[64:79]
    s_waitcnt lgkmcnt(4)
    v_mfma_f32_32x32x16_bf16 v[32:47], v[28:31], v[140:143], v[32:47]
    s_waitcnt lgkmcnt(2)
    v_mfma_f32_32x32x16_bf16 v[48:63], v[80:83], v[140:143], v[48:63]
    s_waitcnt lgkmcnt(0)
    v_mfma_f32_32x32x16_bf16 v[64:79], v[84:87], v[140:143], v[64:79]
    s_barrier
    v_add_u32 v15, 65536, v10
    ds_read_b128 v[144:147], v15 offset:0
    v_add_u32 v15, 65536, v11
    ds_read_b128 v[148:151], v15 offset:0
    v_add_u32 v15, 65536, v90
    ds_read_b128 v[152:155], v15 offset:0
    v_add_u32 v15, 65536, v91
    ds_read_b128 v[156:159], v15 offset:0
    ds_read_b64_tr_b16 v[16:17], v7 offset:0
    ds_read_b64_tr_b16 v[18:19], v7 offset:1536
    ds_read_b64_tr_b16 v[20:21], v8 offset:0
    ds_read_b64_tr_b16 v[22:23], v8 offset:1536
    ds_read_b64_tr_b16 v[24:25], v9 offset:0
    ds_read_b64_tr_b16 v[26:27], v9 offset:1536
    ds_read_b64_tr_b16 v[28:29], v7 offset:6144
    ds_read_b64_tr_b16 v[30:31], v7 offset:7680
    ds_read_b64_tr_b16 v[80:81], v8 offset:6144
    ds_read_b64_tr_b16 v[82:83], v8 offset:7680
    ds_read_b64_tr_b16 v[84:85], v9 offset:6144
    s_waitcnt lgkmcnt(14)
    ds_read_b64_tr_b16 v[86:87], v9 offset:7680
    s_waitcnt lgkmcnt(10)
    v_mfma_f32_32x32x16_bf16 v[32:47], v[16:19], v[144:147], v[32:47]
    ds_read_b64_tr_b16 v[16:17], v7 offset:12288
    ds_read_b64_tr_b16 v[18:19], v7 offset:13824
    s_waitcnt lgkmcnt(10)
    v_mfma_f32_32x32x16_bf16 v[48:63], v[20:23], v[144:147], v[48:63]
    ds_read_b64_tr_b16 v[20:21], v8 offset:12288
    ds_read_b64_tr_b16 v[22:23], v8 offset:13824
    s_waitcnt lgkmcnt(10)
    v_mfma_f32_32x32x16_bf16 v[64:79], v[24:27], v[144:147], v[64:79]
    ds_read_b64_tr_b16 v[24:25], v9 offset:12288
    ds_read_b64_tr_b16 v[26:27], v9 offset:13824
    s_waitcnt lgkmcnt(10)
    v_mfma_f32_32x32x16_bf16 v[32:47], v[28:31], v[148:151], v[32:47]
    ds_read_b64_tr_b16 v[28:29], v7 offset:18432
    ds_read_b64_tr_b16 v[30:31], v7 offset:19968
    s_waitcnt lgkmcnt(10)
    v_mfma_f32_32x32x16_bf16 v[48:63], v[80:83], v[148:151], v[48:63]
    ds_read_b64_tr_b16 v[80:81], v8 offset:18432
    ds_read_b64_tr_b16 v[82:83], v8 offset:19968
    s_waitcnt lgkmcnt(10)
    v_mfma_f32_32x32x16_bf16 v[64:79], v[84:87], v[148:151], v[64:79]
    ds_read_b64_tr_b16 v[84:85], v9 offset:18432
    ds_read_b64_tr_b16 v[86:87], v9 offset:19968
    s_waitcnt lgkmcnt(10)
    v_mfma_f32_32x32x16_bf16 v[32:47], v[16:19], v[152:155], v[32:47]
    s_waitcnt lgkmcnt(8)
    v_mfma_f32_32x32x16_bf16 v[48:63], v[20:23], v[152:155], v[48:63]
    s_waitcnt lgkmcnt(6)
    v_mfma_f32_32x32x16_bf16 v[64:79], v[24:27], v[152:155], v[64:79]
    s_waitcnt lgkmcnt(4)
    v_mfma_f32_32x32x16_bf16 v[32:47], v[28:31], v[156:159], v[32:47]
    s_waitcnt lgkmcnt(2)
    v_mfma_f32_32x32x16_bf16 v[48:63], v[80:83], v[156:159], v[48:63]
    s_waitcnt lgkmcnt(0)
    v_mfma_f32_32x32x16_bf16 v[64:79], v[84:87], v[156:159], v[64:79]
    s_barrier
    v_add_u32 v15, 65536, v10
    ds_read_b128 v[160:163], v15 offset:8192
    v_add_u32 v15, 65536, v11
    ds_read_b128 v[164:167], v15 offset:8192
    v_add_u32 v15, 65536, v90
    ds_read_b128 v[168:171], v15 offset:8192
    v_add_u32 v15, 65536, v91
    ds_read_b128 v[172:175], v15 offset:8192
    ds_read_b64_tr_b16 v[16:17], v7 offset:24576
    ds_read_b64_tr_b16 v[18:19], v7 offset:26112
    ds_read_b64_tr_b16 v[20:21], v8 offset:24576
    ds_read_b64_tr_b16 v[22:23], v8 offset:26112
    ds_read_b64_tr_b16 v[24:25], v9 offset:24576
    ds_read_b64_tr_b16 v[26:27], v9 offset:26112
    ds_read_b64_tr_b16 v[28:29], v7 offset:30720
    ds_read_b64_tr_b16 v[30:31], v7 offset:32256
    ds_read_b64_tr_b16 v[80:81], v8 offset:30720
    ds_read_b64_tr_b16 v[82:83], v8 offset:32256
    ds_read_b64_tr_b16 v[84:85], v9 offset:30720
    s_waitcnt lgkmcnt(14)
    ds_read_b64_tr_b16 v[86:87], v9 offset:32256
    s_waitcnt lgkmcnt(10)
    v_mfma_f32_32x32x16_bf16 v[32:47], v[16:19], v[160:163], v[32:47]
    ds_read_b64_tr_b16 v[16:17], v7 offset:36864
    ds_read_b64_tr_b16 v[18:19], v7 offset:38400
    s_waitcnt lgkmcnt(10)
    v_mfma_f32_32x32x16_bf16 v[48:63], v[20:23], v[160:163], v[48:63]
    ds_read_b64_tr_b16 v[20:21], v8 offset:36864
    ds_read_b64_tr_b16 v[22:23], v8 offset:38400
    s_waitcnt lgkmcnt(10)
    v_mfma_f32_32x32x16_bf16 v[64:79], v[24:27], v[160:163], v[64:79]
    ds_read_b64_tr_b16 v[24:25], v9 offset:36864
    ds_read_b64_tr_b16 v[26:27], v9 offset:38400
    s_waitcnt lgkmcnt(10)
    v_mfma_f32_32x32x16_bf16 v[32:47], v[28:31], v[164:167], v[32:47]
    ds_read_b64_tr_b16 v[28:29], v7 offset:43008
    ds_read_b64_tr_b16 v[30:31], v7 offset:44544
    s_waitcnt lgkmcnt(10)
    v_mfma_f32_32x32x16_bf16 v[48:63], v[80:83], v[164:167], v[48:63]
    ds_read_b64_tr_b16 v[80:81], v8 offset:43008
    ds_read_b64_tr_b16 v[82:83], v8 offset:44544
    s_waitcnt lgkmcnt(10)
    v_mfma_f32_32x32x16_bf16 v[64:79], v[84:87], v[164:167], v[64:79]
    ds_read_b64_tr_b16 v[84:85], v9 offset:43008
    ds_read_b64_tr_b16 v[86:87], v9 offset:44544
    s_waitcnt lgkmcnt(10)
    v_mfma_f32_32x32x16_bf16 v[32:47], v[16:19], v[168:171], v[32:47]
    s_waitcnt lgkmcnt(8)
    v_mfma_f32_32x32x16_bf16 v[48:63], v[20:23], v[168:171], v[48:63]
    s_waitcnt lgkmcnt(6)
    v_mfma_f32_32x32x16_bf16 v[64:79], v[24:27], v[168:171], v[64:79]
    s_waitcnt lgkmcnt(4)
    v_mfma_f32_32x32x16_bf16 v[32:47], v[28:31], v[172:175], v[32:47]
    s_waitcnt lgkmcnt(2)
    v_mfma_f32_32x32x16_bf16 v[48:63], v[80:83], v[172:175], v[48:63]
    s_waitcnt lgkmcnt(0)
    v_mfma_f32_32x32x16_bf16 v[64:79], v[84:87], v[172:175], v[64:79]
    s_barrier
    ds_read_b128 v[176:179], v10 offset:40960
    ds_read_b128 v[180:183], v11 offset:40960
    ds_read_b128 v[184:187], v90 offset:40960
    ds_read_b128 v[188:191], v91 offset:40960
    ds_read_b64_tr_b16 v[16:17], v7 offset:49152
    ds_read_b64_tr_b16 v[18:19], v7 offset:50688
    ds_read_b64_tr_b16 v[20:21], v8 offset:49152
    ds_read_b64_tr_b16 v[22:23], v8 offset:50688
    ds_read_b64_tr_b16 v[24:25], v9 offset:49152
    ds_read_b64_tr_b16 v[26:27], v9 offset:50688
    ds_read_b64_tr_b16 v[28:29], v7 offset:55296
    ds_read_b64_tr_b16 v[30:31], v7 offset:56832
    ds_read_b64_tr_b16 v[80:81], v8 offset:55296
    ds_read_b64_tr_b16 v[82:83], v8 offset:56832
    ds_read_b64_tr_b16 v[84:85], v9 offset:55296
    s_waitcnt lgkmcnt(14)
    ds_read_b64_tr_b16 v[86:87], v9 offset:56832
    s_waitcnt lgkmcnt(10)
    v_mfma_f32_32x32x16_bf16 v[32:47], v[16:19], v[176:179], v[32:47]
    ds_read_b64_tr_b16 v[16:17], v12 offset:28672
    ds_read_b64_tr_b16 v[18:19], v12 offset:30208
    s_waitcnt lgkmcnt(10)
    v_mfma_f32_32x32x16_bf16 v[48:63], v[20:23], v[176:179], v[48:63]
    ds_read_b64_tr_b16 v[20:21], v13 offset:28672
    ds_read_b64_tr_b16 v[22:23], v13 offset:30208
    s_waitcnt lgkmcnt(10)
    v_mfma_f32_32x32x16_bf16 v[64:79], v[24:27], v[176:179], v[64:79]
    ds_read_b64_tr_b16 v[24:25], v14 offset:28672
    ds_read_b64_tr_b16 v[26:27], v14 offset:30208
    s_waitcnt lgkmcnt(10)
    v_mfma_f32_32x32x16_bf16 v[32:47], v[28:31], v[180:183], v[32:47]
    ds_read_b64_tr_b16 v[28:29], v12 offset:34816
    ds_read_b64_tr_b16 v[30:31], v12 offset:36352
    s_waitcnt lgkmcnt(10)
    v_mfma_f32_32x32x16_bf16 v[48:63], v[80:83], v[180:183], v[48:63]
    ds_read_b64_tr_b16 v[80:81], v13 offset:34816
    ds_read_b64_tr_b16 v[82:83], v13 offset:36352
    s_waitcnt lgkmcnt(10)
    v_mfma_f32_32x32x16_bf16 v[64:79], v[84:87], v[180:183], v[64:79]
    ds_read_b64_tr_b16 v[84:85], v14 offset:34816
    ds_read_b64_tr_b16 v[86:87], v14 offset:36352
    s_waitcnt lgkmcnt(10)
    v_mfma_f32_32x32x16_bf16 v[32:47], v[16:19], v[184:187], v[32:47]
    s_waitcnt lgkmcnt(8)
    v_mfma_f32_32x32x16_bf16 v[48:63], v[20:23], v[184:187], v[48:63]
    s_waitcnt lgkmcnt(6)
    v_mfma_f32_32x32x16_bf16 v[64:79], v[24:27], v[184:187], v[64:79]
    s_waitcnt lgkmcnt(4)
    v_mfma_f32_32x32x16_bf16 v[32:47], v[28:31], v[188:191], v[32:47]
    s_waitcnt lgkmcnt(2)
    v_mfma_f32_32x32x16_bf16 v[48:63], v[80:83], v[188:191], v[48:63]
    s_waitcnt lgkmcnt(0)
    v_mfma_f32_32x32x16_bf16 v[64:79], v[84:87], v[188:191], v[64:79]
    s_barrier
    ds_read_b128 v[192:195], v10 offset:49152
    ds_read_b128 v[196:199], v11 offset:49152
    ds_read_b128 v[200:203], v90 offset:49152
    ds_read_b128 v[204:207], v91 offset:49152
    ds_read_b64_tr_b16 v[16:17], v7 offset:0
    ds_read_b64_tr_b16 v[18:19], v7 offset:1536
    ds_read_b64_tr_b16 v[20:21], v8 offset:0
    ds_read_b64_tr_b16 v[22:23], v8 offset:1536
    ds_read_b64_tr_b16 v[24:25], v9 offset:0
    ds_read_b64_tr_b16 v[26:27], v9 offset:1536
    ds_read_b64_tr_b16 v[28:29], v7 offset:6144
    ds_read_b64_tr_b16 v[30:31], v7 offset:7680
    ds_read_b64_tr_b16 v[80:81], v8 offset:6144
    ds_read_b64_tr_b16 v[82:83], v8 offset:7680
    ds_read_b64_tr_b16 v[84:85], v9 offset:6144
    s_waitcnt lgkmcnt(14)
    ds_read_b64_tr_b16 v[86:87], v9 offset:7680
    s_waitcnt lgkmcnt(10)
    v_mfma_f32_32x32x16_bf16 v[32:47], v[16:19], v[192:195], v[32:47]
    ds_read_b64_tr_b16 v[16:17], v7 offset:12288
    ds_read_b64_tr_b16 v[18:19], v7 offset:13824
    s_waitcnt lgkmcnt(10)
    v_mfma_f32_32x32x16_bf16 v[48:63], v[20:23], v[192:195], v[48:63]
    ds_read_b64_tr_b16 v[20:21], v8 offset:12288
    ds_read_b64_tr_b16 v[22:23], v8 offset:13824
    s_waitcnt lgkmcnt(10)
    v_mfma_f32_32x32x16_bf16 v[64:79], v[24:27], v[192:195], v[64:79]
    ds_read_b64_tr_b16 v[24:25], v9 offset:12288
    ds_read_b64_tr_b16 v[26:27], v9 offset:13824
    s_waitcnt lgkmcnt(10)
    v_mfma_f32_32x32x16_bf16 v[32:47], v[28:31], v[196:199], v[32:47]
    ds_read_b64_tr_b16 v[28:29], v7 offset:18432
    ds_read_b64_tr_b16 v[30:31], v7 offset:19968
    s_waitcnt lgkmcnt(10)
    v_mfma_f32_32x32x16_bf16 v[48:63], v[80:83], v[196:199], v[48:63]
    ds_read_b64_tr_b16 v[80:81], v8 offset:18432
    ds_read_b64_tr_b16 v[82:83], v8 offset:19968
    s_waitcnt lgkmcnt(10)
    v_mfma_f32_32x32x16_bf16 v[64:79], v[84:87], v[196:199], v[64:79]
    ds_read_b64_tr_b16 v[84:85], v9 offset:18432
    ds_read_b64_tr_b16 v[86:87], v9 offset:19968
    s_waitcnt lgkmcnt(10)
    v_mfma_f32_32x32x16_bf16 v[32:47], v[16:19], v[200:203], v[32:47]
    s_waitcnt lgkmcnt(8)
    v_mfma_f32_32x32x16_bf16 v[48:63], v[20:23], v[200:203], v[48:63]
    s_waitcnt lgkmcnt(6)
    v_mfma_f32_32x32x16_bf16 v[64:79], v[24:27], v[200:203], v[64:79]
    s_waitcnt lgkmcnt(4)
    v_mfma_f32_32x32x16_bf16 v[32:47], v[28:31], v[204:207], v[32:47]
    s_waitcnt lgkmcnt(2)
    v_mfma_f32_32x32x16_bf16 v[48:63], v[80:83], v[204:207], v[48:63]
    s_waitcnt lgkmcnt(0)
    v_mfma_f32_32x32x16_bf16 v[64:79], v[84:87], v[204:207], v[64:79]
    s_barrier
    ds_read_b128 v[208:211], v10 offset:57344
    ds_read_b128 v[212:215], v11 offset:57344
    ds_read_b128 v[216:219], v90 offset:57344
    ds_read_b128 v[220:223], v91 offset:57344
    ds_read_b64_tr_b16 v[16:17], v7 offset:24576
    ds_read_b64_tr_b16 v[18:19], v7 offset:26112
    ds_read_b64_tr_b16 v[20:21], v8 offset:24576
    ds_read_b64_tr_b16 v[22:23], v8 offset:26112
    ds_read_b64_tr_b16 v[24:25], v9 offset:24576
    ds_read_b64_tr_b16 v[26:27], v9 offset:26112
    ds_read_b64_tr_b16 v[28:29], v7 offset:30720
    ds_read_b64_tr_b16 v[30:31], v7 offset:32256
    ds_read_b64_tr_b16 v[80:81], v8 offset:30720
    ds_read_b64_tr_b16 v[82:83], v8 offset:32256
    ds_read_b64_tr_b16 v[84:85], v9 offset:30720
    s_waitcnt lgkmcnt(14)
    ds_read_b64_tr_b16 v[86:87], v9 offset:32256
    s_waitcnt lgkmcnt(10)
    v_mfma_f32_32x32x16_bf16 v[32:47], v[16:19], v[208:211], v[32:47]
    ds_read_b64_tr_b16 v[16:17], v7 offset:36864
    ds_read_b64_tr_b16 v[18:19], v7 offset:38400
    s_waitcnt lgkmcnt(10)
    v_mfma_f32_32x32x16_bf16 v[48:63], v[20:23], v[208:211], v[48:63]
    ds_read_b64_tr_b16 v[20:21], v8 offset:36864
    ds_read_b64_tr_b16 v[22:23], v8 offset:38400
    s_waitcnt lgkmcnt(10)
    v_mfma_f32_32x32x16_bf16 v[64:79], v[24:27], v[208:211], v[64:79]
    ds_read_b64_tr_b16 v[24:25], v9 offset:36864
    ds_read_b64_tr_b16 v[26:27], v9 offset:38400
    s_waitcnt lgkmcnt(10)
    v_mfma_f32_32x32x16_bf16 v[32:47], v[28:31], v[212:215], v[32:47]
    ds_read_b64_tr_b16 v[28:29], v7 offset:43008
    ds_read_b64_tr_b16 v[30:31], v7 offset:44544
    s_waitcnt lgkmcnt(10)
    v_mfma_f32_32x32x16_bf16 v[48:63], v[80:83], v[212:215], v[48:63]
    ds_read_b64_tr_b16 v[80:81], v8 offset:43008
    ds_read_b64_tr_b16 v[82:83], v8 offset:44544
    s_waitcnt lgkmcnt(10)
    v_mfma_f32_32x32x16_bf16 v[64:79], v[84:87], v[212:215], v[64:79]
    ds_read_b64_tr_b16 v[84:85], v9 offset:43008
    ds_read_b64_tr_b16 v[86:87], v9 offset:44544
    s_waitcnt lgkmcnt(10)
    v_mfma_f32_32x32x16_bf16 v[32:47], v[16:19], v[216:219], v[32:47]
    s_waitcnt lgkmcnt(8)
    v_mfma_f32_32x32x16_bf16 v[48:63], v[20:23], v[216:219], v[48:63]
    s_waitcnt lgkmcnt(6)
    v_mfma_f32_32x32x16_bf16 v[64:79], v[24:27], v[216:219], v[64:79]
    s_waitcnt lgkmcnt(4)
    v_mfma_f32_32x32x16_bf16 v[32:47], v[28:31], v[220:223], v[32:47]
    s_waitcnt lgkmcnt(2)
    v_mfma_f32_32x32x16_bf16 v[48:63], v[80:83], v[220:223], v[48:63]
    s_waitcnt lgkmcnt(0)
    v_mfma_f32_32x32x16_bf16 v[64:79], v[84:87], v[220:223], v[64:79]
    s_barrier
    v_add_u32 v15, 65536, v10
    ds_read_b128 v[224:227], v15 offset:0
    v_add_u32 v15, 65536, v11
    ds_read_b128 v[228:231], v15 offset:0
    v_add_u32 v15, 65536, v90
    ds_read_b128 v[232:235], v15 offset:0
    v_add_u32 v15, 65536, v91
    ds_read_b128 v[236:239], v15 offset:0
    ds_read_b64_tr_b16 v[16:17], v7 offset:49152
    ds_read_b64_tr_b16 v[18:19], v7 offset:50688
    ds_read_b64_tr_b16 v[20:21], v8 offset:49152
    ds_read_b64_tr_b16 v[22:23], v8 offset:50688
    ds_read_b64_tr_b16 v[24:25], v9 offset:49152
    ds_read_b64_tr_b16 v[26:27], v9 offset:50688
    ds_read_b64_tr_b16 v[28:29], v7 offset:55296
    ds_read_b64_tr_b16 v[30:31], v7 offset:56832
    ds_read_b64_tr_b16 v[80:81], v8 offset:55296
    ds_read_b64_tr_b16 v[82:83], v8 offset:56832
    ds_read_b64_tr_b16 v[84:85], v9 offset:55296
    s_waitcnt lgkmcnt(14)
    ds_read_b64_tr_b16 v[86:87], v9 offset:56832
    s_waitcnt lgkmcnt(10)
    v_mfma_f32_32x32x16_bf16 v[32:47], v[16:19], v[224:227], v[32:47]
    ds_read_b64_tr_b16 v[16:17], v12 offset:28672
    ds_read_b64_tr_b16 v[18:19], v12 offset:30208
    s_waitcnt lgkmcnt(10)
    v_mfma_f32_32x32x16_bf16 v[48:63], v[20:23], v[224:227], v[48:63]
    ds_read_b64_tr_b16 v[20:21], v13 offset:28672
    ds_read_b64_tr_b16 v[22:23], v13 offset:30208
    s_waitcnt lgkmcnt(10)
    v_mfma_f32_32x32x16_bf16 v[64:79], v[24:27], v[224:227], v[64:79]
    ds_read_b64_tr_b16 v[24:25], v14 offset:28672
    ds_read_b64_tr_b16 v[26:27], v14 offset:30208
    s_waitcnt lgkmcnt(10)
    v_mfma_f32_32x32x16_bf16 v[32:47], v[28:31], v[228:231], v[32:47]
    ds_read_b64_tr_b16 v[28:29], v12 offset:34816
    ds_read_b64_tr_b16 v[30:31], v12 offset:36352
    s_waitcnt lgkmcnt(10)
    v_mfma_f32_32x32x16_bf16 v[48:63], v[80:83], v[228:231], v[48:63]
    ds_read_b64_tr_b16 v[80:81], v13 offset:34816
    ds_read_b64_tr_b16 v[82:83], v13 offset:36352
    s_waitcnt lgkmcnt(10)
    v_mfma_f32_32x32x16_bf16 v[64:79], v[84:87], v[228:231], v[64:79]
    ds_read_b64_tr_b16 v[84:85], v14 offset:34816
    ds_read_b64_tr_b16 v[86:87], v14 offset:36352
    s_waitcnt lgkmcnt(10)
    v_mfma_f32_32x32x16_bf16 v[32:47], v[16:19], v[232:235], v[32:47]
    s_waitcnt lgkmcnt(8)
    v_mfma_f32_32x32x16_bf16 v[48:63], v[20:23], v[232:235], v[48:63]
    s_waitcnt lgkmcnt(6)
    v_mfma_f32_32x32x16_bf16 v[64:79], v[24:27], v[232:235], v[64:79]
    s_waitcnt lgkmcnt(4)
    v_mfma_f32_32x32x16_bf16 v[32:47], v[28:31], v[236:239], v[32:47]
    s_waitcnt lgkmcnt(2)
    v_mfma_f32_32x32x16_bf16 v[48:63], v[80:83], v[236:239], v[48:63]
    s_waitcnt lgkmcnt(0)
    v_mfma_f32_32x32x16_bf16 v[64:79], v[84:87], v[236:239], v[64:79]
    s_barrier
    v_add_u32 v15, 65536, v10
    ds_read_b128 v[240:243], v15 offset:8192
    v_add_u32 v15, 65536, v11
    ds_read_b128 v[244:247], v15 offset:8192
    v_add_u32 v15, 65536, v90
    ds_read_b128 v[248:251], v15 offset:8192
    v_add_u32 v15, 65536, v91
    ds_read_b128 v[252:255], v15 offset:8192
    ds_read_b64_tr_b16 v[16:17], v7 offset:0
    ds_read_b64_tr_b16 v[18:19], v7 offset:1536
    ds_read_b64_tr_b16 v[20:21], v8 offset:0
    ds_read_b64_tr_b16 v[22:23], v8 offset:1536
    ds_read_b64_tr_b16 v[24:25], v9 offset:0
    ds_read_b64_tr_b16 v[26:27], v9 offset:1536
    ds_read_b64_tr_b16 v[28:29], v7 offset:6144
    ds_read_b64_tr_b16 v[30:31], v7 offset:7680
    ds_read_b64_tr_b16 v[80:81], v8 offset:6144
    ds_read_b64_tr_b16 v[82:83], v8 offset:7680
    ds_read_b64_tr_b16 v[84:85], v9 offset:6144
    s_waitcnt lgkmcnt(14)
    ds_read_b64_tr_b16 v[86:87], v9 offset:7680
    s_waitcnt lgkmcnt(10)
    v_mfma_f32_32x32x16_bf16 v[32:47], v[16:19], v[240:243], v[32:47]
    ds_read_b64_tr_b16 v[16:17], v7 offset:12288
    ds_read_b64_tr_b16 v[18:19], v7 offset:13824
    s_waitcnt lgkmcnt(10)
    v_mfma_f32_32x32x16_bf16 v[48:63], v[20:23], v[240:243], v[48:63]
    ds_read_b64_tr_b16 v[20:21], v8 offset:12288
    ds_read_b64_tr_b16 v[22:23], v8 offset:13824
    s_waitcnt lgkmcnt(10)
    v_mfma_f32_32x32x16_bf16 v[64:79], v[24:27], v[240:243], v[64:79]
    ds_read_b64_tr_b16 v[24:25], v9 offset:12288
    ds_read_b64_tr_b16 v[26:27], v9 offset:13824
    s_waitcnt lgkmcnt(10)
    v_mfma_f32_32x32x16_bf16 v[32:47], v[28:31], v[244:247], v[32:47]
    ds_read_b64_tr_b16 v[28:29], v7 offset:18432
    ds_read_b64_tr_b16 v[30:31], v7 offset:19968
    s_waitcnt lgkmcnt(10)
    v_mfma_f32_32x32x16_bf16 v[48:63], v[80:83], v[244:247], v[48:63]
    ds_read_b64_tr_b16 v[80:81], v8 offset:18432
    ds_read_b64_tr_b16 v[82:83], v8 offset:19968
    s_waitcnt lgkmcnt(10)
    v_mfma_f32_32x32x16_bf16 v[64:79], v[84:87], v[244:247], v[64:79]
    ds_read_b64_tr_b16 v[84:85], v9 offset:18432
    ds_read_b64_tr_b16 v[86:87], v9 offset:19968
    s_waitcnt lgkmcnt(10)
    v_mfma_f32_32x32x16_bf16 v[32:47], v[16:19], v[248:251], v[32:47]
    s_waitcnt lgkmcnt(8)
    v_mfma_f32_32x32x16_bf16 v[48:63], v[20:23], v[248:251], v[48:63]
    s_waitcnt lgkmcnt(6)
    v_mfma_f32_32x32x16_bf16 v[64:79], v[24:27], v[248:251], v[64:79]
    s_waitcnt lgkmcnt(4)
    v_mfma_f32_32x32x16_bf16 v[32:47], v[28:31], v[252:255], v[32:47]
    s_waitcnt lgkmcnt(2)
    v_mfma_f32_32x32x16_bf16 v[48:63], v[80:83], v[252:255], v[48:63]
    s_waitcnt lgkmcnt(0)
    v_mfma_f32_32x32x16_bf16 v[64:79], v[84:87], v[252:255], v[64:79]
    s_barrier
    s_and_b32 s66, s4, 1
    s_lshl_b32 s67, s66, 5
    v_and_b32 v12, 31, v0
    v_add_u32 v12, s67, v12
    v_bfe_u32 v13, v12, 1, 3
    v_mul_u32_u24 v12, 384, v12
    v_lshrrev_b32 v14, 5, v0
    v_lshlrev_b32 v14, 3, v14
    v_add_u32 v12, v12, v14
    v_cvt_pk_bf16_f32 v32, v32, v33
    v_cvt_pk_bf16_f32 v33, v34, v35
    s_add_u32 s66, s72, 0
    v_xor_b32 v14, s66, v13
    v_lshl_add_u32 v14, v14, 4, v12
    ds_write_b64 v14, v[32:33] offset:0
    v_cvt_pk_bf16_f32 v36, v36, v37
    v_cvt_pk_bf16_f32 v37, v38, v39
    s_add_u32 s66, s72, 1
    v_xor_b32 v15, s66, v13
    v_lshl_add_u32 v15, v15, 4, v12
    ds_write_b64 v15, v[36:37] offset:0
    v_cvt_pk_bf16_f32 v40, v40, v41
    v_cvt_pk_bf16_f32 v41, v42, v43
    s_add_u32 s66, s72, 2
    v_xor_b32 v14, s66, v13
    v_lshl_add_u32 v14, v14, 4, v12
    ds_write_b64 v14, v[40:41] offset:0
    v_cvt_pk_bf16_f32 v44, v44, v45
    v_cvt_pk_bf16_f32 v45, v46, v47
    s_add_u32 s66, s72, 3
    v_xor_b32 v15, s66, v13
    v_lshl_add_u32 v15, v15, 4, v12
    ds_write_b64 v15, v[44:45] offset:0
    v_cvt_pk_bf16_f32 v48, v48, v49
    v_cvt_pk_bf16_f32 v49, v50, v51
    s_add_u32 s66, s72, 4
    v_xor_b32 v14, s66, v13
    v_lshl_add_u32 v14, v14, 4, v12
    ds_write_b64 v14, v[48:49] offset:0
    v_cvt_pk_bf16_f32 v52, v52, v53
    v_cvt_pk_bf16_f32 v53, v54, v55
    s_add_u32 s66, s72, 5
    v_xor_b32 v15, s66, v13
    v_lshl_add_u32 v15, v15, 4, v12
    ds_write_b64 v15, v[52:53] offset:0
    v_cvt_pk_bf16_f32 v56, v56, v57
    v_cvt_pk_bf16_f32 v57, v58, v59
    s_add_u32 s66, s72, 6
    v_xor_b32 v14, s66, v13
    v_lshl_add_u32 v14, v14, 4, v12
    ds_write_b64 v14, v[56:57] offset:0
    v_cvt_pk_bf16_f32 v60, v60, v61
    v_cvt_pk_bf16_f32 v61, v62, v63
    s_add_u32 s66, s72, 7
    v_xor_b32 v15, s66, v13
    v_lshl_add_u32 v15, v15, 4, v12
    ds_write_b64 v15, v[60:61] offset:0
    v_cvt_pk_bf16_f32 v64, v64, v65
    v_cvt_pk_bf16_f32 v65, v66, v67
    s_add_u32 s66, s72, 8
    v_xor_b32 v14, s66, v13
    v_lshl_add_u32 v14, v14, 4, v12
    ds_write_b64 v14, v[64:65] offset:0
    v_cvt_pk_bf16_f32 v68, v68, v69
    v_cvt_pk_bf16_f32 v69, v70, v71
    s_add_u32 s66, s72, 9
    v_xor_b32 v15, s66, v13
    v_lshl_add_u32 v15, v15, 4, v12
    ds_write_b64 v15, v[68:69] offset:0
    v_cvt_pk_bf16_f32 v72, v72, v73
    v_cvt_pk_bf16_f32 v73, v74, v75
    s_add_u32 s66, s72, 10
    v_xor_b32 v14, s66, v13
    v_lshl_add_u32 v14, v14, 4, v12
    ds_write_b64 v14, v[72:73] offset:0
    v_cvt_pk_bf16_f32 v76, v76, v77
    v_cvt_pk_bf16_f32 v77, v78, v79
    s_add_u32 s66, s72, 11
    v_xor_b32 v15, s66, v13
    v_lshl_add_u32 v15, v15, 4, v12
    ds_write_b64 v15, v[76:77] offset:0
    s_lshl_b32 s66, s4, 2
    v_add_u32 v12, 0, v0
    v_mul_u32_u24 v12, 171, v12
    v_lshrrev_b32 v12, 13, v12
    v_add_u32 v12, s66, v12
    v_and_b32 v12, 7, v12
    v_xor_b32 v12, v12, v0
    v_lshlrev_b32 v12, 4, v12
    v_add_u32 v90, s60, v12
    v_add_u32 v12, 64, v0
    v_mul_u32_u24 v12, 171, v12
    v_lshrrev_b32 v12, 13, v12
    v_add_u32 v12, s66, v12
    v_and_b32 v12, 7, v12
    v_xor_b32 v12, v12, v0
    v_lshlrev_b32 v12, 4, v12
    v_add_u32 v91, s60, v12
    v_add_u32 v12, 128, v0
    v_mul_u32_u24 v12, 171, v12
    v_lshrrev_b32 v12, 13, v12
    v_add_u32 v12, s66, v12
    v_and_b32 v12, 7, v12
    v_xor_b32 v12, v12, v0
    v_lshlrev_b32 v12, 4, v12
    v_add_u32 v92, s60, v12
    s_mul_i32 s66, s4, 6144
    v_lshrrev_b32 v12, 3, v0
    v_and_b32 v13, 6, v12
    v_xor_b32 v13, v13, v0
    v_and_b32 v13, 7, v13
    v_lshlrev_b32 v13, 4, v13
    v_mul_u32_u24 v12, 384, v12
    v_add_u32 v12, v12, v13
    v_add_u32 v93, s66, v12
    v_add_u32 v94, 2048, v93
    s_add_u32 s70, s7, 0
    s_sub_u32 s67, s70, 20
    s_cmp_ge_u32 s70, 20
    s_cselect_b32 s70, s67, s70
    s_mul_i32 s66, s70, 393216
    s_add_u32 s66, s66, s64
    s_add_u32 s66, s66, 384
    s_add_u32 m0, s60, 24576
    s_nop 0
    buffer_load_dwordx4 v4, s[40:43], s66 offen lds
    buffer_load_dwordx4 v5, s[40:43], s66 offen offset:1024 lds
    buffer_load_dwordx4 v6, s[40:43], s66 offen offset:2048 lds
    s_add_u32 s70, s7, 1
    s_sub_u32 s67, s70, 20
    s_cmp_ge_u32 s70, 20
    s_cselect_b32 s70, s67, s70
    s_mul_i32 s66, s70, 393216
    s_add_u32 s66, s66, s64
    s_add_u32 s66, s66, 384
    s_add_u32 m0, s60, 36864
    s_nop 0
    buffer_load_dwordx4 v4, s[40:43], s66 offen lds
    buffer_load_dwordx4 v5, s[40:43], s66 offen offset:1024 lds
    buffer_load_dwordx4 v6, s[40:43], s66 offen offset:2048 lds
    s_mul_i32 s66, s4, 320
    v_add_u32 v15, 0, v0
    v_add_u32 v15, s66, v15
    v_mul_u32_u24 v15, 3277, v15
    v_lshrrev_b32 v15, 18, v15
    v_and_b32 v15, 3, v15
    v_lshlrev_b32 v15, 2, v15
    v_xor_b32 v15, v15, v0
    v_lshlrev_b32 v15, 4, v15
    v_add_u32 v1, s63, v15
    v_add_u32 v15, 64, v0
    v_add_u32 v15, s66, v15
    v_mul_u32_u24 v15, 3277, v15
    v_lshrrev_b32 v15, 18, v15
    v_and_b32 v15, 3, v15
    v_lshlrev_b32 v15, 2, v15
    v_xor_b32 v15, v15, v0
    v_lshlrev_b32 v15, 4, v15
    v_add_u32 v2, s63, v15
    v_add_u32 v15, 128, v0
    v_add_u32 v15, s66, v15
    v_mul_u32_u24 v15, 3277, v15
    v_lshrrev_b32 v15, 18, v15
    v_and_b32 v15, 3, v15
    v_lshlrev_b32 v15, 2, v15
    v_xor_b32 v15, v15, v0
    v_lshlrev_b32 v15, 4, v15
    v_add_u32 v3, s63, v15
    v_add_u32 v15, 192, v0
    v_add_u32 v15, s66, v15
    v_mul_u32_u24 v15, 3277, v15
    v_lshrrev_b32 v15, 18, v15
    v_and_b32 v15, 3, v15
    v_lshlrev_b32 v15, 2, v15
    v_xor_b32 v15, v15, v0
    v_lshlrev_b32 v15, 4, v15
    v_add_u32 v88, s63, v15
    v_add_u32 v15, 256, v0
    v_add_u32 v15, s66, v15
    v_mul_u32_u24 v15, 3277, v15
    v_lshrrev_b32 v15, 18, v15
    v_and_b32 v15, 3, v15
    v_lshlrev_b32 v15, 2, v15
    v_xor_b32 v15, v15, v0
    v_lshlrev_b32 v15, 4, v15
    v_add_u32 v89, s63, v15
    v_add_u32 v89, 4096, v89
    s_waitcnt lgkmcnt(0)
    s_barrier
    s_add_u32 s70, s7, 2
    s_sub_u32 s67, s70, 20
    s_cmp_ge_u32 s70, 20
    s_cselect_b32 s70, s67, s70
    s_mul_i32 s66, s70, 393216
    s_add_u32 s66, s66, s64
    s_add_u32 s66, s66, 384
    s_add_u32 m0, s60, 49152
    s_nop 0
    buffer_load_dwordx4 v4, s[40:43], s66 offen lds
    buffer_load_dwordx4 v5, s[40:43], s66 offen offset:1024 lds
    buffer_load_dwordx4 v6, s[40:43], s66 offen offset:2048 lds
    s_add_u32 s70, s7, 3
    s_sub_u32 s67, s70, 20
    s_cmp_ge_u32 s70, 20
    s_cselect_b32 s70, s67, s70
    s_mul_i32 s66, s70, 393216
    s_add_u32 s66, s66, s64
    s_add_u32 s66, s66, 384
    s_add_u32 m0, s60, 61440
    s_nop 0
    buffer_load_dwordx4 v4, s[40:43], s66 offen lds
    buffer_load_dwordx4 v5, s[40:43], s66 offen offset:1024 lds
    buffer_load_dwordx4 v6, s[40:43], s66 offen offset:2048 lds
    s_barrier
    s_add_u32 m0, s60, 90112
    s_mov_b32 s66, 73728
    buffer_load_dwordx4 v90, s[32:35], s66 offen nt lds
    buffer_load_dwordx4 v91, s[32:35], s66 offen offset:1024 nt lds
    buffer_load_dwordx4 v92, s[32:35], s66 offen offset:2048 nt lds
    s_add_u32 m0, s60, 102400
    s_mov_b32 s66, 86016
    buffer_load_dwordx4 v90, s[32:35], s66 offen nt lds
    buffer_load_dwordx4 v91, s[32:35], s66 offen offset:1024 nt lds
    buffer_load_dwordx4 v92, s[32:35], s66 offen offset:2048 nt lds
    s_add_u32 s70, s7, 4
    s_sub_u32 s67, s70, 20
    s_cmp_ge_u32 s70, 20
    s_cselect_b32 s70, s67, s70
    s_mul_i32 s66, s70, 393216
    s_add_u32 s66, s66, s64
    s_add_u32 s66, s66, 384
    s_add_u32 m0, s60, 0
    s_nop 0
    buffer_load_dwordx4 v4, s[40:43], s66 offen lds
    buffer_load_dwordx4 v5, s[40:43], s66 offen offset:1024 lds
    buffer_load_dwordx4 v6, s[40:43], s66 offen offset:2048 lds
    s_add_u32 s70, s7, 5
    s_sub_u32 s67, s70, 20
    s_cmp_ge_u32 s70, 20
    s_cselect_b32 s70, s67, s70
    s_mul_i32 s66, s70, 393216
    s_add_u32 s66, s66, s64
    s_add_u32 s66, s66, 384
    s_add_u32 m0, s60, 12288
    s_nop 0
    buffer_load_dwordx4 v4, s[40:43], s66 offen lds
    buffer_load_dwordx4 v5, s[40:43], s66 offen offset:1024 lds
    buffer_load_dwordx4 v6, s[40:43], s66 offen offset:2048 lds
    s_waitcnt vmcnt(21)
    s_waitcnt vmcnt(18)
    s_barrier
    ds_read_b64_tr_b16 v[16:17], v7 offset:24576
    ds_read_b64_tr_b16 v[18:19], v7 offset:26112
    ds_read_b64_tr_b16 v[20:21], v8 offset:24576
    ds_read_b64_tr_b16 v[22:23], v8 offset:26112
    ds_read_b64_tr_b16 v[24:25], v9 offset:24576
    ds_read_b64_tr_b16 v[26:27], v9 offset:26112
    ds_read_b64_tr_b16 v[28:29], v7 offset:30720
    ds_read_b64_tr_b16 v[30:31], v7 offset:32256
    ds_read_b64_tr_b16 v[80:81], v8 offset:30720
    ds_read_b64_tr_b16 v[82:83], v8 offset:32256
    ds_read_b64_tr_b16 v[84:85], v9 offset:30720
    ds_read_b64_tr_b16 v[86:87], v9 offset:32256
    s_add_u32 m0, s60, 114688
    s_mov_b32 s66, 98304
    buffer_load_dwordx4 v90, s[32:35], s66 offen nt lds
    buffer_load_dwordx4 v91, s[32:35], s66 offen offset:1024 nt lds
    buffer_load_dwordx4 v92, s[32:35], s66 offen offset:2048 nt lds
    s_add_u32 m0, s60, 126976
    s_mov_b32 s66, 110592
    buffer_load_dwordx4 v90, s[32:35], s66 offen nt lds
    buffer_load_dwordx4 v91, s[32:35], s66 offen offset:1024 nt lds
    buffer_load_dwordx4 v92, s[32:35], s66 offen offset:2048 nt lds
    s_waitcnt lgkmcnt(10)
    v_mfma_f32_32x32x16_bf16 v[32:47], v[16:19], v[96:99], 0
    ds_read_b64_tr_b16 v[16:17], v7 offset:36864
    ds_read_b64_tr_b16 v[18:19], v7 offset:38400
    s_waitcnt lgkmcnt(10)
    v_mfma_f32_32x32x16_bf16 v[48:63], v[20:23], v[96:99], 0
    ds_read_b64_tr_b16 v[20:21], v8 offset:36864
    ds_read_b64_tr_b16 v[22:23], v8 offset:38400
    s_waitcnt lgkmcnt(10)
    v_mfma_f32_32x32x16_bf16 v[64:79], v[24:27], v[96:99], 0
    ds_read_b64_tr_b16 v[24:25], v9 offset:36864
    ds_read_b64_tr_b16 v[26:27], v9 offset:38400
    s_waitcnt lgkmcnt(10)
    v_mfma_f32_32x32x16_bf16 v[32:47], v[28:31], v[100:103], v[32:47]
    ds_read_b64_tr_b16 v[28:29], v7 offset:43008
    ds_read_b64_tr_b16 v[30:31], v7 offset:44544
    s_waitcnt lgkmcnt(10)
    v_mfma_f32_32x32x16_bf16 v[48:63], v[80:83], v[100:103], v[48:63]
    ds_read_b64_tr_b16 v[80:81], v8 offset:43008
    ds_read_b64_tr_b16 v[82:83], v8 offset:44544
    s_waitcnt lgkmcnt(10)
    v_mfma_f32_32x32x16_bf16 v[64:79], v[84:87], v[100:103], v[64:79]
    ds_read_b64_tr_b16 v[84:85], v9 offset:43008
    ds_read_b64_tr_b16 v[86:87], v9 offset:44544
    s_waitcnt lgkmcnt(10)
    v_mfma_f32_32x32x16_bf16 v[32:47], v[16:19], v[104:107], v[32:47]
    s_waitcnt lgkmcnt(8)
    v_mfma_f32_32x32x16_bf16 v[48:63], v[20:23], v[104:107], v[48:63]
    s_waitcnt lgkmcnt(6)
    v_mfma_f32_32x32x16_bf16 v[64:79], v[24:27], v[104:107], v[64:79]
    s_waitcnt lgkmcnt(4)
    v_mfma_f32_32x32x16_bf16 v[32:47], v[28:31], v[108:111], v[32:47]
    s_waitcnt lgkmcnt(2)
    v_mfma_f32_32x32x16_bf16 v[48:63], v[80:83], v[108:111], v[48:63]
    s_waitcnt lgkmcnt(0)
    v_mfma_f32_32x32x16_bf16 v[64:79], v[84:87], v[108:111], v[64:79]
    s_waitcnt vmcnt(15)
    s_waitcnt vmcnt(12)
    s_barrier
    v_add_u32 v12, 32768, v7
    v_add_u32 v13, 32768, v8
    v_add_u32 v14, 32768, v9
    ds_read_b64_tr_b16 v[16:17], v7 offset:49152
    ds_read_b64_tr_b16 v[18:19], v7 offset:50688
    ds_read_b64_tr_b16 v[20:21], v8 offset:49152
    ds_read_b64_tr_b16 v[22:23], v8 offset:50688
    ds_read_b64_tr_b16 v[24:25], v9 offset:49152
    ds_read_b64_tr_b16 v[26:27], v9 offset:50688
    ds_read_b64_tr_b16 v[28:29], v7 offset:55296
    ds_read_b64_tr_b16 v[30:31], v7 offset:56832
    ds_read_b64_tr_b16 v[80:81], v8 offset:55296
    ds_read_b64_tr_b16 v[82:83], v8 offset:56832
    ds_read_b64_tr_b16 v[84:85], v9 offset:55296
    ds_read_b64_tr_b16 v[86:87], v9 offset:56832
    s_add_u32 m0, s60, 139264
    s_mov_b32 s66, 122880
    buffer_load_dwordx4 v90, s[32:35], s66 offen nt lds
    buffer_load_dwordx4 v91, s[32:35], s66 offen offset:1024 nt lds
    buffer_load_dwordx4 v92, s[32:35], s66 offen offset:2048 nt lds
    s_add_u32 m0, s60, 151552
    s_mov_b32 s66, 135168
    buffer_load_dwordx4 v90, s[32:35], s66 offen nt lds
    buffer_load_dwordx4 v91, s[32:35], s66 offen offset:1024 nt lds
    buffer_load_dwordx4 v92, s[32:35], s66 offen offset:2048 nt lds
    s_add_u32 s70, s7, 6
    s_sub_u32 s67, s70, 20
    s_cmp_ge_u32 s70, 20
    s_cselect_b32 s70, s67, s70
    s_mul_i32 s66, s70, 393216
    s_add_u32 s66, s66, s64
    s_add_u32 s66, s66, 384
    s_add_u32 m0, s60, 24576
    s_nop 0
    buffer_load_dwordx4 v4, s[40:43], s66 offen lds
    buffer_load_dwordx4 v5, s[40:43], s66 offen offset:1024 lds
    buffer_load_dwordx4 v6, s[40:43], s66 offen offset:2048 lds
    s_add_u32 s70, s7, 7
    s_sub_u32 s67, s70, 20
    s_cmp_ge_u32 s70, 20
    s_cselect_b32 s70, s67, s70
    s_mul_i32 s66, s70, 393216
    s_add_u32 s66, s66, s64
    s_add_u32 s66, s66, 384
    s_add_u32 m0, s60, 36864
    s_nop 0
    buffer_load_dwordx4 v4, s[40:43], s66 offen lds
    buffer_load_dwordx4 v5, s[40:43], s66 offen offset:1024 lds
    buffer_load_dwordx4 v6, s[40:43], s66 offen offset:2048 lds
    s_waitcnt lgkmcnt(10)
    v_mfma_f32_32x32x16_bf16 v[32:47], v[16:19], v[112:115], v[32:47]
    ds_read_b64_tr_b16 v[16:17], v12 offset:28672
    ds_read_b64_tr_b16 v[18:19], v12 offset:30208
    s_waitcnt lgkmcnt(10)
    v_mfma_f32_32x32x16_bf16 v[48:63], v[20:23], v[112:115], v[48:63]
    ds_read_b64_tr_b16 v[20:21], v13 offset:28672
    ds_read_b64_tr_b16 v[22:23], v13 offset:30208
    s_waitcnt lgkmcnt(10)
    v_mfma_f32_32x32x16_bf16 v[64:79], v[24:27], v[112:115], v[64:79]
    ds_read_b64_tr_b16 v[24:25], v14 offset:28672
    ds_read_b64_tr_b16 v[26:27], v14 offset:30208
    s_waitcnt lgkmcnt(10)
    v_mfma_f32_32x32x16_bf16 v[32:47], v[28:31], v[116:119], v[32:47]
    ds_read_b64_tr_b16 v[28:29], v12 offset:34816
    ds_read_b64_tr_b16 v[30:31], v12 offset:36352
    s_waitcnt lgkmcnt(10)
    v_mfma_f32_32x32x16_bf16 v[48:63], v[80:83], v[116:119], v[48:63]
    ds_read_b64_tr_b16 v[80:81], v13 offset:34816
    ds_read_b64_tr_b16 v[82:83], v13 offset:36352
    s_waitcnt lgkmcnt(10)
    v_mfma_f32_32x32x16_bf16 v[64:79], v[84:87], v[116:119], v[64:79]
    ds_read_b64_tr_b16 v[84:85], v14 offset:34816
    ds_read_b64_tr_b16 v[86:87], v14 offset:36352
    s_waitcnt lgkmcnt(10)
    v_mfma_f32_32x32x16_bf16 v[32:47], v[16:19], v[120:123], v[32:47]
    s_waitcnt lgkmcnt(8)
    v_mfma_f32_32x32x16_bf16 v[48:63], v[20:23], v[120:123], v[48:63]
    s_waitcnt lgkmcnt(6)
    v_mfma_f32_32x32x16_bf16 v[64:79], v[24:27], v[120:123], v[64:79]
    s_waitcnt lgkmcnt(4)
    v_mfma_f32_32x32x16_bf16 v[32:47], v[28:31], v[124:127], v[32:47]
    s_waitcnt lgkmcnt(2)
    v_mfma_f32_32x32x16_bf16 v[48:63], v[80:83], v[124:127], v[48:63]
    s_waitcnt lgkmcnt(0)
    v_mfma_f32_32x32x16_bf16 v[64:79], v[84:87], v[124:127], v[64:79]
    s_waitcnt vmcnt(15)
    s_waitcnt vmcnt(12)
    s_barrier
    ds_read_b64_tr_b16 v[16:17], v7 offset:0
    ds_read_b64_tr_b16 v[18:19], v7 offset:1536
    ds_read_b64_tr_b16 v[20:21], v8 offset:0
    ds_read_b64_tr_b16 v[22:23], v8 offset:1536
    ds_read_b64_tr_b16 v[24:25], v9 offset:0
    ds_read_b64_tr_b16 v[26:27], v9 offset:1536
    ds_read_b64_tr_b16 v[28:29], v7 offset:6144
    ds_read_b64_tr_b16 v[30:31], v7 offset:7680
    ds_read_b64_tr_b16 v[80:81], v8 offset:6144
    ds_read_b64_tr_b16 v[82:83], v8 offset:7680
    ds_read_b64_tr_b16 v[84:85], v9 offset:6144
    ds_read_b64_tr_b16 v[86:87], v9 offset:7680
    s_add_u32 m0, s60, 90112
    s_mov_b32 s66, 147456
    buffer_load_dwordx4 v90, s[32:35], s66 offen nt lds
    buffer_load_dwordx4 v91, s[32:35], s66 offen offset:1024 nt lds
    buffer_load_dwordx4 v92, s[32:35], s66 offen offset:2048 nt lds
    s_add_u32 m0, s60, 102400
    s_mov_b32 s66, 159744
    buffer_load_dwordx4 v90, s[32:35], s66 offen nt lds
    buffer_load_dwordx4 v91, s[32:35], s66 offen offset:1024 nt lds
    buffer_load_dwordx4 v92, s[32:35], s66 offen offset:2048 nt lds
    s_add_u32 s70, s7, 8
    s_sub_u32 s67, s70, 20
    s_cmp_ge_u32 s70, 20
    s_cselect_b32 s70, s67, s70
    s_mul_i32 s66, s70, 393216
    s_add_u32 s66, s66, s64
    s_add_u32 s66, s66, 384
    s_add_u32 m0, s60, 49152
    s_nop 0
    buffer_load_dwordx4 v4, s[40:43], s66 offen lds
    buffer_load_dwordx4 v5, s[40:43], s66 offen offset:1024 lds
    buffer_load_dwordx4 v6, s[40:43], s66 offen offset:2048 lds
    s_add_u32 s70, s7, 9
    s_sub_u32 s67, s70, 20
    s_cmp_ge_u32 s70, 20
    s_cselect_b32 s70, s67, s70
    s_mul_i32 s66, s70, 393216
    s_add_u32 s66, s66, s64
    s_add_u32 s66, s66, 384
    s_add_u32 m0, s60, 61440
    s_nop 0
    buffer_load_dwordx4 v4, s[40:43], s66 offen lds
    buffer_load_dwordx4 v5, s[40:43], s66 offen offset:1024 lds
    buffer_load_dwordx4 v6, s[40:43], s66 offen offset:2048 lds
    s_waitcnt lgkmcnt(10)
    v_mfma_f32_32x32x16_bf16 v[32:47], v[16:19], v[128:131], v[32:47]
    ds_read_b64_tr_b16 v[16:17], v7 offset:12288
    ds_read_b64_tr_b16 v[18:19], v7 offset:13824
    s_waitcnt lgkmcnt(10)
    v_mfma_f32_32x32x16_bf16 v[48:63], v[20:23], v[128:131], v[48:63]
    ds_read_b64_tr_b16 v[20:21], v8 offset:12288
    ds_read_b64_tr_b16 v[22:23], v8 offset:13824
    s_waitcnt lgkmcnt(10)
    v_mfma_f32_32x32x16_bf16 v[64:79], v[24:27], v[128:131], v[64:79]
    ds_read_b64_tr_b16 v[24:25], v9 offset:12288
    ds_read_b64_tr_b16 v[26:27], v9 offset:13824
    s_waitcnt lgkmcnt(10)
    v_mfma_f32_32x32x16_bf16 v[32:47], v[28:31], v[132:135], v[32:47]
    ds_read_b64_tr_b16 v[28:29], v7 offset:18432
    ds_read_b64_tr_b16 v[30:31], v7 offset:19968
    s_waitcnt lgkmcnt(10)
    v_mfma_f32_32x32x16_bf16 v[48:63], v[80:83], v[132:135], v[48:63]
    ds_read_b64_tr_b16 v[80:81], v8 offset:18432
    ds_read_b64_tr_b16 v[82:83], v8 offset:19968
    s_waitcnt lgkmcnt(10)
    v_mfma_f32_32x32x16_bf16 v[64:79], v[84:87], v[132:135], v[64:79]
    ds_read_b64_tr_b16 v[84:85], v9 offset:18432
    ds_read_b64_tr_b16 v[86:87], v9 offset:19968
    s_waitcnt lgkmcnt(10)
    v_mfma_f32_32x32x16_bf16 v[32:47], v[16:19], v[136:139], v[32:47]
    s_waitcnt lgkmcnt(8)
    v_mfma_f32_32x32x16_bf16 v[48:63], v[20:23], v[136:139], v[48:63]
    s_waitcnt lgkmcnt(6)
    v_mfma_f32_32x32x16_bf16 v[64:79], v[24:27], v[136:139], v[64:79]
    s_waitcnt lgkmcnt(4)
    v_mfma_f32_32x32x16_bf16 v[32:47], v[28:31], v[140:143], v[32:47]
    s_waitcnt lgkmcnt(2)
    v_mfma_f32_32x32x16_bf16 v[48:63], v[80:83], v[140:143], v[48:63]
    s_waitcnt lgkmcnt(0)
    v_mfma_f32_32x32x16_bf16 v[64:79], v[84:87], v[140:143], v[64:79]
    s_waitcnt vmcnt(21)
    s_waitcnt vmcnt(18)
    s_waitcnt vmcnt(15)
    s_waitcnt vmcnt(12)
    s_barrier
    ds_read_b64_tr_b16 v[16:17], v7 offset:24576
    ds_read_b64_tr_b16 v[18:19], v7 offset:26112
    ds_read_b64_tr_b16 v[20:21], v8 offset:24576
    ds_read_b64_tr_b16 v[22:23], v8 offset:26112
    ds_read_b64_tr_b16 v[24:25], v9 offset:24576
    ds_read_b64_tr_b16 v[26:27], v9 offset:26112
    ds_read_b64_tr_b16 v[28:29], v7 offset:30720
    ds_read_b64_tr_b16 v[30:31], v7 offset:32256
    ds_read_b64_tr_b16 v[80:81], v8 offset:30720
    ds_read_b64_tr_b16 v[82:83], v8 offset:32256
    ds_read_b64_tr_b16 v[84:85], v9 offset:30720
    ds_read_b64_tr_b16 v[86:87], v9 offset:32256
    s_add_u32 m0, s60, 114688
    s_mov_b32 s66, 172032
    buffer_load_dwordx4 v90, s[32:35], s66 offen nt lds
    buffer_load_dwordx4 v91, s[32:35], s66 offen offset:1024 nt lds
    buffer_load_dwordx4 v92, s[32:35], s66 offen offset:2048 nt lds
    s_add_u32 m0, s60, 126976
    s_mov_b32 s66, 184320
    buffer_load_dwordx4 v90, s[32:35], s66 offen nt lds
    buffer_load_dwordx4 v91, s[32:35], s66 offen offset:1024 nt lds
    buffer_load_dwordx4 v92, s[32:35], s66 offen offset:2048 nt lds
    s_add_u32 s70, s7, 10
    s_sub_u32 s67, s70, 20
    s_cmp_ge_u32 s70, 20
    s_cselect_b32 s70, s67, s70
    s_mul_i32 s66, s70, 393216
    s_add_u32 s66, s66, s64
    s_add_u32 s66, s66, 384
    s_add_u32 m0, s60, 0
    s_nop 0
    buffer_load_dwordx4 v4, s[40:43], s66 offen lds
    buffer_load_dwordx4 v5, s[40:43], s66 offen offset:1024 lds
    buffer_load_dwordx4 v6, s[40:43], s66 offen offset:2048 lds
    s_add_u32 s70, s7, 11
    s_sub_u32 s67, s70, 20
    s_cmp_ge_u32 s70, 20
    s_cselect_b32 s70, s67, s70
    s_mul_i32 s66, s70, 393216
    s_add_u32 s66, s66, s64
    s_add_u32 s66, s66, 384
    s_add_u32 m0, s60, 12288
    s_nop 0
    buffer_load_dwordx4 v4, s[40:43], s66 offen lds
    buffer_load_dwordx4 v5, s[40:43], s66 offen offset:1024 lds
    buffer_load_dwordx4 v6, s[40:43], s66 offen offset:2048 lds
    s_waitcnt lgkmcnt(10)
    v_mfma_f32_32x32x16_bf16 v[32:47], v[16:19], v[144:147], v[32:47]
    ds_read_b64_tr_b16 v[16:17], v7 offset:36864
    ds_read_b64_tr_b16 v[18:19], v7 offset:38400
    s_waitcnt lgkmcnt(10)
    v_mfma_f32_32x32x16_bf16 v[48:63], v[20:23], v[144:147], v[48:63]
    ds_read_b64_tr_b16 v[20:21], v8 offset:36864
    ds_read_b64_tr_b16 v[22:23], v8 offset:38400
    s_waitcnt lgkmcnt(10)
    v_mfma_f32_32x32x16_bf16 v[64:79], v[24:27], v[144:147], v[64:79]
    ds_read_b64_tr_b16 v[24:25], v9 offset:36864
    ds_read_b64_tr_b16 v[26:27], v9 offset:38400
    s_waitcnt lgkmcnt(10)
    v_mfma_f32_32x32x16_bf16 v[32:47], v[28:31], v[148:151], v[32:47]
    ds_read_b64_tr_b16 v[28:29], v7 offset:43008
    ds_read_b64_tr_b16 v[30:31], v7 offset:44544
    s_waitcnt lgkmcnt(10)
    v_mfma_f32_32x32x16_bf16 v[48:63], v[80:83], v[148:151], v[48:63]
    ds_read_b64_tr_b16 v[80:81], v8 offset:43008
    ds_read_b64_tr_b16 v[82:83], v8 offset:44544
    s_waitcnt lgkmcnt(10)
    v_mfma_f32_32x32x16_bf16 v[64:79], v[84:87], v[148:151], v[64:79]
    ds_read_b64_tr_b16 v[84:85], v9 offset:43008
    ds_read_b64_tr_b16 v[86:87], v9 offset:44544
    s_waitcnt lgkmcnt(10)
    v_mfma_f32_32x32x16_bf16 v[32:47], v[16:19], v[152:155], v[32:47]
    s_waitcnt lgkmcnt(8)
    v_mfma_f32_32x32x16_bf16 v[48:63], v[20:23], v[152:155], v[48:63]
    s_waitcnt lgkmcnt(6)
    v_mfma_f32_32x32x16_bf16 v[64:79], v[24:27], v[152:155], v[64:79]
    s_waitcnt lgkmcnt(4)
    v_mfma_f32_32x32x16_bf16 v[32:47], v[28:31], v[156:159], v[32:47]
    s_waitcnt lgkmcnt(2)
    v_mfma_f32_32x32x16_bf16 v[48:63], v[80:83], v[156:159], v[48:63]
    s_waitcnt lgkmcnt(0)
    v_mfma_f32_32x32x16_bf16 v[64:79], v[84:87], v[156:159], v[64:79]
    s_waitcnt vmcnt(21)
    s_waitcnt vmcnt(18)
    s_waitcnt vmcnt(15)
    s_waitcnt vmcnt(12)
    s_barrier
    ds_read_b64_tr_b16 v[16:17], v7 offset:49152
    ds_read_b64_tr_b16 v[18:19], v7 offset:50688
    ds_read_b64_tr_b16 v[20:21], v8 offset:49152
    ds_read_b64_tr_b16 v[22:23], v8 offset:50688
    ds_read_b64_tr_b16 v[24:25], v9 offset:49152
    ds_read_b64_tr_b16 v[26:27], v9 offset:50688
    ds_read_b64_tr_b16 v[28:29], v7 offset:55296
    ds_read_b64_tr_b16 v[30:31], v7 offset:56832
    ds_read_b64_tr_b16 v[80:81], v8 offset:55296
    ds_read_b64_tr_b16 v[82:83], v8 offset:56832
    ds_read_b64_tr_b16 v[84:85], v9 offset:55296
    ds_read_b64_tr_b16 v[86:87], v9 offset:56832
    s_add_u32 m0, s62, 139264
    s_add_u32 s66, s14, 0
    buffer_load_dwordx4 v93, s[36:39], s66 offen nt lds
    buffer_load_dwordx4 v94, s[36:39], s66 offen offset:1024 nt lds
    s_add_u32 m0, s62, 147456
    s_add_u32 s66, s14, 24576
    buffer_load_dwordx4 v93, s[36:39], s66 offen nt lds
    buffer_load_dwordx4 v94, s[36:39], s66 offen offset:1024 nt lds
    s_add_u32 s70, s7, 12
    s_sub_u32 s67, s70, 20
    s_cmp_ge_u32 s70, 20
    s_cselect_b32 s70, s67, s70
    s_mul_i32 s66, s70, 393216
    s_add_u32 s66, s66, s64
    s_add_u32 s66, s66, 384
    s_add_u32 m0, s60, 24576
    s_nop 0
    buffer_load_dwordx4 v4, s[40:43], s66 offen lds
    buffer_load_dwordx4 v5, s[40:43], s66 offen offset:1024 lds
    buffer_load_dwordx4 v6, s[40:43], s66 offen offset:2048 lds
    s_add_u32 s70, s7, 13
    s_sub_u32 s67, s70, 20
    s_cmp_ge_u32 s70, 20
    s_cselect_b32 s70, s67, s70
    s_mul_i32 s66, s70, 393216
    s_add_u32 s66, s66, s64
    s_add_u32 s66, s66, 384
    s_add_u32 m0, s60, 36864
    s_nop 0
    buffer_load_dwordx4 v4, s[40:43], s66 offen lds
    buffer_load_dwordx4 v5, s[40:43], s66 offen offset:1024 lds
    buffer_load_dwordx4 v6, s[40:43], s66 offen offset:2048 lds
    s_add_u32 m0, s62, 155648
    s_add_u32 s66, s14, 49152
    buffer_load_dwordx4 v93, s[36:39], s66 offen nt lds
    buffer_load_dwordx4 v94, s[36:39], s66 offen offset:1024 nt lds
    s_waitcnt lgkmcnt(10)
    v_mfma_f32_32x32x16_bf16 v[32:47], v[16:19], v[160:163], v[32:47]
    ds_read_b64_tr_b16 v[16:17], v12 offset:28672
    ds_read_b64_tr_b16 v[18:19], v12 offset:30208
    s_waitcnt lgkmcnt(10)
    v_mfma_f32_32x32x16_bf16 v[48:63], v[20:23], v[160:163], v[48:63]
    ds_read_b64_tr_b16 v[20:21], v13 offset:28672
    ds_read_b64_tr_b16 v[22:23], v13 offset:30208
    s_waitcnt lgkmcnt(10)
    v_mfma_f32_32x32x16_bf16 v[64:79], v[24:27], v[160:163], v[64:79]
    ds_read_b64_tr_b16 v[24:25], v14 offset:28672
    ds_read_b64_tr_b16 v[26:27], v14 offset:30208
    s_waitcnt lgkmcnt(10)
    v_mfma_f32_32x32x16_bf16 v[32:47], v[28:31], v[164:167], v[32:47]
    ds_read_b64_tr_b16 v[28:29], v12 offset:34816
    ds_read_b64_tr_b16 v[30:31], v12 offset:36352
    s_waitcnt lgkmcnt(10)
    v_mfma_f32_32x32x16_bf16 v[48:63], v[80:83], v[164:167], v[48:63]
    ds_read_b64_tr_b16 v[80:81], v13 offset:34816
    ds_read_b64_tr_b16 v[82:83], v13 offset:36352
    s_waitcnt lgkmcnt(10)
    v_mfma_f32_32x32x16_bf16 v[64:79], v[84:87], v[164:167], v[64:79]
    ds_read_b64_tr_b16 v[84:85], v14 offset:34816
    ds_read_b64_tr_b16 v[86:87], v14 offset:36352
    s_waitcnt lgkmcnt(10)
    v_mfma_f32_32x32x16_bf16 v[32:47], v[16:19], v[168:171], v[32:47]
    s_waitcnt lgkmcnt(8)
    v_mfma_f32_32x32x16_bf16 v[48:63], v[20:23], v[168:171], v[48:63]
    s_waitcnt lgkmcnt(6)
    v_mfma_f32_32x32x16_bf16 v[64:79], v[24:27], v[168:171], v[64:79]
    s_waitcnt lgkmcnt(4)
    v_mfma_f32_32x32x16_bf16 v[32:47], v[28:31], v[172:175], v[32:47]
    s_waitcnt lgkmcnt(2)
    v_mfma_f32_32x32x16_bf16 v[48:63], v[80:83], v[172:175], v[48:63]
    s_waitcnt lgkmcnt(0)
    v_mfma_f32_32x32x16_bf16 v[64:79], v[84:87], v[172:175], v[64:79]
    s_waitcnt vmcnt(21)
    s_waitcnt vmcnt(18)
    s_waitcnt vmcnt(15)
    s_waitcnt vmcnt(12)
    s_barrier
    ds_read_b64_tr_b16 v[16:17], v7 offset:0
    ds_read_b64_tr_b16 v[18:19], v7 offset:1536
    ds_read_b64_tr_b16 v[20:21], v8 offset:0
    ds_read_b64_tr_b16 v[22:23], v8 offset:1536
    ds_read_b64_tr_b16 v[24:25], v9 offset:0
    ds_read_b64_tr_b16 v[26:27], v9 offset:1536
    ds_read_b64_tr_b16 v[28:29], v7 offset:6144
    ds_read_b64_tr_b16 v[30:31], v7 offset:7680
    ds_read_b64_tr_b16 v[80:81], v8 offset:6144
    ds_read_b64_tr_b16 v[82:83], v8 offset:7680
    ds_read_b64_tr_b16 v[84:85], v9 offset:6144
    ds_read_b64_tr_b16 v[86:87], v9 offset:7680
    s_add_u32 m0, s62, 90112
    s_add_u32 s66, s14, 73728
    buffer_load_dwordx4 v93, s[36:39], s66 offen nt lds
    buffer_load_dwordx4 v94, s[36:39], s66 offen offset:1024 nt lds
    s_add_u32 s70, s7, 14
    s_sub_u32 s67, s70, 20
    s_cmp_ge_u32 s70, 20
    s_cselect_b32 s70, s67, s70
    s_mul_i32 s66, s70, 393216
    s_add_u32 s66, s66, s64
    s_add_u32 s66, s66, 384
    s_add_u32 m0, s60, 49152
    s_nop 0
    buffer_load_dwordx4 v4, s[40:43], s66 offen lds
    buffer_load_dwordx4 v5, s[40:43], s66 offen offset:1024 lds
    buffer_load_dwordx4 v6, s[40:43], s66 offen offset:2048 lds
    s_add_u32 s70, s7, 15
    s_sub_u32 s67, s70, 20
    s_cmp_ge_u32 s70, 20
    s_cselect_b32 s70, s67, s70
    s_mul_i32 s66, s70, 393216
    s_add_u32 s66, s66, s64
    s_add_u32 s66, s66, 384
    s_add_u32 m0, s60, 61440
    s_nop 0
    buffer_load_dwordx4 v4, s[40:43], s66 offen lds
    buffer_load_dwordx4 v5, s[40:43], s66 offen offset:1024 lds
    buffer_load_dwordx4 v6, s[40:43], s66 offen offset:2048 lds
    s_add_u32 m0, s62, 98304
    s_add_u32 s66, s14, 98304
    buffer_load_dwordx4 v93, s[36:39], s66 offen nt lds
    buffer_load_dwordx4 v94, s[36:39], s66 offen offset:1024 nt lds
    s_add_u32 m0, s62, 106496
    s_add_u32 s66, s14, 122880
    buffer_load_dwordx4 v93, s[36:39], s66 offen nt lds
    buffer_load_dwordx4 v94, s[36:39], s66 offen offset:1024 nt lds
    s_waitcnt lgkmcnt(10)
    v_mfma_f32_32x32x16_bf16 v[32:47], v[16:19], v[176:179], v[32:47]
    ds_read_b64_tr_b16 v[16:17], v7 offset:12288
    ds_read_b64_tr_b16 v[18:19], v7 offset:13824
    s_waitcnt lgkmcnt(10)
    v_mfma_f32_32x32x16_bf16 v[48:63], v[20:23], v[176:179], v[48:63]
    ds_read_b64_tr_b16 v[20:21], v8 offset:12288
    ds_read_b64_tr_b16 v[22:23], v8 offset:13824
    s_waitcnt lgkmcnt(10)
    v_mfma_f32_32x32x16_bf16 v[64:79], v[24:27], v[176:179], v[64:79]
    ds_read_b64_tr_b16 v[24:25], v9 offset:12288
    ds_read_b64_tr_b16 v[26:27], v9 offset:13824
    s_waitcnt lgkmcnt(10)
    v_mfma_f32_32x32x16_bf16 v[32:47], v[28:31], v[180:183], v[32:47]
    ds_read_b64_tr_b16 v[28:29], v7 offset:18432
    ds_read_b64_tr_b16 v[30:31], v7 offset:19968
    s_waitcnt lgkmcnt(10)
    v_mfma_f32_32x32x16_bf16 v[48:63], v[80:83], v[180:183], v[48:63]
    ds_read_b64_tr_b16 v[80:81], v8 offset:18432
    ds_read_b64_tr_b16 v[82:83], v8 offset:19968
    s_waitcnt lgkmcnt(10)
    v_mfma_f32_32x32x16_bf16 v[64:79], v[84:87], v[180:183], v[64:79]
    ds_read_b64_tr_b16 v[84:85], v9 offset:18432
    ds_read_b64_tr_b16 v[86:87], v9 offset:19968
    s_waitcnt lgkmcnt(10)
    v_mfma_f32_32x32x16_bf16 v[32:47], v[16:19], v[184:187], v[32:47]
    s_waitcnt lgkmcnt(8)
    v_mfma_f32_32x32x16_bf16 v[48:63], v[20:23], v[184:187], v[48:63]
    s_waitcnt lgkmcnt(6)
    v_mfma_f32_32x32x16_bf16 v[64:79], v[24:27], v[184:187], v[64:79]
    s_waitcnt lgkmcnt(4)
    v_mfma_f32_32x32x16_bf16 v[32:47], v[28:31], v[188:191], v[32:47]
    s_waitcnt lgkmcnt(2)
    v_mfma_f32_32x32x16_bf16 v[48:63], v[80:83], v[188:191], v[48:63]
    s_waitcnt lgkmcnt(0)
    v_mfma_f32_32x32x16_bf16 v[64:79], v[84:87], v[188:191], v[64:79]
    s_waitcnt vmcnt(22)
    s_waitcnt vmcnt(20)
    s_waitcnt vmcnt(17)
    s_waitcnt vmcnt(14)
    s_barrier
    ds_read_b64_tr_b16 v[16:17], v7 offset:24576
    ds_read_b64_tr_b16 v[18:19], v7 offset:26112
    ds_read_b64_tr_b16 v[20:21], v8 offset:24576
    ds_read_b64_tr_b16 v[22:23], v8 offset:26112
    ds_read_b64_tr_b16 v[24:25], v9 offset:24576
    ds_read_b64_tr_b16 v[26:27], v9 offset:26112
    ds_read_b64_tr_b16 v[28:29], v7 offset:30720
    ds_read_b64_tr_b16 v[30:31], v7 offset:32256
    ds_read_b64_tr_b16 v[80:81], v8 offset:30720
    ds_read_b64_tr_b16 v[82:83], v8 offset:32256
    ds_read_b64_tr_b16 v[84:85], v9 offset:30720
    ds_read_b64_tr_b16 v[86:87], v9 offset:32256
    s_add_u32 s70, s7, 16
    s_sub_u32 s67, s70, 20
    s_cmp_ge_u32 s70, 20
    s_cselect_b32 s70, s67, s70
    s_mul_i32 s66, s70, 393216
    s_add_u32 s66, s66, s64
    s_add_u32 s66, s66, 384
    s_add_u32 m0, s60, 0
    s_nop 0
    buffer_load_dwordx4 v4, s[40:43], s66 offen lds
    buffer_load_dwordx4 v5, s[40:43], s66 offen offset:1024 lds
    buffer_load_dwordx4 v6, s[40:43], s66 offen offset:2048 lds
    s_add_u32 s70, s7, 17
    s_sub_u32 s67, s70, 20
    s_cmp_ge_u32 s70, 20
    s_cselect_b32 s70, s67, s70
    s_mul_i32 s66, s70, 393216
    s_add_u32 s66, s66, s64
    s_add_u32 s66, s66, 384
    s_add_u32 m0, s60, 12288
    s_nop 0
    buffer_load_dwordx4 v4, s[40:43], s66 offen lds
    buffer_load_dwordx4 v5, s[40:43], s66 offen offset:1024 lds
    buffer_load_dwordx4 v6, s[40:43], s66 offen offset:2048 lds
    s_add_u32 m0, s62, 114688
    s_add_u32 s66, s14, 147456
    buffer_load_dwordx4 v93, s[36:39], s66 offen nt lds
    buffer_load_dwordx4 v94, s[36:39], s66 offen offset:1024 nt lds
    s_add_u32 m0, s62, 122880
    s_add_u32 s66, s14, 172032
    buffer_load_dwordx4 v93, s[36:39], s66 offen nt lds
    buffer_load_dwordx4 v94, s[36:39], s66 offen offset:1024 nt lds
    s_add_u32 m0, s62, 131072
    s_add_u32 s66, s15, 0
    buffer_load_dwordx4 v93, s[36:39], s66 offen nt lds
    buffer_load_dwordx4 v94, s[36:39], s66 offen offset:1024 nt lds
    s_waitcnt lgkmcnt(10)
    v_mfma_f32_32x32x16_bf16 v[32:47], v[16:19], v[192:195], v[32:47]
    ds_read_b64_tr_b16 v[16:17], v7 offset:36864
    ds_read_b64_tr_b16 v[18:19], v7 offset:38400
    s_waitcnt lgkmcnt(10)
    v_mfma_f32_32x32x16_bf16 v[48:63], v[20:23], v[192:195], v[48:63]
    ds_read_b64_tr_b16 v[20:21], v8 offset:36864
    ds_read_b64_tr_b16 v[22:23], v8 offset:38400
    s_waitcnt lgkmcnt(10)
    v_mfma_f32_32x32x16_bf16 v[64:79], v[24:27], v[192:195], v[64:79]
    ds_read_b64_tr_b16 v[24:25], v9 offset:36864
    ds_read_b64_tr_b16 v[26:27], v9 offset:38400
    s_waitcnt lgkmcnt(10)
    v_mfma_f32_32x32x16_bf16 v[32:47], v[28:31], v[196:199], v[32:47]
    ds_read_b64_tr_b16 v[28:29], v7 offset:43008
    ds_read_b64_tr_b16 v[30:31], v7 offset:44544
    s_waitcnt lgkmcnt(10)
    v_mfma_f32_32x32x16_bf16 v[48:63], v[80:83], v[196:199], v[48:63]
    ds_read_b64_tr_b16 v[80:81], v8 offset:43008
    ds_read_b64_tr_b16 v[82:83], v8 offset:44544
    s_waitcnt lgkmcnt(10)
    v_mfma_f32_32x32x16_bf16 v[64:79], v[84:87], v[196:199], v[64:79]
    ds_read_b64_tr_b16 v[84:85], v9 offset:43008
    ds_read_b64_tr_b16 v[86:87], v9 offset:44544
    s_waitcnt lgkmcnt(10)
    v_mfma_f32_32x32x16_bf16 v[32:47], v[16:19], v[200:203], v[32:47]
    s_waitcnt lgkmcnt(8)
    v_mfma_f32_32x32x16_bf16 v[48:63], v[20:23], v[200:203], v[48:63]
    s_waitcnt lgkmcnt(6)
    v_mfma_f32_32x32x16_bf16 v[64:79], v[24:27], v[200:203], v[64:79]
    s_waitcnt lgkmcnt(4)
    v_mfma_f32_32x32x16_bf16 v[32:47], v[28:31], v[204:207], v[32:47]
    s_waitcnt lgkmcnt(2)
    v_mfma_f32_32x32x16_bf16 v[48:63], v[80:83], v[204:207], v[48:63]
    s_waitcnt lgkmcnt(0)
    v_mfma_f32_32x32x16_bf16 v[64:79], v[84:87], v[204:207], v[64:79]
    s_waitcnt vmcnt(24)
    s_waitcnt vmcnt(22)
    s_waitcnt vmcnt(19)
    s_waitcnt vmcnt(16)
    s_barrier
    ds_read_b64_tr_b16 v[16:17], v7 offset:49152
    ds_read_b64_tr_b16 v[18:19], v7 offset:50688
    ds_read_b64_tr_b16 v[20:21], v8 offset:49152
    ds_read_b64_tr_b16 v[22:23], v8 offset:50688
    ds_read_b64_tr_b16 v[24:25], v9 offset:49152
    ds_read_b64_tr_b16 v[26:27], v9 offset:50688
    ds_read_b64_tr_b16 v[28:29], v7 offset:55296
    ds_read_b64_tr_b16 v[30:31], v7 offset:56832
    ds_read_b64_tr_b16 v[80:81], v8 offset:55296
    ds_read_b64_tr_b16 v[82:83], v8 offset:56832
    ds_read_b64_tr_b16 v[84:85], v9 offset:55296
    ds_read_b64_tr_b16 v[86:87], v9 offset:56832
    s_add_u32 s70, s7, 18
    s_sub_u32 s67, s70, 20
    s_cmp_ge_u32 s70, 20
    s_cselect_b32 s70, s67, s70
    s_mul_i32 s66, s70, 393216
    s_add_u32 s66, s66, s64
    s_add_u32 s66, s66, 384
    s_add_u32 m0, s60, 24576
    s_nop 0
    buffer_load_dwordx4 v4, s[40:43], s66 offen lds
    buffer_load_dwordx4 v5, s[40:43], s66 offen offset:1024 lds
    buffer_load_dwordx4 v6, s[40:43], s66 offen offset:2048 lds
    s_add_u32 s70, s7, 19
    s_sub_u32 s67, s70, 20
    s_cmp_ge_u32 s70, 20
    s_cselect_b32 s70, s67, s70
    s_mul_i32 s66, s70, 393216
    s_add_u32 s66, s66, s64
    s_add_u32 s66, s66, 384
    s_add_u32 m0, s60, 36864
    s_nop 0
    buffer_load_dwordx4 v4, s[40:43], s66 offen lds
    buffer_load_dwordx4 v5, s[40:43], s66 offen offset:1024 lds
    buffer_load_dwordx4 v6, s[40:43], s66 offen offset:2048 lds
    s_add_u32 m0, s62, 139264
    s_add_u32 s66, s15, 24576
    buffer_load_dwordx4 v93, s[36:39], s66 offen nt lds
    buffer_load_dwordx4 v94, s[36:39], s66 offen offset:1024 nt lds
    s_add_u32 m0, s62, 147456
    s_add_u32 s66, s15, 49152
    buffer_load_dwordx4 v93, s[36:39], s66 offen nt lds
    buffer_load_dwordx4 v94, s[36:39], s66 offen offset:1024 nt lds
    s_waitcnt lgkmcnt(10)
    v_mfma_f32_32x32x16_bf16 v[32:47], v[16:19], v[208:211], v[32:47]
    ds_read_b64_tr_b16 v[16:17], v12 offset:28672
    ds_read_b64_tr_b16 v[18:19], v12 offset:30208
    s_waitcnt lgkmcnt(10)
    v_mfma_f32_32x32x16_bf16 v[48:63], v[20:23], v[208:211], v[48:63]
    ds_read_b64_tr_b16 v[20:21], v13 offset:28672
    ds_read_b64_tr_b16 v[22:23], v13 offset:30208
    s_waitcnt lgkmcnt(10)
    v_mfma_f32_32x32x16_bf16 v[64:79], v[24:27], v[208:211], v[64:79]
    ds_read_b64_tr_b16 v[24:25], v14 offset:28672
    ds_read_b64_tr_b16 v[26:27], v14 offset:30208
    s_waitcnt lgkmcnt(10)
    v_mfma_f32_32x32x16_bf16 v[32:47], v[28:31], v[212:215], v[32:47]
    ds_read_b64_tr_b16 v[28:29], v12 offset:34816
    ds_read_b64_tr_b16 v[30:31], v12 offset:36352
    s_waitcnt lgkmcnt(10)
    v_mfma_f32_32x32x16_bf16 v[48:63], v[80:83], v[212:215], v[48:63]
    ds_read_b64_tr_b16 v[80:81], v13 offset:34816
    ds_read_b64_tr_b16 v[82:83], v13 offset:36352
    s_waitcnt lgkmcnt(10)
    v_mfma_f32_32x32x16_bf16 v[64:79], v[84:87], v[212:215], v[64:79]
    ds_read_b64_tr_b16 v[84:85], v14 offset:34816
    ds_read_b64_tr_b16 v[86:87], v14 offset:36352
    s_waitcnt lgkmcnt(10)
    v_mfma_f32_32x32x16_bf16 v[32:47], v[16:19], v[216:219], v[32:47]
    s_waitcnt lgkmcnt(8)
    v_mfma_f32_32x32x16_bf16 v[48:63], v[20:23], v[216:219], v[48:63]
    s_waitcnt lgkmcnt(6)
    v_mfma_f32_32x32x16_bf16 v[64:79], v[24:27], v[216:219], v[64:79]
    s_waitcnt lgkmcnt(4)
    v_mfma_f32_32x32x16_bf16 v[32:47], v[28:31], v[220:223], v[32:47]
    s_waitcnt lgkmcnt(2)
    v_mfma_f32_32x32x16_bf16 v[48:63], v[80:83], v[220:223], v[48:63]
    s_waitcnt lgkmcnt(0)
    v_mfma_f32_32x32x16_bf16 v[64:79], v[84:87], v[220:223], v[64:79]
    s_waitcnt vmcnt(24)
    s_waitcnt vmcnt(22)
    s_waitcnt vmcnt(19)
    s_waitcnt vmcnt(16)
    s_barrier
    ds_read_b64_tr_b16 v[16:17], v7 offset:0
    ds_read_b64_tr_b16 v[18:19], v7 offset:1536
    ds_read_b64_tr_b16 v[20:21], v8 offset:0
    ds_read_b64_tr_b16 v[22:23], v8 offset:1536
    ds_read_b64_tr_b16 v[24:25], v9 offset:0
    ds_read_b64_tr_b16 v[26:27], v9 offset:1536
    ds_read_b64_tr_b16 v[28:29], v7 offset:6144
    ds_read_b64_tr_b16 v[30:31], v7 offset:7680
    ds_read_b64_tr_b16 v[80:81], v8 offset:6144
    ds_read_b64_tr_b16 v[82:83], v8 offset:7680
    ds_read_b64_tr_b16 v[84:85], v9 offset:6144
    ds_read_b64_tr_b16 v[86:87], v9 offset:7680
    s_add_u32 m0, s62, 155648
    s_add_u32 s66, s15, 73728
    buffer_load_dwordx4 v93, s[36:39], s66 offen nt lds
    buffer_load_dwordx4 v94, s[36:39], s66 offen offset:1024 nt lds
    s_add_u32 m0, s62, 90112
    s_add_u32 s66, s15, 98304
    buffer_load_dwordx4 v93, s[36:39], s66 offen nt lds
    buffer_load_dwordx4 v94, s[36:39], s66 offen offset:1024 nt lds
    s_waitcnt lgkmcnt(10)
    v_mfma_f32_32x32x16_bf16 v[32:47], v[16:19], v[224:227], v[32:47]
    ds_read_b64_tr_b16 v[16:17], v7 offset:12288
    ds_read_b64_tr_b16 v[18:19], v7 offset:13824
    s_waitcnt lgkmcnt(10)
    v_mfma_f32_32x32x16_bf16 v[48:63], v[20:23], v[224:227], v[48:63]
    ds_read_b64_tr_b16 v[20:21], v8 offset:12288
    ds_read_b64_tr_b16 v[22:23], v8 offset:13824
    s_waitcnt lgkmcnt(10)
    v_mfma_f32_32x32x16_bf16 v[64:79], v[24:27], v[224:227], v[64:79]
    ds_read_b64_tr_b16 v[24:25], v9 offset:12288
    ds_read_b64_tr_b16 v[26:27], v9 offset:13824
    s_waitcnt lgkmcnt(10)
    v_mfma_f32_32x32x16_bf16 v[32:47], v[28:31], v[228:231], v[32:47]
    ds_read_b64_tr_b16 v[28:29], v7 offset:18432
    ds_read_b64_tr_b16 v[30:31], v7 offset:19968
    s_waitcnt lgkmcnt(10)
    v_mfma_f32_32x32x16_bf16 v[48:63], v[80:83], v[228:231], v[48:63]
    ds_read_b64_tr_b16 v[80:81], v8 offset:18432
    ds_read_b64_tr_b16 v[82:83], v8 offset:19968
    s_waitcnt lgkmcnt(10)
    v_mfma_f32_32x32x16_bf16 v[64:79], v[84:87], v[228:231], v[64:79]
    ds_read_b64_tr_b16 v[84:85], v9 offset:18432
    ds_read_b64_tr_b16 v[86:87], v9 offset:19968
    s_waitcnt lgkmcnt(10)
    v_mfma_f32_32x32x16_bf16 v[32:47], v[16:19], v[232:235], v[32:47]
    s_waitcnt lgkmcnt(8)
    v_mfma_f32_32x32x16_bf16 v[48:63], v[20:23], v[232:235], v[48:63]
    s_waitcnt lgkmcnt(6)
    v_mfma_f32_32x32x16_bf16 v[64:79], v[24:27], v[232:235], v[64:79]
    s_waitcnt lgkmcnt(4)
    v_mfma_f32_32x32x16_bf16 v[32:47], v[28:31], v[236:239], v[32:47]
    s_waitcnt lgkmcnt(2)
    v_mfma_f32_32x32x16_bf16 v[48:63], v[80:83], v[236:239], v[48:63]
    s_waitcnt lgkmcnt(0)
    v_mfma_f32_32x32x16_bf16 v[64:79], v[84:87], v[236:239], v[64:79]
    s_waitcnt vmcnt(18)
    s_waitcnt vmcnt(16)
    s_waitcnt vmcnt(11)
    s_waitcnt vmcnt(8)
    s_barrier
    ds_read_b64_tr_b16 v[16:17], v7 offset:24576
    ds_read_b64_tr_b16 v[18:19], v7 offset:26112
    ds_read_b64_tr_b16 v[20:21], v8 offset:24576
    ds_read_b64_tr_b16 v[22:23], v8 offset:26112
    ds_read_b64_tr_b16 v[24:25], v9 offset:24576
    ds_read_b64_tr_b16 v[26:27], v9 offset:26112
    ds_read_b64_tr_b16 v[28:29], v7 offset:30720
    ds_read_b64_tr_b16 v[30:31], v7 offset:32256
    ds_read_b64_tr_b16 v[80:81], v8 offset:30720
    ds_read_b64_tr_b16 v[82:83], v8 offset:32256
    ds_read_b64_tr_b16 v[84:85], v9 offset:30720
    ds_read_b64_tr_b16 v[86:87], v9 offset:32256
    s_add_u32 m0, s62, 98304
    s_add_u32 s66, s15, 122880
    buffer_load_dwordx4 v93, s[36:39], s66 offen nt lds
    buffer_load_dwordx4 v94, s[36:39], s66 offen offset:1024 nt lds
    s_add_u32 m0, s63, 0
    s_add_u32 s66, s13, 0
    s_and_b32 s66, s66, 3
    s_mul_i32 s66, s66, 20480
    s_mul_i32 s67, s14, 640
    s_add_u32 s66, s66, s67
    buffer_load_dwordx4 v1, s[48:51], s66 offen lds
    buffer_load_dwordx4 v2, s[48:51], s66 offen offset:1024 lds
    buffer_load_dwordx4 v3, s[48:51], s66 offen offset:2048 lds
    buffer_load_dwordx4 v88, s[48:51], s66 offen offset:3072 lds
    s_add_u32 m0, s63, 4096
    s_nop 0
    buffer_load_dwordx4 v89, s[48:51], s66 offen lds
    s_add_u32 m0, s62, 106496
    s_add_u32 s66, s15, 147456
    buffer_load_dwordx4 v93, s[36:39], s66 offen nt lds
    buffer_load_dwordx4 v94, s[36:39], s66 offen offset:1024 nt lds
    s_waitcnt lgkmcnt(10)
    v_mfma_f32_32x32x16_bf16 v[32:47], v[16:19], v[240:243], v[32:47]
    ds_read_b64_tr_b16 v[16:17], v7 offset:36864
    ds_read_b64_tr_b16 v[18:19], v7 offset:38400
    s_waitcnt lgkmcnt(10)
    v_mfma_f32_32x32x16_bf16 v[48:63], v[20:23], v[240:243], v[48:63]
    ds_read_b64_tr_b16 v[20:21], v8 offset:36864
    ds_read_b64_tr_b16 v[22:23], v8 offset:38400
    s_waitcnt lgkmcnt(10)
    v_mfma_f32_32x32x16_bf16 v[64:79], v[24:27], v[240:243], v[64:79]
    ds_read_b64_tr_b16 v[24:25], v9 offset:36864
    ds_read_b64_tr_b16 v[26:27], v9 offset:38400
    s_waitcnt lgkmcnt(10)
    v_mfma_f32_32x32x16_bf16 v[32:47], v[28:31], v[244:247], v[32:47]
    ds_read_b64_tr_b16 v[28:29], v7 offset:43008
    ds_read_b64_tr_b16 v[30:31], v7 offset:44544
    s_waitcnt lgkmcnt(10)
    v_mfma_f32_32x32x16_bf16 v[48:63], v[80:83], v[244:247], v[48:63]
    ds_read_b64_tr_b16 v[80:81], v8 offset:43008
    ds_read_b64_tr_b16 v[82:83], v8 offset:44544
    s_waitcnt lgkmcnt(10)
    v_mfma_f32_32x32x16_bf16 v[64:79], v[84:87], v[244:247], v[64:79]
    ds_read_b64_tr_b16 v[84:85], v9 offset:43008
    ds_read_b64_tr_b16 v[86:87], v9 offset:44544
    s_waitcnt lgkmcnt(10)
    v_mfma_f32_32x32x16_bf16 v[32:47], v[16:19], v[248:251], v[32:47]
    s_waitcnt lgkmcnt(8)
    v_mfma_f32_32x32x16_bf16 v[48:63], v[20:23], v[248:251], v[48:63]
    s_waitcnt lgkmcnt(6)
    v_mfma_f32_32x32x16_bf16 v[64:79], v[24:27], v[248:251], v[64:79]
    s_waitcnt lgkmcnt(4)
    v_mfma_f32_32x32x16_bf16 v[32:47], v[28:31], v[252:255], v[32:47]
    s_waitcnt lgkmcnt(2)
    v_mfma_f32_32x32x16_bf16 v[48:63], v[80:83], v[252:255], v[48:63]
    s_waitcnt lgkmcnt(0)
    v_mfma_f32_32x32x16_bf16 v[64:79], v[84:87], v[252:255], v[64:79]
    s_waitcnt vmcnt(15)
    s_barrier
    s_and_b32 s66, s4, 1
    s_lshl_b32 s67, s66, 5
    v_and_b32 v12, 31, v0
    v_add_u32 v12, s67, v12
    v_bfe_u32 v13, v12, 1, 3
    v_mul_u32_u24 v12, 384, v12
    v_lshrrev_b32 v14, 5, v0
    v_lshlrev_b32 v14, 3, v14
    v_add_u32 v12, v12, v14
    v_add_u32 v12, 57344, v12
    v_cvt_pk_bf16_f32 v32, v32, v33
    v_cvt_pk_bf16_f32 v33, v34, v35
    s_add_u32 s66, s72, 0
    v_xor_b32 v14, s66, v13
    v_lshl_add_u32 v14, v14, 4, v12
    ds_write_b64 v14, v[32:33] offset:0
    v_cvt_pk_bf16_f32 v36, v36, v37
    v_cvt_pk_bf16_f32 v37, v38, v39
    s_add_u32 s66, s72, 1
    v_xor_b32 v15, s66, v13
    v_lshl_add_u32 v15, v15, 4, v12
    ds_write_b64 v15, v[36:37] offset:0
    v_cvt_pk_bf16_f32 v40, v40, v41
    v_cvt_pk_bf16_f32 v41, v42, v43
    s_add_u32 s66, s72, 2
    v_xor_b32 v14, s66, v13
    v_lshl_add_u32 v14, v14, 4, v12
    ds_write_b64 v14, v[40:41] offset:0
    v_cvt_pk_bf16_f32 v44, v44, v45
    v_cvt_pk_bf16_f32 v45, v46, v47
    s_add_u32 s66, s72, 3
    v_xor_b32 v15, s66, v13
    v_lshl_add_u32 v15, v15, 4, v12
    ds_write_b64 v15, v[44:45] offset:0
    v_cvt_pk_bf16_f32 v48, v48, v49
    v_cvt_pk_bf16_f32 v49, v50, v51
    s_add_u32 s66, s72, 4
    v_xor_b32 v14, s66, v13
    v_lshl_add_u32 v14, v14, 4, v12
    ds_write_b64 v14, v[48:49] offset:0
    v_cvt_pk_bf16_f32 v52, v52, v53
    v_cvt_pk_bf16_f32 v53, v54, v55
    s_add_u32 s66, s72, 5
    v_xor_b32 v15, s66, v13
    v_lshl_add_u32 v15, v15, 4, v12
    ds_write_b64 v15, v[52:53] offset:0
    v_cvt_pk_bf16_f32 v56, v56, v57
    v_cvt_pk_bf16_f32 v57, v58, v59
    s_add_u32 s66, s72, 6
    v_xor_b32 v14, s66, v13
    v_lshl_add_u32 v14, v14, 4, v12
    ds_write_b64 v14, v[56:57] offset:0
    v_cvt_pk_bf16_f32 v60, v60, v61
    v_cvt_pk_bf16_f32 v61, v62, v63
    s_add_u32 s66, s72, 7
    v_xor_b32 v15, s66, v13
    v_lshl_add_u32 v15, v15, 4, v12
    ds_write_b64 v15, v[60:61] offset:0
    v_cvt_pk_bf16_f32 v64, v64, v65
    v_cvt_pk_bf16_f32 v65, v66, v67
    s_add_u32 s66, s72, 8
    v_xor_b32 v14, s66, v13
    v_lshl_add_u32 v14, v14, 4, v12
    ds_write_b64 v14, v[64:65] offset:0
    v_cvt_pk_bf16_f32 v68, v68, v69
    v_cvt_pk_bf16_f32 v69, v70, v71
    s_add_u32 s66, s72, 9
    v_xor_b32 v15, s66, v13
    v_lshl_add_u32 v15, v15, 4, v12
    ds_write_b64 v15, v[68:69] offset:0
    v_cvt_pk_bf16_f32 v72, v72, v73
    v_cvt_pk_bf16_f32 v73, v74, v75
    s_add_u32 s66, s72, 10
    v_xor_b32 v14, s66, v13
    v_lshl_add_u32 v14, v14, 4, v12
    ds_write_b64 v14, v[72:73] offset:0
    v_cvt_pk_bf16_f32 v76, v76, v77
    v_cvt_pk_bf16_f32 v77, v78, v79
    s_add_u32 s66, s72, 11
    v_xor_b32 v15, s66, v13
    v_lshl_add_u32 v15, v15, 4, v12
    ds_write_b64 v15, v[76:77] offset:0
    s_add_u32 m0, s62, 114688
    s_add_u32 s66, s15, 172032
    buffer_load_dwordx4 v93, s[36:39], s66 offen nt lds
    buffer_load_dwordx4 v94, s[36:39], s66 offen offset:1024 nt lds
    s_add_u32 m0, s63, 20480
    s_add_u32 s66, s13, 1
    s_and_b32 s66, s66, 3
    s_mul_i32 s66, s66, 20480
    s_mul_i32 s67, s14, 640
    s_add_u32 s66, s66, s67
    buffer_load_dwordx4 v1, s[48:51], s66 offen lds
    buffer_load_dwordx4 v2, s[48:51], s66 offen offset:1024 lds
    buffer_load_dwordx4 v3, s[48:51], s66 offen offset:2048 lds
    buffer_load_dwordx4 v88, s[48:51], s66 offen offset:3072 lds
    s_add_u32 m0, s63, 24576
    s_nop 0
    buffer_load_dwordx4 v89, s[48:51], s66 offen lds
    s_add_u32 m0, s62, 122880
    s_add_u32 s66, s98, 0
    buffer_load_dwordx4 v93, s[36:39], s66 offen nt lds
    buffer_load_dwordx4 v94, s[36:39], s66 offen offset:1024 nt lds
    s_waitcnt vmcnt(22)
    s_waitcnt vmcnt(20)
    s_waitcnt lgkmcnt(0)
    s_barrier
    v_lshrrev_b32 v20, 5, v0
    v_lshlrev_b32 v20, 3, v20
    v_bfe_u32 v21, v0, 2, 2
    v_add_u32 v20, v20, v21
    v_mul_u32_u24 v20, 1280, v20
    v_bfe_u32 v22, v0, 1, 1
    v_lshlrev_b32 v22, 3, v22
    v_add_u32 v20, v20, v22
    v_bfe_u32 v22, v0, 4, 1
    v_lshlrev_b32 v22, 1, v22
    v_and_b32 v23, 1, v0
    v_add_u32 v22, v22, v23
    v_lshl_add_u32 v20, v22, 4, v20
    s_lshr_b32 s66, s4, 1
    s_mul_i32 s66, s66, 10
    s_add_u32 s67, s66, 0
    v_xor_b32 v22, s67, v21
    v_lshl_add_u32 v6, v22, 6, v20
    s_add_u32 s67, s66, 1
    v_xor_b32 v22, s67, v21
    v_lshl_add_u32 v7, v22, 6, v20
    s_add_u32 s67, s66, 2
    v_xor_b32 v22, s67, v21
    v_lshl_add_u32 v8, v22, 6, v20
    s_add_u32 s67, s66, 3
    v_xor_b32 v22, s67, v21
    v_lshl_add_u32 v9, v22, 6, v20
    s_and_b32 s66, s4, 1
    s_lshl_b32 s67, s66, 5
    v_and_b32 v20, 31, v0
    v_add_u32 v20, s67, v20
    v_bfe_u32 v21, v20, 1, 3
    v_lshlrev_b32 v20, 7, v20
    v_add_u32 v20, 81920, v20
    v_lshrrev_b32 v22, 5, v0
    s_add_u32 s66, s13, 0
    s_and_b32 s66, s66, 3
    s_lshl_b32 s66, s66, 1
    v_add_u32 v23, s66, v22
    v_xor_b32 v23, v23, v21
    v_lshl_add_u32 v10, v23, 4, v20
    s_add_u32 s66, s13, 1
    s_and_b32 s66, s66, 3
    s_lshl_b32 s66, s66, 1
    v_add_u32 v23, s66, v22
    v_xor_b32 v23, v23, v21
    v_lshl_add_u32 v11, v23, 4, v20
    s_add_u32 s66, s13, 2
    s_and_b32 s66, s66, 3
    s_lshl_b32 s66, s66, 1
    v_add_u32 v23, s66, v22
    v_xor_b32 v23, v23, v21
    v_lshl_add_u32 v12, v23, 4, v20
    s_add_u32 s66, s13, 3
    s_and_b32 s66, s66, 3
    s_lshl_b32 s66, s66, 1
    v_add_u32 v23, s66, v22
    v_xor_b32 v23, v23, v21
    v_lshl_add_u32 v13, v23, 4, v20
    s_add_u32 m0, s62, 131072
    s_add_u32 s66, s98, 24576
    buffer_load_dwordx4 v93, s[36:39], s66 offen nt lds
    buffer_load_dwordx4 v94, s[36:39], s66 offen offset:1024 nt lds
    s_add_u32 m0, s62, 139264
    s_add_u32 s66, s98, 49152
    buffer_load_dwordx4 v93, s[36:39], s66 offen nt lds
    buffer_load_dwordx4 v94, s[36:39], s66 offen offset:1024 nt lds
    s_waitcnt vmcnt(22)
    s_waitcnt vmcnt(20)
    s_waitcnt vmcnt(15)
    s_barrier
    ds_read_b128 v[32:35], v10 offset:0
    ds_read_b128 v[36:39], v11 offset:0
    ds_read_b128 v[40:43], v12 offset:0
    ds_read_b128 v[44:47], v13 offset:0
    ds_read_b64_tr_b16 v[48:49], v6 offset:0
    ds_read_b64_tr_b16 v[50:51], v6 offset:5120
    ds_read_b64_tr_b16 v[52:53], v7 offset:0
    ds_read_b64_tr_b16 v[54:55], v7 offset:5120
    ds_read_b64_tr_b16 v[56:57], v8 offset:0
    ds_read_b64_tr_b16 v[58:59], v8 offset:5120
    ds_read_b64_tr_b16 v[60:61], v9 offset:0
    ds_read_b64_tr_b16 v[62:63], v9 offset:5120
    ds_read_b64_tr_b16 v[64:65], v6 offset:256
    ds_read_b64_tr_b16 v[66:67], v6 offset:5376
    ds_read_b64_tr_b16 v[68:69], v7 offset:256
    s_waitcnt lgkmcnt(14)
    ds_read_b64_tr_b16 v[70:71], v7 offset:5376
    s_waitcnt lgkmcnt(14)
    ds_read_b64_tr_b16 v[72:73], v8 offset:256
    s_waitcnt lgkmcnt(14)
    ds_read_b64_tr_b16 v[74:75], v8 offset:5376
    s_waitcnt lgkmcnt(14)
    ds_read_b64_tr_b16 v[76:77], v9 offset:256
    s_waitcnt lgkmcnt(14)
    ds_read_b64_tr_b16 v[78:79], v9 offset:5376
    s_waitcnt lgkmcnt(14)
    ds_read_b64_tr_b16 v[80:81], v6 offset:512
    s_waitcnt lgkmcnt(14)
    ds_read_b64_tr_b16 v[82:83], v6 offset:5632
    s_waitcnt lgkmcnt(14)
    ds_read_b64_tr_b16 v[84:85], v7 offset:512
    s_waitcnt lgkmcnt(14)
    ds_read_b64_tr_b16 v[86:87], v7 offset:5632
    s_add_u32 m0, s63, 40960
    s_add_u32 s66, s13, 2
    s_and_b32 s66, s66, 3
    s_mul_i32 s66, s66, 20480
    s_mul_i32 s67, s14, 640
    s_add_u32 s66, s66, s67
    buffer_load_dwordx4 v1, s[48:51], s66 offen lds
    buffer_load_dwordx4 v2, s[48:51], s66 offen offset:1024 lds
    buffer_load_dwordx4 v3, s[48:51], s66 offen offset:2048 lds
    buffer_load_dwordx4 v88, s[48:51], s66 offen offset:3072 lds
    s_add_u32 m0, s63, 45056
    s_nop 0
    buffer_load_dwordx4 v89, s[48:51], s66 offen lds
    s_add_u32 m0, s62, 147456
    s_add_u32 s66, s98, 73728
    buffer_load_dwordx4 v93, s[36:39], s66 offen nt lds
    buffer_load_dwordx4 v94, s[36:39], s66 offen offset:1024 nt lds
    s_add_u32 m0, s63, 61440
    s_add_u32 s66, s13, 3
    s_and_b32 s66, s66, 3
    s_mul_i32 s66, s66, 20480
    s_mul_i32 s67, s14, 640
    s_add_u32 s66, s66, s67
    buffer_load_dwordx4 v1, s[48:51], s66 offen lds
    buffer_load_dwordx4 v2, s[48:51], s66 offen offset:1024 lds
    buffer_load_dwordx4 v3, s[48:51], s66 offen offset:2048 lds
    buffer_load_dwordx4 v88, s[48:51], s66 offen offset:3072 lds
    s_add_u32 m0, s63, 65536
    s_nop 0
    buffer_load_dwordx4 v89, s[48:51], s66 offen lds
    s_add_u32 m0, s62, 155648
    s_add_u32 s66, s98, 98304
    buffer_load_dwordx4 v93, s[36:39], s66 offen nt lds
    buffer_load_dwordx4 v94, s[36:39], s66 offen offset:1024 nt lds
    v_mfma_f32_32x32x16_bf16 v[96:111], v[48:51], v[32:35], 0
    v_mfma_f32_32x32x16_bf16 v[112:127], v[52:55], v[32:35], 0
    s_waitcnt lgkmcnt(14)
    v_mfma_f32_32x32x16_bf16 v[128:143], v[56:59], v[32:35], 0
    s_waitcnt lgkmcnt(12)
    v_mfma_f32_32x32x16_bf16 v[144:159], v[60:63], v[32:35], 0
    s_waitcnt lgkmcnt(10)
    v_mfma_f32_32x32x16_bf16 v[160:175], v[64:67], v[32:35], 0
    s_waitcnt lgkmcnt(8)
    v_mfma_f32_32x32x16_bf16 v[176:191], v[68:71], v[32:35], 0
    s_waitcnt lgkmcnt(6)
    v_mfma_f32_32x32x16_bf16 v[192:207], v[72:75], v[32:35], 0
    s_waitcnt lgkmcnt(4)
    v_mfma_f32_32x32x16_bf16 v[208:223], v[76:79], v[32:35], 0
    s_waitcnt lgkmcnt(2)
    v_mfma_f32_32x32x16_bf16 v[224:239], v[80:83], v[32:35], 0
    s_waitcnt lgkmcnt(0)
    v_mfma_f32_32x32x16_bf16 v[240:255], v[84:87], v[32:35], 0
    s_waitcnt vmcnt(27)
    s_waitcnt vmcnt(25)
    s_waitcnt vmcnt(20)
    s_barrier
    ds_read_b64_tr_b16 v[48:49], v6 offset:20480
    ds_read_b64_tr_b16 v[50:51], v6 offset:25600
    ds_read_b64_tr_b16 v[52:53], v7 offset:20480
    ds_read_b64_tr_b16 v[54:55], v7 offset:25600
    ds_read_b64_tr_b16 v[56:57], v8 offset:20480
    ds_read_b64_tr_b16 v[58:59], v8 offset:25600
    ds_read_b64_tr_b16 v[60:61], v9 offset:20480
    ds_read_b64_tr_b16 v[62:63], v9 offset:25600
    ds_read_b64_tr_b16 v[64:65], v6 offset:20736
    ds_read_b64_tr_b16 v[66:67], v6 offset:25856
    ds_read_b64_tr_b16 v[68:69], v7 offset:20736
    ds_read_b64_tr_b16 v[70:71], v7 offset:25856
    ds_read_b64_tr_b16 v[72:73], v8 offset:20736
    ds_read_b64_tr_b16 v[74:75], v8 offset:25856
    ds_read_b64_tr_b16 v[76:77], v9 offset:20736
    s_waitcnt lgkmcnt(14)
    ds_read_b64_tr_b16 v[78:79], v9 offset:25856
    s_waitcnt lgkmcnt(14)
    ds_read_b64_tr_b16 v[80:81], v6 offset:20992
    s_waitcnt lgkmcnt(14)
    ds_read_b64_tr_b16 v[82:83], v6 offset:26112
    s_waitcnt lgkmcnt(14)
    ds_read_b64_tr_b16 v[84:85], v7 offset:20992
    s_waitcnt lgkmcnt(14)
    ds_read_b64_tr_b16 v[86:87], v7 offset:26112
    s_add_u32 m0, s62, 90112
    s_add_u32 s66, s98, 122880
    buffer_load_dwordx4 v93, s[36:39], s66 offen nt lds
    buffer_load_dwordx4 v94, s[36:39], s66 offen offset:1024 nt lds
    s_add_u32 m0, s63, 0
    s_add_u32 s66, s13, 0
    s_and_b32 s66, s66, 3
    s_mul_i32 s66, s66, 20480
    s_mul_i32 s67, s15, 640
    s_add_u32 s66, s66, s67
    buffer_load_dwordx4 v1, s[48:51], s66 offen lds
    buffer_load_dwordx4 v2, s[48:51], s66 offen offset:1024 lds
    buffer_load_dwordx4 v3, s[48:51], s66 offen offset:2048 lds
    buffer_load_dwordx4 v88, s[48:51], s66 offen offset:3072 lds
    s_add_u32 m0, s63, 4096
    s_nop 0
    buffer_load_dwordx4 v89, s[48:51], s66 offen lds
    s_add_u32 m0, s62, 98304
    s_add_u32 s66, s98, 147456
    buffer_load_dwordx4 v93, s[36:39], s66 offen nt lds
    buffer_load_dwordx4 v94, s[36:39], s66 offen offset:1024 nt lds
    v_mfma_f32_32x32x16_bf16 v[96:111], v[48:51], v[36:39], v[96:111]
    v_mfma_f32_32x32x16_bf16 v[112:127], v[52:55], v[36:39], v[112:127]
    s_waitcnt lgkmcnt(14)
    v_mfma_f32_32x32x16_bf16 v[128:143], v[56:59], v[36:39], v[128:143]
    s_waitcnt lgkmcnt(12)
    v_mfma_f32_32x32x16_bf16 v[144:159], v[60:63], v[36:39], v[144:159]
    s_waitcnt lgkmcnt(10)
    v_mfma_f32_32x32x16_bf16 v[160:175], v[64:67], v[36:39], v[160:175]
    s_waitcnt lgkmcnt(8)
    v_mfma_f32_32x32x16_bf16 v[176:191], v[68:71], v[36:39], v[176:191]
    s_waitcnt lgkmcnt(6)
    v_mfma_f32_32x32x16_bf16 v[192:207], v[72:75], v[36:39], v[192:207]
    s_waitcnt lgkmcnt(4)
    v_mfma_f32_32x32x16_bf16 v[208:223], v[76:79], v[36:39], v[208:223]
    s_waitcnt lgkmcnt(2)
    v_mfma_f32_32x32x16_bf16 v[224:239], v[80:83], v[36:39], v[224:239]
    s_waitcnt lgkmcnt(0)
    v_mfma_f32_32x32x16_bf16 v[240:255], v[84:87], v[36:39], v[240:255]
    s_waitcnt vmcnt(27)
    s_waitcnt vmcnt(25)
    s_waitcnt vmcnt(18)
    s_barrier
    ds_read_b64_tr_b16 v[48:49], v6 offset:40960
    ds_read_b64_tr_b16 v[50:51], v6 offset:46080
    ds_read_b64_tr_b16 v[52:53], v7 offset:40960
    ds_read_b64_tr_b16 v[54:55], v7 offset:46080
    ds_read_b64_tr_b16 v[56:57], v8 offset:40960
    ds_read_b64_tr_b16 v[58:59], v8 offset:46080
    ds_read_b64_tr_b16 v[60:61], v9 offset:40960
    ds_read_b64_tr_b16 v[62:63], v9 offset:46080
    ds_read_b64_tr_b16 v[64:65], v6 offset:41216
    ds_read_b64_tr_b16 v[66:67], v6 offset:46336
    ds_read_b64_tr_b16 v[68:69], v7 offset:41216
    ds_read_b64_tr_b16 v[70:71], v7 offset:46336
    ds_read_b64_tr_b16 v[72:73], v8 offset:41216
    ds_read_b64_tr_b16 v[74:75], v8 offset:46336
    ds_read_b64_tr_b16 v[76:77], v9 offset:41216
    s_waitcnt lgkmcnt(14)
    ds_read_b64_tr_b16 v[78:79], v9 offset:46336
    s_waitcnt lgkmcnt(14)
    ds_read_b64_tr_b16 v[80:81], v6 offset:41472
    s_waitcnt lgkmcnt(14)
    ds_read_b64_tr_b16 v[82:83], v6 offset:46592
    s_waitcnt lgkmcnt(14)
    ds_read_b64_tr_b16 v[84:85], v7 offset:41472
    s_waitcnt lgkmcnt(14)
    ds_read_b64_tr_b16 v[86:87], v7 offset:46592
    s_add_u32 m0, s62, 106496
    s_add_u32 s66, s98, 172032
    buffer_load_dwordx4 v93, s[36:39], s66 offen nt lds
    buffer_load_dwordx4 v94, s[36:39], s66 offen offset:1024 nt lds
    s_add_u32 m0, s63, 20480
    s_add_u32 s66, s13, 1
    s_and_b32 s66, s66, 3
    s_mul_i32 s66, s66, 20480
    s_mul_i32 s67, s15, 640
    s_add_u32 s66, s66, s67
    buffer_load_dwordx4 v1, s[48:51], s66 offen lds
    buffer_load_dwordx4 v2, s[48:51], s66 offen offset:1024 lds
    buffer_load_dwordx4 v3, s[48:51], s66 offen offset:2048 lds
    buffer_load_dwordx4 v88, s[48:51], s66 offen offset:3072 lds
    s_add_u32 m0, s63, 24576
    s_nop 0
    buffer_load_dwordx4 v89, s[48:51], s66 offen lds
    v_mfma_f32_32x32x16_bf16 v[96:111], v[48:51], v[40:43], v[96:111]
    v_mfma_f32_32x32x16_bf16 v[112:127], v[52:55], v[40:43], v[112:127]
    s_waitcnt lgkmcnt(14)
    v_mfma_f32_32x32x16_bf16 v[128:143], v[56:59], v[40:43], v[128:143]
    s_waitcnt lgkmcnt(12)
    v_mfma_f32_32x32x16_bf16 v[144:159], v[60:63], v[40:43], v[144:159]
    s_waitcnt lgkmcnt(10)
    v_mfma_f32_32x32x16_bf16 v[160:175], v[64:67], v[40:43], v[160:175]
    s_waitcnt lgkmcnt(8)
    v_mfma_f32_32x32x16_bf16 v[176:191], v[68:71], v[40:43], v[176:191]
    s_waitcnt lgkmcnt(6)
    v_mfma_f32_32x32x16_bf16 v[192:207], v[72:75], v[40:43], v[192:207]
    s_waitcnt lgkmcnt(4)
    v_mfma_f32_32x32x16_bf16 v[208:223], v[76:79], v[40:43], v[208:223]
    s_waitcnt lgkmcnt(2)
    v_mfma_f32_32x32x16_bf16 v[224:239], v[80:83], v[40:43], v[224:239]
    s_waitcnt lgkmcnt(0)
    v_mfma_f32_32x32x16_bf16 v[240:255], v[84:87], v[40:43], v[240:255]
    s_waitcnt vmcnt(23)
    s_waitcnt vmcnt(18)
    s_barrier
    v_add_u32 v16, 61440, v6
    v_add_u32 v17, 61440, v7
    v_add_u32 v18, 61440, v8
    v_add_u32 v19, 61440, v9
    ds_read_b64_tr_b16 v[48:49], v16 offset:0
    ds_read_b64_tr_b16 v[50:51], v16 offset:5120
    ds_read_b64_tr_b16 v[52:53], v17 offset:0
    ds_read_b64_tr_b16 v[54:55], v17 offset:5120
    ds_read_b64_tr_b16 v[56:57], v18 offset:0
    ds_read_b64_tr_b16 v[58:59], v18 offset:5120
    ds_read_b64_tr_b16 v[60:61], v19 offset:0
    ds_read_b64_tr_b16 v[62:63], v19 offset:5120
    ds_read_b64_tr_b16 v[64:65], v16 offset:256
    ds_read_b64_tr_b16 v[66:67], v16 offset:5376
    ds_read_b64_tr_b16 v[68:69], v17 offset:256
    ds_read_b64_tr_b16 v[70:71], v17 offset:5376
    ds_read_b64_tr_b16 v[72:73], v18 offset:256
    ds_read_b64_tr_b16 v[74:75], v18 offset:5376
    ds_read_b64_tr_b16 v[76:77], v19 offset:256
    s_waitcnt lgkmcnt(14)
    ds_read_b64_tr_b16 v[78:79], v19 offset:5376
    s_waitcnt lgkmcnt(14)
    ds_read_b64_tr_b16 v[80:81], v16 offset:512
    s_waitcnt lgkmcnt(14)
    ds_read_b64_tr_b16 v[82:83], v16 offset:5632
    s_waitcnt lgkmcnt(14)
    ds_read_b64_tr_b16 v[84:85], v17 offset:512
    s_waitcnt lgkmcnt(14)
    ds_read_b64_tr_b16 v[86:87], v17 offset:5632
    s_add_u32 m0, s60, 114688
    s_mov_b32 s66, 196608
    buffer_load_dwordx4 v90, s[32:35], s66 offen nt lds
    buffer_load_dwordx4 v91, s[32:35], s66 offen offset:1024 nt lds
    buffer_load_dwordx4 v92, s[32:35], s66 offen offset:2048 nt lds
    s_add_u32 m0, s60, 126976
    s_mov_b32 s66, 208896
    buffer_load_dwordx4 v90, s[32:35], s66 offen nt lds
    buffer_load_dwordx4 v91, s[32:35], s66 offen offset:1024 nt lds
    buffer_load_dwordx4 v92, s[32:35], s66 offen offset:2048 nt lds
    s_add_u32 m0, s63, 40960
    s_add_u32 s66, s13, 2
    s_and_b32 s66, s66, 3
    s_mul_i32 s66, s66, 20480
    s_mul_i32 s67, s15, 640
    s_add_u32 s66, s66, s67
    buffer_load_dwordx4 v1, s[48:51], s66 offen lds
    buffer_load_dwordx4 v2, s[48:51], s66 offen offset:1024 lds
    buffer_load_dwordx4 v3, s[48:51], s66 offen offset:2048 lds
    buffer_load_dwordx4 v88, s[48:51], s66 offen offset:3072 lds
    s_add_u32 m0, s63, 45056
    s_nop 0
    buffer_load_dwordx4 v89, s[48:51], s66 offen lds
    v_mfma_f32_32x32x16_bf16 v[96:111], v[48:51], v[44:47], v[96:111]
    v_mfma_f32_32x32x16_bf16 v[112:127], v[52:55], v[44:47], v[112:127]
    s_waitcnt lgkmcnt(14)
    v_mfma_f32_32x32x16_bf16 v[128:143], v[56:59], v[44:47], v[128:143]
    s_waitcnt lgkmcnt(12)
    v_mfma_f32_32x32x16_bf16 v[144:159], v[60:63], v[44:47], v[144:159]
    s_waitcnt lgkmcnt(10)
    v_mfma_f32_32x32x16_bf16 v[160:175], v[64:67], v[44:47], v[160:175]
    s_waitcnt lgkmcnt(8)
    v_mfma_f32_32x32x16_bf16 v[176:191], v[68:71], v[44:47], v[176:191]
    s_waitcnt lgkmcnt(6)
    v_mfma_f32_32x32x16_bf16 v[192:207], v[72:75], v[44:47], v[192:207]
    s_waitcnt lgkmcnt(4)
    v_mfma_f32_32x32x16_bf16 v[208:223], v[76:79], v[44:47], v[208:223]
    s_waitcnt lgkmcnt(2)
    v_mfma_f32_32x32x16_bf16 v[224:239], v[80:83], v[44:47], v[224:239]
    s_waitcnt lgkmcnt(0)
    v_mfma_f32_32x32x16_bf16 v[240:255], v[84:87], v[44:47], v[240:255]
    s_waitcnt vmcnt(27)
    s_waitcnt vmcnt(25)
    s_waitcnt vmcnt(20)
    s_barrier
    ds_read_b128 v[32:35], v10 offset:0
    ds_read_b128 v[36:39], v11 offset:0
    ds_read_b128 v[40:43], v12 offset:0
    ds_read_b128 v[44:47], v13 offset:0
    ds_read_b64_tr_b16 v[48:49], v6 offset:0
    ds_read_b64_tr_b16 v[50:51], v6 offset:5120
    ds_read_b64_tr_b16 v[52:53], v7 offset:0
    ds_read_b64_tr_b16 v[54:55], v7 offset:5120
    ds_read_b64_tr_b16 v[56:57], v8 offset:0
    ds_read_b64_tr_b16 v[58:59], v8 offset:5120
    ds_read_b64_tr_b16 v[60:61], v9 offset:0
    ds_read_b64_tr_b16 v[62:63], v9 offset:5120
    ds_read_b64_tr_b16 v[64:65], v6 offset:256
    ds_read_b64_tr_b16 v[66:67], v6 offset:5376
    ds_read_b64_tr_b16 v[68:69], v7 offset:256
    s_waitcnt lgkmcnt(14)
    ds_read_b64_tr_b16 v[70:71], v7 offset:5376
    s_waitcnt lgkmcnt(14)
    ds_read_b64_tr_b16 v[72:73], v8 offset:256
    s_waitcnt lgkmcnt(14)
    ds_read_b64_tr_b16 v[74:75], v8 offset:5376
    s_waitcnt lgkmcnt(14)
    ds_read_b64_tr_b16 v[76:77], v9 offset:256
    s_waitcnt lgkmcnt(14)
    ds_read_b64_tr_b16 v[78:79], v9 offset:5376
    s_waitcnt lgkmcnt(14)
    ds_read_b64_tr_b16 v[80:81], v6 offset:512
    s_waitcnt lgkmcnt(14)
    ds_read_b64_tr_b16 v[82:83], v6 offset:5632
    s_waitcnt lgkmcnt(14)
    ds_read_b64_tr_b16 v[84:85], v7 offset:512
    s_waitcnt lgkmcnt(14)
    ds_read_b64_tr_b16 v[86:87], v7 offset:5632
    s_add_u32 m0, s60, 139264
    s_mov_b32 s66, 221184
    buffer_load_dwordx4 v90, s[32:35], s66 offen nt lds
    buffer_load_dwordx4 v91, s[32:35], s66 offen offset:1024 nt lds
    buffer_load_dwordx4 v92, s[32:35], s66 offen offset:2048 nt lds
    s_add_u32 m0, s63, 61440
    s_add_u32 s66, s13, 3
    s_and_b32 s66, s66, 3
    s_mul_i32 s66, s66, 20480
    s_mul_i32 s67, s15, 640
    s_add_u32 s66, s66, s67
    buffer_load_dwordx4 v1, s[48:51], s66 offen lds
    buffer_load_dwordx4 v2, s[48:51], s66 offen offset:1024 lds
    buffer_load_dwordx4 v3, s[48:51], s66 offen offset:2048 lds
    buffer_load_dwordx4 v88, s[48:51], s66 offen offset:3072 lds
    s_add_u32 m0, s63, 65536
    s_nop 0
    buffer_load_dwordx4 v89, s[48:51], s66 offen lds
    v_mfma_f32_32x32x16_bf16 v[96:111], v[48:51], v[32:35], v[96:111]
    v_mfma_f32_32x32x16_bf16 v[112:127], v[52:55], v[32:35], v[112:127]
    s_waitcnt lgkmcnt(14)
    v_mfma_f32_32x32x16_bf16 v[128:143], v[56:59], v[32:35], v[128:143]
    s_waitcnt lgkmcnt(12)
    v_mfma_f32_32x32x16_bf16 v[144:159], v[60:63], v[32:35], v[144:159]
    s_waitcnt lgkmcnt(10)
    v_mfma_f32_32x32x16_bf16 v[160:175], v[64:67], v[32:35], v[160:175]
    s_waitcnt lgkmcnt(8)
    v_mfma_f32_32x32x16_bf16 v[176:191], v[68:71], v[32:35], v[176:191]
    s_waitcnt lgkmcnt(6)
    v_mfma_f32_32x32x16_bf16 v[192:207], v[72:75], v[32:35], v[192:207]
    s_waitcnt lgkmcnt(4)
    v_mfma_f32_32x32x16_bf16 v[208:223], v[76:79], v[32:35], v[208:223]
    s_waitcnt lgkmcnt(2)
    v_mfma_f32_32x32x16_bf16 v[224:239], v[80:83], v[32:35], v[224:239]
    s_waitcnt lgkmcnt(0)
    v_mfma_f32_32x32x16_bf16 v[240:255], v[84:87], v[32:35], v[240:255]
    s_waitcnt vmcnt(26)
    s_waitcnt vmcnt(24)
    s_waitcnt vmcnt(19)
    s_barrier
    ds_read_b64_tr_b16 v[48:49], v6 offset:20480
    ds_read_b64_tr_b16 v[50:51], v6 offset:25600
    ds_read_b64_tr_b16 v[52:53], v7 offset:20480
    ds_read_b64_tr_b16 v[54:55], v7 offset:25600
    ds_read_b64_tr_b16 v[56:57], v8 offset:20480
    ds_read_b64_tr_b16 v[58:59], v8 offset:25600
    ds_read_b64_tr_b16 v[60:61], v9 offset:20480
    ds_read_b64_tr_b16 v[62:63], v9 offset:25600
    ds_read_b64_tr_b16 v[64:65], v6 offset:20736
    ds_read_b64_tr_b16 v[66:67], v6 offset:25856
    ds_read_b64_tr_b16 v[68:69], v7 offset:20736
    ds_read_b64_tr_b16 v[70:71], v7 offset:25856
    ds_read_b64_tr_b16 v[72:73], v8 offset:20736
    ds_read_b64_tr_b16 v[74:75], v8 offset:25856
    ds_read_b64_tr_b16 v[76:77], v9 offset:20736
    s_waitcnt lgkmcnt(14)
    ds_read_b64_tr_b16 v[78:79], v9 offset:25856
    s_waitcnt lgkmcnt(14)
    ds_read_b64_tr_b16 v[80:81], v6 offset:20992
    s_waitcnt lgkmcnt(14)
    ds_read_b64_tr_b16 v[82:83], v6 offset:26112
    s_waitcnt lgkmcnt(14)
    ds_read_b64_tr_b16 v[84:85], v7 offset:20992
    s_waitcnt lgkmcnt(14)
    ds_read_b64_tr_b16 v[86:87], v7 offset:26112
    s_add_u32 m0, s60, 151552
    s_mov_b32 s66, 233472
    buffer_load_dwordx4 v90, s[32:35], s66 offen nt lds
    buffer_load_dwordx4 v91, s[32:35], s66 offen offset:1024 nt lds
    buffer_load_dwordx4 v92, s[32:35], s66 offen offset:2048 nt lds
    s_add_u32 m0, s63, 0
    s_add_u32 s66, s13, 0
    s_and_b32 s66, s66, 3
    s_mul_i32 s66, s66, 20480
    s_mul_i32 s67, s98, 640
    s_add_u32 s66, s66, s67
    buffer_load_dwordx4 v1, s[48:51], s66 offen lds
    buffer_load_dwordx4 v2, s[48:51], s66 offen offset:1024 lds
    buffer_load_dwordx4 v3, s[48:51], s66 offen offset:2048 lds
    buffer_load_dwordx4 v88, s[48:51], s66 offen offset:3072 lds
    s_add_u32 m0, s63, 4096
    s_nop 0
    buffer_load_dwordx4 v89, s[48:51], s66 offen lds
    v_mfma_f32_32x32x16_bf16 v[96:111], v[48:51], v[36:39], v[96:111]
    v_mfma_f32_32x32x16_bf16 v[112:127], v[52:55], v[36:39], v[112:127]
    s_waitcnt lgkmcnt(14)
    v_mfma_f32_32x32x16_bf16 v[128:143], v[56:59], v[36:39], v[128:143]
    s_waitcnt lgkmcnt(12)
    v_mfma_f32_32x32x16_bf16 v[144:159], v[60:63], v[36:39], v[144:159]
    s_waitcnt lgkmcnt(10)
    v_mfma_f32_32x32x16_bf16 v[160:175], v[64:67], v[36:39], v[160:175]
    s_waitcnt lgkmcnt(8)
    v_mfma_f32_32x32x16_bf16 v[176:191], v[68:71], v[36:39], v[176:191]
    s_waitcnt lgkmcnt(6)
    v_mfma_f32_32x32x16_bf16 v[192:207], v[72:75], v[36:39], v[192:207]
    s_waitcnt lgkmcnt(4)
    v_mfma_f32_32x32x16_bf16 v[208:223], v[76:79], v[36:39], v[208:223]
    s_waitcnt lgkmcnt(2)
    v_mfma_f32_32x32x16_bf16 v[224:239], v[80:83], v[36:39], v[224:239]
    s_waitcnt lgkmcnt(0)
    v_mfma_f32_32x32x16_bf16 v[240:255], v[84:87], v[36:39], v[240:255]
    s_waitcnt vmcnt(24)
    s_waitcnt vmcnt(21)
    s_waitcnt vmcnt(16)
    s_barrier
    ds_read_b64_tr_b16 v[48:49], v6 offset:40960
    ds_read_b64_tr_b16 v[50:51], v6 offset:46080
    ds_read_b64_tr_b16 v[52:53], v7 offset:40960
    ds_read_b64_tr_b16 v[54:55], v7 offset:46080
    ds_read_b64_tr_b16 v[56:57], v8 offset:40960
    ds_read_b64_tr_b16 v[58:59], v8 offset:46080
    ds_read_b64_tr_b16 v[60:61], v9 offset:40960
    ds_read_b64_tr_b16 v[62:63], v9 offset:46080
    ds_read_b64_tr_b16 v[64:65], v6 offset:41216
    ds_read_b64_tr_b16 v[66:67], v6 offset:46336
    ds_read_b64_tr_b16 v[68:69], v7 offset:41216
    ds_read_b64_tr_b16 v[70:71], v7 offset:46336
    ds_read_b64_tr_b16 v[72:73], v8 offset:41216
    ds_read_b64_tr_b16 v[74:75], v8 offset:46336
    ds_read_b64_tr_b16 v[76:77], v9 offset:41216
    s_waitcnt lgkmcnt(14)
    ds_read_b64_tr_b16 v[78:79], v9 offset:46336
    s_waitcnt lgkmcnt(14)
    ds_read_b64_tr_b16 v[80:81], v6 offset:41472
    s_waitcnt lgkmcnt(14)
    ds_read_b64_tr_b16 v[82:83], v6 offset:46592
    s_waitcnt lgkmcnt(14)
    ds_read_b64_tr_b16 v[84:85], v7 offset:41472
    s_waitcnt lgkmcnt(14)
    ds_read_b64_tr_b16 v[86:87], v7 offset:46592
    s_add_u32 m0, s60, 90112
    s_mov_b32 s66, 245760
    buffer_load_dwordx4 v90, s[32:35], s66 offen nt lds
    buffer_load_dwordx4 v91, s[32:35], s66 offen offset:1024 nt lds
    buffer_load_dwordx4 v92, s[32:35], s66 offen offset:2048 nt lds
    s_add_u32 m0, s60, 102400
    s_mov_b32 s66, 258048
    buffer_load_dwordx4 v90, s[32:35], s66 offen nt lds
    buffer_load_dwordx4 v91, s[32:35], s66 offen offset:1024 nt lds
    buffer_load_dwordx4 v92, s[32:35], s66 offen offset:2048 nt lds
    s_add_u32 m0, s63, 20480
    s_add_u32 s66, s13, 1
    s_and_b32 s66, s66, 3
    s_mul_i32 s66, s66, 20480
    s_mul_i32 s67, s98, 640
    s_add_u32 s66, s66, s67
    buffer_load_dwordx4 v1, s[48:51], s66 offen lds
    buffer_load_dwordx4 v2, s[48:51], s66 offen offset:1024 lds
    buffer_load_dwordx4 v3, s[48:51], s66 offen offset:2048 lds
    buffer_load_dwordx4 v88, s[48:51], s66 offen offset:3072 lds
    s_add_u32 m0, s63, 24576
    s_nop 0
    buffer_load_dwordx4 v89, s[48:51], s66 offen lds
    v_mfma_f32_32x32x16_bf16 v[96:111], v[48:51], v[40:43], v[96:111]
    v_mfma_f32_32x32x16_bf16 v[112:127], v[52:55], v[40:43], v[112:127]
    s_waitcnt lgkmcnt(14)
    v_mfma_f32_32x32x16_bf16 v[128:143], v[56:59], v[40:43], v[128:143]
    s_waitcnt lgkmcnt(12)
    v_mfma_f32_32x32x16_bf16 v[144:159], v[60:63], v[40:43], v[144:159]
    s_waitcnt lgkmcnt(10)
    v_mfma_f32_32x32x16_bf16 v[160:175], v[64:67], v[40:43], v[160:175]
    s_waitcnt lgkmcnt(8)
    v_mfma_f32_32x32x16_bf16 v[176:191], v[68:71], v[40:43], v[176:191]
    s_waitcnt lgkmcnt(6)
    v_mfma_f32_32x32x16_bf16 v[192:207], v[72:75], v[40:43], v[192:207]
    s_waitcnt lgkmcnt(4)
    v_mfma_f32_32x32x16_bf16 v[208:223], v[76:79], v[40:43], v[208:223]
    s_waitcnt lgkmcnt(2)
    v_mfma_f32_32x32x16_bf16 v[224:239], v[80:83], v[40:43], v[224:239]
    s_waitcnt lgkmcnt(0)
    v_mfma_f32_32x32x16_bf16 v[240:255], v[84:87], v[40:43], v[240:255]
    s_waitcnt vmcnt(24)
    s_waitcnt vmcnt(16)
    s_barrier
    ds_read_b64_tr_b16 v[48:49], v16 offset:0
    ds_read_b64_tr_b16 v[50:51], v16 offset:5120
    ds_read_b64_tr_b16 v[52:53], v17 offset:0
    ds_read_b64_tr_b16 v[54:55], v17 offset:5120
    ds_read_b64_tr_b16 v[56:57], v18 offset:0
    ds_read_b64_tr_b16 v[58:59], v18 offset:5120
    ds_read_b64_tr_b16 v[60:61], v19 offset:0
    ds_read_b64_tr_b16 v[62:63], v19 offset:5120
    ds_read_b64_tr_b16 v[64:65], v16 offset:256
    ds_read_b64_tr_b16 v[66:67], v16 offset:5376
    ds_read_b64_tr_b16 v[68:69], v17 offset:256
    ds_read_b64_tr_b16 v[70:71], v17 offset:5376
    ds_read_b64_tr_b16 v[72:73], v18 offset:256
    ds_read_b64_tr_b16 v[74:75], v18 offset:5376
    ds_read_b64_tr_b16 v[76:77], v19 offset:256
    s_waitcnt lgkmcnt(14)
    ds_read_b64_tr_b16 v[78:79], v19 offset:5376
    s_waitcnt lgkmcnt(14)
    ds_read_b64_tr_b16 v[80:81], v16 offset:512
    s_waitcnt lgkmcnt(14)
    ds_read_b64_tr_b16 v[82:83], v16 offset:5632
    s_waitcnt lgkmcnt(14)
    ds_read_b64_tr_b16 v[84:85], v17 offset:512
    s_waitcnt lgkmcnt(14)
    ds_read_b64_tr_b16 v[86:87], v17 offset:5632
    s_add_u32 m0, s60, 114688
    s_mov_b32 s66, 270336
    buffer_load_dwordx4 v90, s[32:35], s66 offen nt lds
    buffer_load_dwordx4 v91, s[32:35], s66 offen offset:1024 nt lds
    buffer_load_dwordx4 v92, s[32:35], s66 offen offset:2048 nt lds
    s_add_u32 m0, s60, 126976
    s_mov_b32 s66, 282624
    buffer_load_dwordx4 v90, s[32:35], s66 offen nt lds
    buffer_load_dwordx4 v91, s[32:35], s66 offen offset:1024 nt lds
    buffer_load_dwordx4 v92, s[32:35], s66 offen offset:2048 nt lds
    s_add_u32 m0, s63, 40960
    s_add_u32 s66, s13, 2
    s_and_b32 s66, s66, 3
    s_mul_i32 s66, s66, 20480
    s_mul_i32 s67, s98, 640
    s_add_u32 s66, s66, s67
    buffer_load_dwordx4 v1, s[48:51], s66 offen lds
    buffer_load_dwordx4 v2, s[48:51], s66 offen offset:1024 lds
    buffer_load_dwordx4 v3, s[48:51], s66 offen offset:2048 lds
    buffer_load_dwordx4 v88, s[48:51], s66 offen offset:3072 lds
    s_add_u32 m0, s63, 45056
    s_nop 0
    buffer_load_dwordx4 v89, s[48:51], s66 offen lds
    v_mfma_f32_32x32x16_bf16 v[96:111], v[48:51], v[44:47], v[96:111]
    v_mfma_f32_32x32x16_bf16 v[112:127], v[52:55], v[44:47], v[112:127]
    s_waitcnt lgkmcnt(14)
    v_mfma_f32_32x32x16_bf16 v[128:143], v[56:59], v[44:47], v[128:143]
    s_waitcnt lgkmcnt(12)
    v_mfma_f32_32x32x16_bf16 v[144:159], v[60:63], v[44:47], v[144:159]
    s_waitcnt lgkmcnt(10)
    v_mfma_f32_32x32x16_bf16 v[160:175], v[64:67], v[44:47], v[160:175]
    s_waitcnt lgkmcnt(8)
    v_mfma_f32_32x32x16_bf16 v[176:191], v[68:71], v[44:47], v[176:191]
    s_waitcnt lgkmcnt(6)
    v_mfma_f32_32x32x16_bf16 v[192:207], v[72:75], v[44:47], v[192:207]
    s_waitcnt lgkmcnt(4)
    v_mfma_f32_32x32x16_bf16 v[208:223], v[76:79], v[44:47], v[208:223]
    s_waitcnt lgkmcnt(2)
    v_mfma_f32_32x32x16_bf16 v[224:239], v[80:83], v[44:47], v[224:239]
    s_waitcnt lgkmcnt(0)
    v_mfma_f32_32x32x16_bf16 v[240:255], v[84:87], v[44:47], v[240:255]
    s_waitcnt vmcnt(19)
    s_waitcnt vmcnt(16)
    s_barrier
    ds_read_b128 v[32:35], v10 offset:0
    ds_read_b128 v[36:39], v11 offset:0
    ds_read_b128 v[40:43], v12 offset:0
    ds_read_b128 v[44:47], v13 offset:0
    ds_read_b64_tr_b16 v[48:49], v6 offset:0
    ds_read_b64_tr_b16 v[50:51], v6 offset:5120
    ds_read_b64_tr_b16 v[52:53], v7 offset:0
    ds_read_b64_tr_b16 v[54:55], v7 offset:5120
    ds_read_b64_tr_b16 v[56:57], v8 offset:0
    ds_read_b64_tr_b16 v[58:59], v8 offset:5120
    ds_read_b64_tr_b16 v[60:61], v9 offset:0
    ds_read_b64_tr_b16 v[62:63], v9 offset:5120
    ds_read_b64_tr_b16 v[64:65], v6 offset:256
    ds_read_b64_tr_b16 v[66:67], v6 offset:5376
    ds_read_b64_tr_b16 v[68:69], v7 offset:256
    s_waitcnt lgkmcnt(14)
    ds_read_b64_tr_b16 v[70:71], v7 offset:5376
    s_waitcnt lgkmcnt(14)
    ds_read_b64_tr_b16 v[72:73], v8 offset:256
    s_waitcnt lgkmcnt(14)
    ds_read_b64_tr_b16 v[74:75], v8 offset:5376
    s_waitcnt lgkmcnt(14)
    ds_read_b64_tr_b16 v[76:77], v9 offset:256
    s_waitcnt lgkmcnt(14)
    ds_read_b64_tr_b16 v[78:79], v9 offset:5376
    s_waitcnt lgkmcnt(14)
    ds_read_b64_tr_b16 v[80:81], v6 offset:512
    s_waitcnt lgkmcnt(14)
    ds_read_b64_tr_b16 v[82:83], v6 offset:5632
    s_waitcnt lgkmcnt(14)
    ds_read_b64_tr_b16 v[84:85], v7 offset:512
    s_waitcnt lgkmcnt(14)
    ds_read_b64_tr_b16 v[86:87], v7 offset:5632
    s_add_u32 m0, s60, 139264
    s_mov_b32 s66, 294912
    buffer_load_dwordx4 v90, s[32:35], s66 offen nt lds
    buffer_load_dwordx4 v91, s[32:35], s66 offen offset:1024 nt lds
    buffer_load_dwordx4 v92, s[32:35], s66 offen offset:2048 nt lds
    s_add_u32 m0, s60, 151552
    s_mov_b32 s66, 307200
    buffer_load_dwordx4 v90, s[32:35], s66 offen nt lds
    buffer_load_dwordx4 v91, s[32:35], s66 offen offset:1024 nt lds
    buffer_load_dwordx4 v92, s[32:35], s66 offen offset:2048 nt lds
    s_add_u32 m0, s63, 61440
    s_add_u32 s66, s13, 3
    s_and_b32 s66, s66, 3
    s_mul_i32 s66, s66, 20480
    s_mul_i32 s67, s98, 640
    s_add_u32 s66, s66, s67
    buffer_load_dwordx4 v1, s[48:51], s66 offen lds
    buffer_load_dwordx4 v2, s[48:51], s66 offen offset:1024 lds
    buffer_load_dwordx4 v3, s[48:51], s66 offen offset:2048 lds
    buffer_load_dwordx4 v88, s[48:51], s66 offen offset:3072 lds
    s_add_u32 m0, s63, 65536
    s_nop 0
    buffer_load_dwordx4 v89, s[48:51], s66 offen lds
    v_mfma_f32_32x32x16_bf16 v[96:111], v[48:51], v[32:35], v[96:111]
    v_mfma_f32_32x32x16_bf16 v[112:127], v[52:55], v[32:35], v[112:127]
    s_waitcnt lgkmcnt(14)
    v_mfma_f32_32x32x16_bf16 v[128:143], v[56:59], v[32:35], v[128:143]
    s_waitcnt lgkmcnt(12)
    v_mfma_f32_32x32x16_bf16 v[144:159], v[60:63], v[32:35], v[144:159]
    s_waitcnt lgkmcnt(10)
    v_mfma_f32_32x32x16_bf16 v[160:175], v[64:67], v[32:35], v[160:175]
    s_waitcnt lgkmcnt(8)
    v_mfma_f32_32x32x16_bf16 v[176:191], v[68:71], v[32:35], v[176:191]
    s_waitcnt lgkmcnt(6)
    v_mfma_f32_32x32x16_bf16 v[192:207], v[72:75], v[32:35], v[192:207]
    s_waitcnt lgkmcnt(4)
    v_mfma_f32_32x32x16_bf16 v[208:223], v[76:79], v[32:35], v[208:223]
    s_waitcnt lgkmcnt(2)
    v_mfma_f32_32x32x16_bf16 v[224:239], v[80:83], v[32:35], v[224:239]
    s_waitcnt lgkmcnt(0)
    v_mfma_f32_32x32x16_bf16 v[240:255], v[84:87], v[32:35], v[240:255]
    s_waitcnt vmcnt(19)
    s_waitcnt vmcnt(16)
    s_barrier
    ds_read_b64_tr_b16 v[48:49], v6 offset:20480
    ds_read_b64_tr_b16 v[50:51], v6 offset:25600
    ds_read_b64_tr_b16 v[52:53], v7 offset:20480
    ds_read_b64_tr_b16 v[54:55], v7 offset:25600
    ds_read_b64_tr_b16 v[56:57], v8 offset:20480
    ds_read_b64_tr_b16 v[58:59], v8 offset:25600
    ds_read_b64_tr_b16 v[60:61], v9 offset:20480
    ds_read_b64_tr_b16 v[62:63], v9 offset:25600
    ds_read_b64_tr_b16 v[64:65], v6 offset:20736
    ds_read_b64_tr_b16 v[66:67], v6 offset:25856
    ds_read_b64_tr_b16 v[68:69], v7 offset:20736
    ds_read_b64_tr_b16 v[70:71], v7 offset:25856
    ds_read_b64_tr_b16 v[72:73], v8 offset:20736
    ds_read_b64_tr_b16 v[74:75], v8 offset:25856
    ds_read_b64_tr_b16 v[76:77], v9 offset:20736
    s_waitcnt lgkmcnt(14)
    ds_read_b64_tr_b16 v[78:79], v9 offset:25856
    s_waitcnt lgkmcnt(14)
    ds_read_b64_tr_b16 v[80:81], v6 offset:20992
    s_waitcnt lgkmcnt(14)
    ds_read_b64_tr_b16 v[82:83], v6 offset:26112
    s_waitcnt lgkmcnt(14)
    ds_read_b64_tr_b16 v[84:85], v7 offset:20992
    s_waitcnt lgkmcnt(14)
    ds_read_b64_tr_b16 v[86:87], v7 offset:26112
    s_add_u32 m0, s60, 90112
    s_mov_b32 s66, 319488
    buffer_load_dwordx4 v90, s[32:35], s66 offen nt lds
    buffer_load_dwordx4 v91, s[32:35], s66 offen offset:1024 nt lds
    buffer_load_dwordx4 v92, s[32:35], s66 offen offset:2048 nt lds
    s_add_u32 m0, s60, 102400
    s_mov_b32 s66, 331776
    buffer_load_dwordx4 v90, s[32:35], s66 offen nt lds
    buffer_load_dwordx4 v91, s[32:35], s66 offen offset:1024 nt lds
    buffer_load_dwordx4 v92, s[32:35], s66 offen offset:2048 nt lds
    s_add_u32 m0, s63, 0
    s_add_u32 s66, s13, 0
    s_and_b32 s66, s66, 3
    s_mul_i32 s66, s66, 20480
    s_mul_i32 s67, s14, 640
    s_add_u32 s66, s66, s67
    s_add_u32 s66, s66, 245760
    buffer_load_dwordx4 v1, s[48:51], s66 offen lds
    buffer_load_dwordx4 v2, s[48:51], s66 offen offset:1024 lds
    buffer_load_dwordx4 v3, s[48:51], s66 offen offset:2048 lds
    buffer_load_dwordx4 v88, s[48:51], s66 offen offset:3072 lds
    s_add_u32 m0, s63, 4096
    s_nop 0
    buffer_load_dwordx4 v89, s[48:51], s66 offen lds
    v_mfma_f32_32x32x16_bf16 v[96:111], v[48:51], v[36:39], v[96:111]
    v_mfma_f32_32x32x16_bf16 v[112:127], v[52:55], v[36:39], v[112:127]
    s_waitcnt lgkmcnt(14)
    v_mfma_f32_32x32x16_bf16 v[128:143], v[56:59], v[36:39], v[128:143]
    s_waitcnt lgkmcnt(12)
    v_mfma_f32_32x32x16_bf16 v[144:159], v[60:63], v[36:39], v[144:159]
    s_waitcnt lgkmcnt(10)
    v_mfma_f32_32x32x16_bf16 v[160:175], v[64:67], v[36:39], v[160:175]
    s_waitcnt lgkmcnt(8)
    v_mfma_f32_32x32x16_bf16 v[176:191], v[68:71], v[36:39], v[176:191]
    s_waitcnt lgkmcnt(6)
    v_mfma_f32_32x32x16_bf16 v[192:207], v[72:75], v[36:39], v[192:207]
    s_waitcnt lgkmcnt(4)
    v_mfma_f32_32x32x16_bf16 v[208:223], v[76:79], v[36:39], v[208:223]
    s_waitcnt lgkmcnt(2)
    v_mfma_f32_32x32x16_bf16 v[224:239], v[80:83], v[36:39], v[224:239]
    s_waitcnt lgkmcnt(0)
    v_mfma_f32_32x32x16_bf16 v[240:255], v[84:87], v[36:39], v[240:255]
    s_waitcnt vmcnt(19)
    s_waitcnt vmcnt(16)
    s_barrier
    ds_read_b64_tr_b16 v[48:49], v6 offset:40960
    ds_read_b64_tr_b16 v[50:51], v6 offset:46080
    ds_read_b64_tr_b16 v[52:53], v7 offset:40960
    ds_read_b64_tr_b16 v[54:55], v7 offset:46080
    ds_read_b64_tr_b16 v[56:57], v8 offset:40960
    ds_read_b64_tr_b16 v[58:59], v8 offset:46080
    ds_read_b64_tr_b16 v[60:61], v9 offset:40960
    ds_read_b64_tr_b16 v[62:63], v9 offset:46080
    ds_read_b64_tr_b16 v[64:65], v6 offset:41216
    ds_read_b64_tr_b16 v[66:67], v6 offset:46336
    ds_read_b64_tr_b16 v[68:69], v7 offset:41216
    ds_read_b64_tr_b16 v[70:71], v7 offset:46336
    ds_read_b64_tr_b16 v[72:73], v8 offset:41216
    ds_read_b64_tr_b16 v[74:75], v8 offset:46336
    ds_read_b64_tr_b16 v[76:77], v9 offset:41216
    s_waitcnt lgkmcnt(14)
    ds_read_b64_tr_b16 v[78:79], v9 offset:46336
    s_waitcnt lgkmcnt(14)
    ds_read_b64_tr_b16 v[80:81], v6 offset:41472
    s_waitcnt lgkmcnt(14)
    ds_read_b64_tr_b16 v[82:83], v6 offset:46592
    s_waitcnt lgkmcnt(14)
    ds_read_b64_tr_b16 v[84:85], v7 offset:41472
    s_waitcnt lgkmcnt(14)
    ds_read_b64_tr_b16 v[86:87], v7 offset:46592
    s_add_u32 m0, s60, 114688
    s_mov_b32 s66, 344064
    buffer_load_dwordx4 v90, s[32:35], s66 offen nt lds
    buffer_load_dwordx4 v91, s[32:35], s66 offen offset:1024 nt lds
    buffer_load_dwordx4 v92, s[32:35], s66 offen offset:2048 nt lds
    s_add_u32 m0, s60, 126976
    s_mov_b32 s66, 356352
    buffer_load_dwordx4 v90, s[32:35], s66 offen nt lds
    buffer_load_dwordx4 v91, s[32:35], s66 offen offset:1024 nt lds
    buffer_load_dwordx4 v92, s[32:35], s66 offen offset:2048 nt lds
    s_add_u32 m0, s63, 20480
    s_add_u32 s66, s13, 1
    s_and_b32 s66, s66, 3
    s_mul_i32 s66, s66, 20480
    s_mul_i32 s67, s14, 640
    s_add_u32 s66, s66, s67
    s_add_u32 s66, s66, 245760
    buffer_load_dwordx4 v1, s[48:51], s66 offen lds
    buffer_load_dwordx4 v2, s[48:51], s66 offen offset:1024 lds
    buffer_load_dwordx4 v3, s[48:51], s66 offen offset:2048 lds
    buffer_load_dwordx4 v88, s[48:51], s66 offen offset:3072 lds
    s_add_u32 m0, s63, 24576
    s_nop 0
    buffer_load_dwordx4 v89, s[48:51], s66 offen lds
    v_mfma_f32_32x32x16_bf16 v[96:111], v[48:51], v[40:43], v[96:111]
    v_mfma_f32_32x32x16_bf16 v[112:127], v[52:55], v[40:43], v[112:127]
    s_waitcnt lgkmcnt(14)
    v_mfma_f32_32x32x16_bf16 v[128:143], v[56:59], v[40:43], v[128:143]
    s_waitcnt lgkmcnt(12)
    v_mfma_f32_32x32x16_bf16 v[144:159], v[60:63], v[40:43], v[144:159]
    s_waitcnt lgkmcnt(10)
    v_mfma_f32_32x32x16_bf16 v[160:175], v[64:67], v[40:43], v[160:175]
    s_waitcnt lgkmcnt(8)
    v_mfma_f32_32x32x16_bf16 v[176:191], v[68:71], v[40:43], v[176:191]
    s_waitcnt lgkmcnt(6)
    v_mfma_f32_32x32x16_bf16 v[192:207], v[72:75], v[40:43], v[192:207]
    s_waitcnt lgkmcnt(4)
    v_mfma_f32_32x32x16_bf16 v[208:223], v[76:79], v[40:43], v[208:223]
    s_waitcnt lgkmcnt(2)
    v_mfma_f32_32x32x16_bf16 v[224:239], v[80:83], v[40:43], v[224:239]
    s_waitcnt lgkmcnt(0)
    v_mfma_f32_32x32x16_bf16 v[240:255], v[84:87], v[40:43], v[240:255]
    s_waitcnt vmcnt(19)
    s_waitcnt vmcnt(16)
    s_barrier
    ds_read_b64_tr_b16 v[48:49], v16 offset:0
    ds_read_b64_tr_b16 v[50:51], v16 offset:5120
    ds_read_b64_tr_b16 v[52:53], v17 offset:0
    ds_read_b64_tr_b16 v[54:55], v17 offset:5120
    ds_read_b64_tr_b16 v[56:57], v18 offset:0
    ds_read_b64_tr_b16 v[58:59], v18 offset:5120
    ds_read_b64_tr_b16 v[60:61], v19 offset:0
    ds_read_b64_tr_b16 v[62:63], v19 offset:5120
    ds_read_b64_tr_b16 v[64:65], v16 offset:256
    ds_read_b64_tr_b16 v[66:67], v16 offset:5376
    ds_read_b64_tr_b16 v[68:69], v17 offset:256
    ds_read_b64_tr_b16 v[70:71], v17 offset:5376
    ds_read_b64_tr_b16 v[72:73], v18 offset:256
    ds_read_b64_tr_b16 v[74:75], v18 offset:5376
    ds_read_b64_tr_b16 v[76:77], v19 offset:256
    s_waitcnt lgkmcnt(14)
    ds_read_b64_tr_b16 v[78:79], v19 offset:5376
    s_waitcnt lgkmcnt(14)
    ds_read_b64_tr_b16 v[80:81], v16 offset:512
    s_waitcnt lgkmcnt(14)
    ds_read_b64_tr_b16 v[82:83], v16 offset:5632
    s_waitcnt lgkmcnt(14)
    ds_read_b64_tr_b16 v[84:85], v17 offset:512
    s_waitcnt lgkmcnt(14)
    ds_read_b64_tr_b16 v[86:87], v17 offset:5632
    s_add_u32 m0, s60, 139264
    s_mov_b32 s66, 368640
    buffer_load_dwordx4 v90, s[32:35], s66 offen nt lds
    buffer_load_dwordx4 v91, s[32:35], s66 offen offset:1024 nt lds
    buffer_load_dwordx4 v92, s[32:35], s66 offen offset:2048 nt lds
    s_add_u32 m0, s60, 151552
    s_mov_b32 s66, 380928
    buffer_load_dwordx4 v90, s[32:35], s66 offen nt lds
    buffer_load_dwordx4 v91, s[32:35], s66 offen offset:1024 nt lds
    buffer_load_dwordx4 v92, s[32:35], s66 offen offset:2048 nt lds
    s_add_u32 m0, s63, 40960
    s_add_u32 s66, s13, 2
    s_and_b32 s66, s66, 3
    s_mul_i32 s66, s66, 20480
    s_mul_i32 s67, s14, 640
    s_add_u32 s66, s66, s67
    s_add_u32 s66, s66, 245760
    buffer_load_dwordx4 v1, s[48:51], s66 offen lds
    buffer_load_dwordx4 v2, s[48:51], s66 offen offset:1024 lds
    buffer_load_dwordx4 v3, s[48:51], s66 offen offset:2048 lds
    buffer_load_dwordx4 v88, s[48:51], s66 offen offset:3072 lds
    s_add_u32 m0, s63, 45056
    s_nop 0
    buffer_load_dwordx4 v89, s[48:51], s66 offen lds
    v_mfma_f32_32x32x16_bf16 v[96:111], v[48:51], v[44:47], v[96:111]
    v_mfma_f32_32x32x16_bf16 v[112:127], v[52:55], v[44:47], v[112:127]
    s_waitcnt lgkmcnt(14)
    v_mfma_f32_32x32x16_bf16 v[128:143], v[56:59], v[44:47], v[128:143]
    s_waitcnt lgkmcnt(12)
    v_mfma_f32_32x32x16_bf16 v[144:159], v[60:63], v[44:47], v[144:159]
    s_waitcnt lgkmcnt(10)
    v_mfma_f32_32x32x16_bf16 v[160:175], v[64:67], v[44:47], v[160:175]
    s_waitcnt lgkmcnt(8)
    v_mfma_f32_32x32x16_bf16 v[176:191], v[68:71], v[44:47], v[176:191]
    s_waitcnt lgkmcnt(6)
    v_mfma_f32_32x32x16_bf16 v[192:207], v[72:75], v[44:47], v[192:207]
    s_waitcnt lgkmcnt(4)
    v_mfma_f32_32x32x16_bf16 v[208:223], v[76:79], v[44:47], v[208:223]
    s_waitcnt lgkmcnt(2)
    v_mfma_f32_32x32x16_bf16 v[224:239], v[80:83], v[44:47], v[224:239]
    s_waitcnt lgkmcnt(0)
    v_mfma_f32_32x32x16_bf16 v[240:255], v[84:87], v[44:47], v[240:255]
    s_waitcnt vmcnt(19)
    s_waitcnt vmcnt(16)
    s_barrier
    s_add_u32 m0, s62, 90112
    s_add_u32 s66, s14, 196608
    buffer_load_dwordx4 v93, s[36:39], s66 offen nt lds
    buffer_load_dwordx4 v94, s[36:39], s66 offen offset:1024 nt lds
    s_add_u32 m0, s62, 98304
    s_add_u32 s66, s14, 221184
    buffer_load_dwordx4 v93, s[36:39], s66 offen nt lds
    buffer_load_dwordx4 v94, s[36:39], s66 offen offset:1024 nt lds
    s_add_u32 m0, s62, 106496
    s_add_u32 s66, s14, 245760
    buffer_load_dwordx4 v93, s[36:39], s66 offen nt lds
    buffer_load_dwordx4 v94, s[36:39], s66 offen offset:1024 nt lds
    s_add_u32 m0, s63, 61440
    s_add_u32 s66, s13, 3
    s_and_b32 s66, s66, 3
    s_mul_i32 s66, s66, 20480
    s_mul_i32 s67, s14, 640
    s_add_u32 s66, s66, s67
    s_add_u32 s66, s66, 245760
    buffer_load_dwordx4 v1, s[48:51], s66 offen lds
    buffer_load_dwordx4 v2, s[48:51], s66 offen offset:1024 lds
    buffer_load_dwordx4 v3, s[48:51], s66 offen offset:2048 lds
    buffer_load_dwordx4 v88, s[48:51], s66 offen offset:3072 lds
    s_add_u32 m0, s63, 65536
    s_nop 0
    buffer_load_dwordx4 v89, s[48:51], s66 offen lds
    s_waitcnt vmcnt(19)
    s_waitcnt vmcnt(16)
    s_barrier
    s_add_u32 m0, s62, 114688
    s_add_u32 s66, s14, 270336
    buffer_load_dwordx4 v93, s[36:39], s66 offen nt lds
    buffer_load_dwordx4 v94, s[36:39], s66 offen offset:1024 nt lds
    s_add_u32 m0, s62, 122880
    s_add_u32 s66, s14, 294912
    buffer_load_dwordx4 v93, s[36:39], s66 offen nt lds
    buffer_load_dwordx4 v94, s[36:39], s66 offen offset:1024 nt lds
    s_add_u32 m0, s62, 131072
    s_add_u32 s66, s14, 319488
    buffer_load_dwordx4 v93, s[36:39], s66 offen nt lds
    buffer_load_dwordx4 v94, s[36:39], s66 offen offset:1024 nt lds
    s_waitcnt vmcnt(15)
    s_waitcnt vmcnt(13)
    s_barrier
    s_add_u32 m0, s62, 139264
    s_add_u32 s66, s14, 344064
    buffer_load_dwordx4 v93, s[36:39], s66 offen nt lds
    buffer_load_dwordx4 v94, s[36:39], s66 offen offset:1024 nt lds
    s_add_u32 m0, s62, 147456
    s_add_u32 s66, s14, 368640
    buffer_load_dwordx4 v93, s[36:39], s66 offen nt lds
    buffer_load_dwordx4 v94, s[36:39], s66 offen offset:1024 nt lds
    s_add_u32 m0, s62, 155648
    s_add_u32 s66, s15, 196608
    buffer_load_dwordx4 v93, s[36:39], s66 offen nt lds
    buffer_load_dwordx4 v94, s[36:39], s66 offen offset:1024 nt lds
    s_waitcnt vmcnt(17)
    s_waitcnt vmcnt(10)
    s_barrier
    s_add_u32 m0, s62, 90112
    s_add_u32 s66, s15, 221184
    buffer_load_dwordx4 v93, s[36:39], s66 offen nt lds
    buffer_load_dwordx4 v94, s[36:39], s66 offen offset:1024 nt lds
    s_add_u32 m0, s62, 98304
    s_add_u32 s66, s15, 245760
    buffer_load_dwordx4 v93, s[36:39], s66 offen nt lds
    buffer_load_dwordx4 v94, s[36:39], s66 offen offset:1024 nt lds
    s_waitcnt vmcnt(12)
    s_waitcnt vmcnt(10)
    s_barrier
    s_add_u32 m0, s62, 106496
    s_add_u32 s66, s15, 270336
    buffer_load_dwordx4 v93, s[36:39], s66 offen nt lds
    buffer_load_dwordx4 v94, s[36:39], s66 offen offset:1024 nt lds
    s_add_u32 m0, s62, 114688
    s_add_u32 s66, s15, 294912
    buffer_load_dwordx4 v93, s[36:39], s66 offen nt lds
    buffer_load_dwordx4 v94, s[36:39], s66 offen offset:1024 nt lds
    s_waitcnt vmcnt(12)
    s_waitcnt vmcnt(10)
    s_barrier
    s_add_u32 m0, s62, 122880
    s_add_u32 s66, s15, 319488
    buffer_load_dwordx4 v93, s[36:39], s66 offen nt lds
    buffer_load_dwordx4 v94, s[36:39], s66 offen offset:1024 nt lds
    s_add_u32 m0, s62, 131072
    s_add_u32 s66, s15, 344064
    buffer_load_dwordx4 v93, s[36:39], s66 offen nt lds
    buffer_load_dwordx4 v94, s[36:39], s66 offen offset:1024 nt lds
    s_waitcnt vmcnt(12)
    s_waitcnt vmcnt(10)
    s_barrier
    ds_read_b128 v[32:35], v10 offset:0
    ds_read_b128 v[36:39], v11 offset:0
    ds_read_b128 v[40:43], v12 offset:0
    ds_read_b128 v[44:47], v13 offset:0
    ds_read_b64_tr_b16 v[48:49], v6 offset:0
    ds_read_b64_tr_b16 v[50:51], v6 offset:5120
    ds_read_b64_tr_b16 v[52:53], v7 offset:0
    ds_read_b64_tr_b16 v[54:55], v7 offset:5120
    ds_read_b64_tr_b16 v[56:57], v8 offset:0
    ds_read_b64_tr_b16 v[58:59], v8 offset:5120
    ds_read_b64_tr_b16 v[60:61], v9 offset:0
    ds_read_b64_tr_b16 v[62:63], v9 offset:5120
    ds_read_b64_tr_b16 v[64:65], v6 offset:256
    ds_read_b64_tr_b16 v[66:67], v6 offset:5376
    ds_read_b64_tr_b16 v[68:69], v7 offset:256
    s_waitcnt lgkmcnt(14)
    ds_read_b64_tr_b16 v[70:71], v7 offset:5376
    s_waitcnt lgkmcnt(14)
    ds_read_b64_tr_b16 v[72:73], v8 offset:256
    s_waitcnt lgkmcnt(14)
    ds_read_b64_tr_b16 v[74:75], v8 offset:5376
    s_waitcnt lgkmcnt(14)
    ds_read_b64_tr_b16 v[76:77], v9 offset:256
    s_waitcnt lgkmcnt(14)
    ds_read_b64_tr_b16 v[78:79], v9 offset:5376
    s_waitcnt lgkmcnt(14)
    ds_read_b64_tr_b16 v[80:81], v6 offset:512
    s_waitcnt lgkmcnt(14)
    ds_read_b64_tr_b16 v[82:83], v6 offset:5632
    s_waitcnt lgkmcnt(14)
    ds_read_b64_tr_b16 v[84:85], v7 offset:512
    s_waitcnt lgkmcnt(14)
    ds_read_b64_tr_b16 v[86:87], v7 offset:5632
    s_add_u32 m0, s62, 139264
    s_add_u32 s66, s15, 368640
    buffer_load_dwordx4 v93, s[36:39], s66 offen nt lds
    buffer_load_dwordx4 v94, s[36:39], s66 offen offset:1024 nt lds
    s_add_u32 m0, s62, 147456
    s_add_u32 s66, s98, 196608
    buffer_load_dwordx4 v93, s[36:39], s66 offen nt lds
    buffer_load_dwordx4 v94, s[36:39], s66 offen offset:1024 nt lds
    v_mfma_f32_32x32x16_bf16 v[96:111], v[48:51], v[32:35], v[96:111]
    v_mfma_f32_32x32x16_bf16 v[112:127], v[52:55], v[32:35], v[112:127]
    s_waitcnt lgkmcnt(14)
    v_mfma_f32_32x32x16_bf16 v[128:143], v[56:59], v[32:35], v[128:143]
    s_waitcnt lgkmcnt(12)
    v_mfma_f32_32x32x16_bf16 v[144:159], v[60:63], v[32:35], v[144:159]
    s_waitcnt lgkmcnt(10)
    v_mfma_f32_32x32x16_bf16 v[160:175], v[64:67], v[32:35], v[160:175]
    s_waitcnt lgkmcnt(8)
    v_mfma_f32_32x32x16_bf16 v[176:191], v[68:71], v[32:35], v[176:191]
    s_waitcnt lgkmcnt(6)
    v_mfma_f32_32x32x16_bf16 v[192:207], v[72:75], v[32:35], v[192:207]
    s_waitcnt lgkmcnt(4)
    v_mfma_f32_32x32x16_bf16 v[208:223], v[76:79], v[32:35], v[208:223]
    s_waitcnt lgkmcnt(2)
    v_mfma_f32_32x32x16_bf16 v[224:239], v[80:83], v[32:35], v[224:239]
    s_waitcnt lgkmcnt(0)
    v_mfma_f32_32x32x16_bf16 v[240:255], v[84:87], v[32:35], v[240:255]
    s_waitcnt vmcnt(12)
    s_waitcnt vmcnt(10)
    s_barrier
    ds_read_b64_tr_b16 v[48:49], v6 offset:20480
    ds_read_b64_tr_b16 v[50:51], v6 offset:25600
    ds_read_b64_tr_b16 v[52:53], v7 offset:20480
    ds_read_b64_tr_b16 v[54:55], v7 offset:25600
    ds_read_b64_tr_b16 v[56:57], v8 offset:20480
    ds_read_b64_tr_b16 v[58:59], v8 offset:25600
    ds_read_b64_tr_b16 v[60:61], v9 offset:20480
    ds_read_b64_tr_b16 v[62:63], v9 offset:25600
    ds_read_b64_tr_b16 v[64:65], v6 offset:20736
    ds_read_b64_tr_b16 v[66:67], v6 offset:25856
    ds_read_b64_tr_b16 v[68:69], v7 offset:20736
    ds_read_b64_tr_b16 v[70:71], v7 offset:25856
    ds_read_b64_tr_b16 v[72:73], v8 offset:20736
    ds_read_b64_tr_b16 v[74:75], v8 offset:25856
    ds_read_b64_tr_b16 v[76:77], v9 offset:20736
    s_waitcnt lgkmcnt(14)
    ds_read_b64_tr_b16 v[78:79], v9 offset:25856
    s_waitcnt lgkmcnt(14)
    ds_read_b64_tr_b16 v[80:81], v6 offset:20992
    s_waitcnt lgkmcnt(14)
    ds_read_b64_tr_b16 v[82:83], v6 offset:26112
    s_waitcnt lgkmcnt(14)
    ds_read_b64_tr_b16 v[84:85], v7 offset:20992
    s_waitcnt lgkmcnt(14)
    ds_read_b64_tr_b16 v[86:87], v7 offset:26112
    s_add_u32 m0, s62, 155648
    s_add_u32 s66, s98, 221184
    buffer_load_dwordx4 v93, s[36:39], s66 offen nt lds
    buffer_load_dwordx4 v94, s[36:39], s66 offen offset:1024 nt lds
    s_add_u32 m0, s63, 0
    s_add_u32 s66, s13, 0
    s_and_b32 s66, s66, 3
    s_mul_i32 s66, s66, 20480
    s_mul_i32 s67, s15, 640
    s_add_u32 s66, s66, s67
    s_add_u32 s66, s66, 245760
    buffer_load_dwordx4 v1, s[48:51], s66 offen lds
    buffer_load_dwordx4 v2, s[48:51], s66 offen offset:1024 lds
    buffer_load_dwordx4 v3, s[48:51], s66 offen offset:2048 lds
    buffer_load_dwordx4 v88, s[48:51], s66 offen offset:3072 lds
    s_add_u32 m0, s63, 4096
    s_nop 0
    buffer_load_dwordx4 v89, s[48:51], s66 offen lds
    s_add_u32 m0, s62, 90112
    s_add_u32 s66, s98, 245760
    buffer_load_dwordx4 v93, s[36:39], s66 offen nt lds
    buffer_load_dwordx4 v94, s[36:39], s66 offen offset:1024 nt lds
    v_mfma_f32_32x32x16_bf16 v[96:111], v[48:51], v[36:39], v[96:111]
    v_mfma_f32_32x32x16_bf16 v[112:127], v[52:55], v[36:39], v[112:127]
    s_waitcnt lgkmcnt(14)
    v_mfma_f32_32x32x16_bf16 v[128:143], v[56:59], v[36:39], v[128:143]
    s_waitcnt lgkmcnt(12)
    v_mfma_f32_32x32x16_bf16 v[144:159], v[60:63], v[36:39], v[144:159]
    s_waitcnt lgkmcnt(10)
    v_mfma_f32_32x32x16_bf16 v[160:175], v[64:67], v[36:39], v[160:175]
    s_waitcnt lgkmcnt(8)
    v_mfma_f32_32x32x16_bf16 v[176:191], v[68:71], v[36:39], v[176:191]
    s_waitcnt lgkmcnt(6)
    v_mfma_f32_32x32x16_bf16 v[192:207], v[72:75], v[36:39], v[192:207]
    s_waitcnt lgkmcnt(4)
    v_mfma_f32_32x32x16_bf16 v[208:223], v[76:79], v[36:39], v[208:223]
    s_waitcnt lgkmcnt(2)
    v_mfma_f32_32x32x16_bf16 v[224:239], v[80:83], v[36:39], v[224:239]
    s_waitcnt lgkmcnt(0)
    v_mfma_f32_32x32x16_bf16 v[240:255], v[84:87], v[36:39], v[240:255]
    s_waitcnt vmcnt(17)
    s_waitcnt vmcnt(15)
    s_barrier
    ds_read_b64_tr_b16 v[48:49], v6 offset:40960
    ds_read_b64_tr_b16 v[50:51], v6 offset:46080
    ds_read_b64_tr_b16 v[52:53], v7 offset:40960
    ds_read_b64_tr_b16 v[54:55], v7 offset:46080
    ds_read_b64_tr_b16 v[56:57], v8 offset:40960
    ds_read_b64_tr_b16 v[58:59], v8 offset:46080
    ds_read_b64_tr_b16 v[60:61], v9 offset:40960
    ds_read_b64_tr_b16 v[62:63], v9 offset:46080
    ds_read_b64_tr_b16 v[64:65], v6 offset:41216
    ds_read_b64_tr_b16 v[66:67], v6 offset:46336
    ds_read_b64_tr_b16 v[68:69], v7 offset:41216
    ds_read_b64_tr_b16 v[70:71], v7 offset:46336
    ds_read_b64_tr_b16 v[72:73], v8 offset:41216
    ds_read_b64_tr_b16 v[74:75], v8 offset:46336
    ds_read_b64_tr_b16 v[76:77], v9 offset:41216
    s_waitcnt lgkmcnt(14)
    ds_read_b64_tr_b16 v[78:79], v9 offset:46336
    s_waitcnt lgkmcnt(14)
    ds_read_b64_tr_b16 v[80:81], v6 offset:41472
    s_waitcnt lgkmcnt(14)
    ds_read_b64_tr_b16 v[82:83], v6 offset:46592
    s_waitcnt lgkmcnt(14)
    ds_read_b64_tr_b16 v[84:85], v7 offset:41472
    s_waitcnt lgkmcnt(14)
    ds_read_b64_tr_b16 v[86:87], v7 offset:46592
    s_add_u32 m0, s62, 98304
    s_add_u32 s66, s98, 270336
    buffer_load_dwordx4 v93, s[36:39], s66 offen nt lds
    buffer_load_dwordx4 v94, s[36:39], s66 offen offset:1024 nt lds
    s_add_u32 m0, s63, 20480
    s_add_u32 s66, s13, 1
    s_and_b32 s66, s66, 3
    s_mul_i32 s66, s66, 20480
    s_mul_i32 s67, s15, 640
    s_add_u32 s66, s66, s67
    s_add_u32 s66, s66, 245760
    buffer_load_dwordx4 v1, s[48:51], s66 offen lds
    buffer_load_dwordx4 v2, s[48:51], s66 offen offset:1024 lds
    buffer_load_dwordx4 v3, s[48:51], s66 offen offset:2048 lds
    buffer_load_dwordx4 v88, s[48:51], s66 offen offset:3072 lds
    s_add_u32 m0, s63, 24576
    s_nop 0
    buffer_load_dwordx4 v89, s[48:51], s66 offen lds
    s_add_u32 m0, s62, 106496
    s_add_u32 s66, s98, 294912
    buffer_load_dwordx4 v93, s[36:39], s66 offen nt lds
    buffer_load_dwordx4 v94, s[36:39], s66 offen offset:1024 nt lds
    v_mfma_f32_32x32x16_bf16 v[96:111], v[48:51], v[40:43], v[96:111]
    v_mfma_f32_32x32x16_bf16 v[112:127], v[52:55], v[40:43], v[112:127]
    s_waitcnt lgkmcnt(14)
    v_mfma_f32_32x32x16_bf16 v[128:143], v[56:59], v[40:43], v[128:143]
    s_waitcnt lgkmcnt(12)
    v_mfma_f32_32x32x16_bf16 v[144:159], v[60:63], v[40:43], v[144:159]
    s_waitcnt lgkmcnt(10)
    v_mfma_f32_32x32x16_bf16 v[160:175], v[64:67], v[40:43], v[160:175]
    s_waitcnt lgkmcnt(8)
    v_mfma_f32_32x32x16_bf16 v[176:191], v[68:71], v[40:43], v[176:191]
    s_waitcnt lgkmcnt(6)
    v_mfma_f32_32x32x16_bf16 v[192:207], v[72:75], v[40:43], v[192:207]
    s_waitcnt lgkmcnt(4)
    v_mfma_f32_32x32x16_bf16 v[208:223], v[76:79], v[40:43], v[208:223]
    s_waitcnt lgkmcnt(2)
    v_mfma_f32_32x32x16_bf16 v[224:239], v[80:83], v[40:43], v[224:239]
    s_waitcnt lgkmcnt(0)
    v_mfma_f32_32x32x16_bf16 v[240:255], v[84:87], v[40:43], v[240:255]
    s_waitcnt vmcnt(22)
    s_waitcnt vmcnt(20)
    s_barrier
    ds_read_b64_tr_b16 v[48:49], v16 offset:0
    ds_read_b64_tr_b16 v[50:51], v16 offset:5120
    ds_read_b64_tr_b16 v[52:53], v17 offset:0
    ds_read_b64_tr_b16 v[54:55], v17 offset:5120
    ds_read_b64_tr_b16 v[56:57], v18 offset:0
    ds_read_b64_tr_b16 v[58:59], v18 offset:5120
    ds_read_b64_tr_b16 v[60:61], v19 offset:0
    ds_read_b64_tr_b16 v[62:63], v19 offset:5120
    ds_read_b64_tr_b16 v[64:65], v16 offset:256
    ds_read_b64_tr_b16 v[66:67], v16 offset:5376
    ds_read_b64_tr_b16 v[68:69], v17 offset:256
    ds_read_b64_tr_b16 v[70:71], v17 offset:5376
    ds_read_b64_tr_b16 v[72:73], v18 offset:256
    ds_read_b64_tr_b16 v[74:75], v18 offset:5376
    ds_read_b64_tr_b16 v[76:77], v19 offset:256
    s_waitcnt lgkmcnt(14)
    ds_read_b64_tr_b16 v[78:79], v19 offset:5376
    s_waitcnt lgkmcnt(14)
    ds_read_b64_tr_b16 v[80:81], v16 offset:512
    s_waitcnt lgkmcnt(14)
    ds_read_b64_tr_b16 v[82:83], v16 offset:5632
    s_waitcnt lgkmcnt(14)
    ds_read_b64_tr_b16 v[84:85], v17 offset:512
    s_waitcnt lgkmcnt(14)
    ds_read_b64_tr_b16 v[86:87], v17 offset:5632
    s_add_u32 m0, s62, 114688
    s_add_u32 s66, s98, 319488
    buffer_load_dwordx4 v93, s[36:39], s66 offen nt lds
    buffer_load_dwordx4 v94, s[36:39], s66 offen offset:1024 nt lds
    s_add_u32 m0, s63, 40960
    s_add_u32 s66, s13, 2
    s_and_b32 s66, s66, 3
    s_mul_i32 s66, s66, 20480
    s_mul_i32 s67, s15, 640
    s_add_u32 s66, s66, s67
    s_add_u32 s66, s66, 245760
    buffer_load_dwordx4 v1, s[48:51], s66 offen lds
    buffer_load_dwordx4 v2, s[48:51], s66 offen offset:1024 lds
    buffer_load_dwordx4 v3, s[48:51], s66 offen offset:2048 lds
    buffer_load_dwordx4 v88, s[48:51], s66 offen offset:3072 lds
    s_add_u32 m0, s63, 45056
    s_nop 0
    buffer_load_dwordx4 v89, s[48:51], s66 offen lds
    s_add_u32 m0, s62, 122880
    s_add_u32 s66, s98, 344064
    buffer_load_dwordx4 v93, s[36:39], s66 offen nt lds
    buffer_load_dwordx4 v94, s[36:39], s66 offen offset:1024 nt lds
    v_mfma_f32_32x32x16_bf16 v[96:111], v[48:51], v[44:47], v[96:111]
    v_mfma_f32_32x32x16_bf16 v[112:127], v[52:55], v[44:47], v[112:127]
    s_waitcnt lgkmcnt(14)
    v_mfma_f32_32x32x16_bf16 v[128:143], v[56:59], v[44:47], v[128:143]
    s_waitcnt lgkmcnt(12)
    v_mfma_f32_32x32x16_bf16 v[144:159], v[60:63], v[44:47], v[144:159]
    s_waitcnt lgkmcnt(10)
    v_mfma_f32_32x32x16_bf16 v[160:175], v[64:67], v[44:47], v[160:175]
    s_waitcnt lgkmcnt(8)
    v_mfma_f32_32x32x16_bf16 v[176:191], v[68:71], v[44:47], v[176:191]
    s_waitcnt lgkmcnt(6)
    v_mfma_f32_32x32x16_bf16 v[192:207], v[72:75], v[44:47], v[192:207]
    s_waitcnt lgkmcnt(4)
    v_mfma_f32_32x32x16_bf16 v[208:223], v[76:79], v[44:47], v[208:223]
    s_waitcnt lgkmcnt(2)
    v_mfma_f32_32x32x16_bf16 v[224:239], v[80:83], v[44:47], v[224:239]
    s_waitcnt lgkmcnt(0)
    v_mfma_f32_32x32x16_bf16 v[240:255], v[84:87], v[44:47], v[240:255]
    s_waitcnt vmcnt(27)
    s_waitcnt vmcnt(25)
    s_waitcnt vmcnt(20)
    s_barrier
    ds_read_b128 v[32:35], v10 offset:0
    ds_read_b128 v[36:39], v11 offset:0
    ds_read_b128 v[40:43], v12 offset:0
    ds_read_b128 v[44:47], v13 offset:0
    ds_read_b64_tr_b16 v[48:49], v6 offset:0
    ds_read_b64_tr_b16 v[50:51], v6 offset:5120
    ds_read_b64_tr_b16 v[52:53], v7 offset:0
    ds_read_b64_tr_b16 v[54:55], v7 offset:5120
    ds_read_b64_tr_b16 v[56:57], v8 offset:0
    ds_read_b64_tr_b16 v[58:59], v8 offset:5120
    ds_read_b64_tr_b16 v[60:61], v9 offset:0
    ds_read_b64_tr_b16 v[62:63], v9 offset:5120
    ds_read_b64_tr_b16 v[64:65], v6 offset:256
    ds_read_b64_tr_b16 v[66:67], v6 offset:5376
    ds_read_b64_tr_b16 v[68:69], v7 offset:256
    s_waitcnt lgkmcnt(14)
    ds_read_b64_tr_b16 v[70:71], v7 offset:5376
    s_waitcnt lgkmcnt(14)
    ds_read_b64_tr_b16 v[72:73], v8 offset:256
    s_waitcnt lgkmcnt(14)
    ds_read_b64_tr_b16 v[74:75], v8 offset:5376
    s_waitcnt lgkmcnt(14)
    ds_read_b64_tr_b16 v[76:77], v9 offset:256
    s_waitcnt lgkmcnt(14)
    ds_read_b64_tr_b16 v[78:79], v9 offset:5376
    s_waitcnt lgkmcnt(14)
    ds_read_b64_tr_b16 v[80:81], v6 offset:512
    s_waitcnt lgkmcnt(14)
    ds_read_b64_tr_b16 v[82:83], v6 offset:5632
    s_waitcnt lgkmcnt(14)
    ds_read_b64_tr_b16 v[84:85], v7 offset:512
    s_waitcnt lgkmcnt(14)
    ds_read_b64_tr_b16 v[86:87], v7 offset:5632
    s_add_u32 m0, s62, 131072
    s_add_u32 s66, s98, 368640
    buffer_load_dwordx4 v93, s[36:39], s66 offen nt lds
    buffer_load_dwordx4 v94, s[36:39], s66 offen offset:1024 nt lds
    s_add_u32 m0, s63, 61440
    s_add_u32 s66, s13, 3
    s_and_b32 s66, s66, 3
    s_mul_i32 s66, s66, 20480
    s_mul_i32 s67, s15, 640
    s_add_u32 s66, s66, s67
    s_add_u32 s66, s66, 245760
    buffer_load_dwordx4 v1, s[48:51], s66 offen lds
    buffer_load_dwordx4 v2, s[48:51], s66 offen offset:1024 lds
    buffer_load_dwordx4 v3, s[48:51], s66 offen offset:2048 lds
    buffer_load_dwordx4 v88, s[48:51], s66 offen offset:3072 lds
    s_add_u32 m0, s63, 65536
    s_nop 0
    buffer_load_dwordx4 v89, s[48:51], s66 offen lds
    v_mfma_f32_32x32x16_bf16 v[96:111], v[48:51], v[32:35], v[96:111]
    v_mfma_f32_32x32x16_bf16 v[112:127], v[52:55], v[32:35], v[112:127]
    s_waitcnt lgkmcnt(14)
    v_mfma_f32_32x32x16_bf16 v[128:143], v[56:59], v[32:35], v[128:143]
    s_waitcnt lgkmcnt(12)
    v_mfma_f32_32x32x16_bf16 v[144:159], v[60:63], v[32:35], v[144:159]
    s_waitcnt lgkmcnt(10)
    v_mfma_f32_32x32x16_bf16 v[160:175], v[64:67], v[32:35], v[160:175]
    s_waitcnt lgkmcnt(8)
    v_mfma_f32_32x32x16_bf16 v[176:191], v[68:71], v[32:35], v[176:191]
    s_waitcnt lgkmcnt(6)
    v_mfma_f32_32x32x16_bf16 v[192:207], v[72:75], v[32:35], v[192:207]
    s_waitcnt lgkmcnt(4)
    v_mfma_f32_32x32x16_bf16 v[208:223], v[76:79], v[32:35], v[208:223]
    s_waitcnt lgkmcnt(2)
    v_mfma_f32_32x32x16_bf16 v[224:239], v[80:83], v[32:35], v[224:239]
    s_waitcnt lgkmcnt(0)
    v_mfma_f32_32x32x16_bf16 v[240:255], v[84:87], v[32:35], v[240:255]
    s_waitcnt vmcnt(25)
    s_waitcnt vmcnt(23)
    s_waitcnt vmcnt(18)
    s_barrier
    ds_read_b64_tr_b16 v[48:49], v6 offset:20480
    ds_read_b64_tr_b16 v[50:51], v6 offset:25600
    ds_read_b64_tr_b16 v[52:53], v7 offset:20480
    ds_read_b64_tr_b16 v[54:55], v7 offset:25600
    ds_read_b64_tr_b16 v[56:57], v8 offset:20480
    ds_read_b64_tr_b16 v[58:59], v8 offset:25600
    ds_read_b64_tr_b16 v[60:61], v9 offset:20480
    ds_read_b64_tr_b16 v[62:63], v9 offset:25600
    ds_read_b64_tr_b16 v[64:65], v6 offset:20736
    ds_read_b64_tr_b16 v[66:67], v6 offset:25856
    ds_read_b64_tr_b16 v[68:69], v7 offset:20736
    ds_read_b64_tr_b16 v[70:71], v7 offset:25856
    ds_read_b64_tr_b16 v[72:73], v8 offset:20736
    ds_read_b64_tr_b16 v[74:75], v8 offset:25856
    ds_read_b64_tr_b16 v[76:77], v9 offset:20736
    s_waitcnt lgkmcnt(14)
    ds_read_b64_tr_b16 v[78:79], v9 offset:25856
    s_waitcnt lgkmcnt(14)
    ds_read_b64_tr_b16 v[80:81], v6 offset:20992
    s_waitcnt lgkmcnt(14)
    ds_read_b64_tr_b16 v[82:83], v6 offset:26112
    s_waitcnt lgkmcnt(14)
    ds_read_b64_tr_b16 v[84:85], v7 offset:20992
    s_waitcnt lgkmcnt(14)
    ds_read_b64_tr_b16 v[86:87], v7 offset:26112
    s_add_u32 m0, s63, 139264
    s_add_u32 s66, s13, 0
    s_and_b32 s66, s66, 3
    s_mul_i32 s66, s66, 20480
    s_mul_i32 s67, s98, 640
    s_add_u32 s66, s66, s67
    s_add_u32 s66, s66, 245760
    buffer_load_dwordx4 v1, s[48:51], s66 offen lds
    buffer_load_dwordx4 v2, s[48:51], s66 offen offset:1024 lds
    buffer_load_dwordx4 v3, s[48:51], s66 offen offset:2048 lds
    buffer_load_dwordx4 v88, s[48:51], s66 offen offset:3072 lds
    s_add_u32 m0, s63, 143360
    s_nop 0
    buffer_load_dwordx4 v89, s[48:51], s66 offen lds
    s_add_u32 m0, s63, 0
    s_add_u32 s66, s13, 1
    s_and_b32 s66, s66, 3
    s_mul_i32 s66, s66, 20480
    s_mul_i32 s67, s98, 640
    s_add_u32 s66, s66, s67
    s_add_u32 s66, s66, 245760
    buffer_load_dwordx4 v1, s[48:51], s66 offen lds
    buffer_load_dwordx4 v2, s[48:51], s66 offen offset:1024 lds
    buffer_load_dwordx4 v3, s[48:51], s66 offen offset:2048 lds
    buffer_load_dwordx4 v88, s[48:51], s66 offen offset:3072 lds
    s_add_u32 m0, s63, 4096
    s_nop 0
    buffer_load_dwordx4 v89, s[48:51], s66 offen lds
    v_mfma_f32_32x32x16_bf16 v[96:111], v[48:51], v[36:39], v[96:111]
    v_mfma_f32_32x32x16_bf16 v[112:127], v[52:55], v[36:39], v[112:127]
    s_waitcnt lgkmcnt(14)
    v_mfma_f32_32x32x16_bf16 v[128:143], v[56:59], v[36:39], v[128:143]
    s_waitcnt lgkmcnt(12)
    v_mfma_f32_32x32x16_bf16 v[144:159], v[60:63], v[36:39], v[144:159]
    s_waitcnt lgkmcnt(10)
    v_mfma_f32_32x32x16_bf16 v[160:175], v[64:67], v[36:39], v[160:175]
    s_waitcnt lgkmcnt(8)
    v_mfma_f32_32x32x16_bf16 v[176:191], v[68:71], v[36:39], v[176:191]
    s_waitcnt lgkmcnt(6)
    v_mfma_f32_32x32x16_bf16 v[192:207], v[72:75], v[36:39], v[192:207]
    s_waitcnt lgkmcnt(4)
    v_mfma_f32_32x32x16_bf16 v[208:223], v[76:79], v[36:39], v[208:223]
    s_waitcnt lgkmcnt(2)
    v_mfma_f32_32x32x16_bf16 v[224:239], v[80:83], v[36:39], v[224:239]
    s_waitcnt lgkmcnt(0)
    v_mfma_f32_32x32x16_bf16 v[240:255], v[84:87], v[36:39], v[240:255]
    s_waitcnt vmcnt(26)
    s_waitcnt vmcnt(24)
    s_waitcnt vmcnt(19)
    s_barrier
    ds_read_b64_tr_b16 v[48:49], v6 offset:40960
    ds_read_b64_tr_b16 v[50:51], v6 offset:46080
    ds_read_b64_tr_b16 v[52:53], v7 offset:40960
    ds_read_b64_tr_b16 v[54:55], v7 offset:46080
    ds_read_b64_tr_b16 v[56:57], v8 offset:40960
    ds_read_b64_tr_b16 v[58:59], v8 offset:46080
    ds_read_b64_tr_b16 v[60:61], v9 offset:40960
    ds_read_b64_tr_b16 v[62:63], v9 offset:46080
    ds_read_b64_tr_b16 v[64:65], v6 offset:41216
    ds_read_b64_tr_b16 v[66:67], v6 offset:46336
    ds_read_b64_tr_b16 v[68:69], v7 offset:41216
    ds_read_b64_tr_b16 v[70:71], v7 offset:46336
    ds_read_b64_tr_b16 v[72:73], v8 offset:41216
    ds_read_b64_tr_b16 v[74:75], v8 offset:46336
    ds_read_b64_tr_b16 v[76:77], v9 offset:41216
    s_waitcnt lgkmcnt(14)
    ds_read_b64_tr_b16 v[78:79], v9 offset:46336
    s_waitcnt lgkmcnt(14)
    ds_read_b64_tr_b16 v[80:81], v6 offset:41472
    s_waitcnt lgkmcnt(14)
    ds_read_b64_tr_b16 v[82:83], v6 offset:46592
    s_waitcnt lgkmcnt(14)
    ds_read_b64_tr_b16 v[84:85], v7 offset:41472
    s_waitcnt lgkmcnt(14)
    ds_read_b64_tr_b16 v[86:87], v7 offset:46592
    s_add_u32 m0, s63, 20480
    s_add_u32 s66, s13, 2
    s_and_b32 s66, s66, 3
    s_mul_i32 s66, s66, 20480
    s_mul_i32 s67, s98, 640
    s_add_u32 s66, s66, s67
    s_add_u32 s66, s66, 245760
    buffer_load_dwordx4 v1, s[48:51], s66 offen lds
    buffer_load_dwordx4 v2, s[48:51], s66 offen offset:1024 lds
    buffer_load_dwordx4 v3, s[48:51], s66 offen offset:2048 lds
    buffer_load_dwordx4 v88, s[48:51], s66 offen offset:3072 lds
    s_add_u32 m0, s63, 24576
    s_nop 0
    buffer_load_dwordx4 v89, s[48:51], s66 offen lds
    v_mfma_f32_32x32x16_bf16 v[96:111], v[48:51], v[40:43], v[96:111]
    v_mfma_f32_32x32x16_bf16 v[112:127], v[52:55], v[40:43], v[112:127]
    s_waitcnt lgkmcnt(14)
    v_mfma_f32_32x32x16_bf16 v[128:143], v[56:59], v[40:43], v[128:143]
    s_waitcnt lgkmcnt(12)
    v_mfma_f32_32x32x16_bf16 v[144:159], v[60:63], v[40:43], v[144:159]
    s_waitcnt lgkmcnt(10)
    v_mfma_f32_32x32x16_bf16 v[160:175], v[64:67], v[40:43], v[160:175]
    s_waitcnt lgkmcnt(8)
    v_mfma_f32_32x32x16_bf16 v[176:191], v[68:71], v[40:43], v[176:191]
    s_waitcnt lgkmcnt(6)
    v_mfma_f32_32x32x16_bf16 v[192:207], v[72:75], v[40:43], v[192:207]
    s_waitcnt lgkmcnt(4)
    v_mfma_f32_32x32x16_bf16 v[208:223], v[76:79], v[40:43], v[208:223]
    s_waitcnt lgkmcnt(2)
    v_mfma_f32_32x32x16_bf16 v[224:239], v[80:83], v[40:43], v[224:239]
    s_waitcnt lgkmcnt(0)
    v_mfma_f32_32x32x16_bf16 v[240:255], v[84:87], v[40:43], v[240:255]
    s_waitcnt vmcnt(22)
    s_waitcnt vmcnt(20)
    s_waitcnt vmcnt(15)
    s_barrier
    ds_read_b64_tr_b16 v[48:49], v16 offset:0
    ds_read_b64_tr_b16 v[50:51], v16 offset:5120
    ds_read_b64_tr_b16 v[52:53], v17 offset:0
    ds_read_b64_tr_b16 v[54:55], v17 offset:5120
    ds_read_b64_tr_b16 v[56:57], v18 offset:0
    ds_read_b64_tr_b16 v[58:59], v18 offset:5120
    ds_read_b64_tr_b16 v[60:61], v19 offset:0
    ds_read_b64_tr_b16 v[62:63], v19 offset:5120
    ds_read_b64_tr_b16 v[64:65], v16 offset:256
    ds_read_b64_tr_b16 v[66:67], v16 offset:5376
    ds_read_b64_tr_b16 v[68:69], v17 offset:256
    ds_read_b64_tr_b16 v[70:71], v17 offset:5376
    ds_read_b64_tr_b16 v[72:73], v18 offset:256
    ds_read_b64_tr_b16 v[74:75], v18 offset:5376
    ds_read_b64_tr_b16 v[76:77], v19 offset:256
    s_waitcnt lgkmcnt(14)
    ds_read_b64_tr_b16 v[78:79], v19 offset:5376
    s_waitcnt lgkmcnt(14)
    ds_read_b64_tr_b16 v[80:81], v16 offset:512
    s_waitcnt lgkmcnt(14)
    ds_read_b64_tr_b16 v[82:83], v16 offset:5632
    s_waitcnt lgkmcnt(14)
    ds_read_b64_tr_b16 v[84:85], v17 offset:512
    s_waitcnt lgkmcnt(14)
    ds_read_b64_tr_b16 v[86:87], v17 offset:5632
    s_add_u32 m0, s63, 40960
    s_add_u32 s66, s13, 3
    s_and_b32 s66, s66, 3
    s_mul_i32 s66, s66, 20480
    s_mul_i32 s67, s98, 640
    s_add_u32 s66, s66, s67
    s_add_u32 s66, s66, 245760
    buffer_load_dwordx4 v1, s[48:51], s66 offen lds
    buffer_load_dwordx4 v2, s[48:51], s66 offen offset:1024 lds
    buffer_load_dwordx4 v3, s[48:51], s66 offen offset:2048 lds
    buffer_load_dwordx4 v88, s[48:51], s66 offen offset:3072 lds
    s_add_u32 m0, s63, 45056
    s_nop 0
    buffer_load_dwordx4 v89, s[48:51], s66 offen lds
    v_mfma_f32_32x32x16_bf16 v[96:111], v[48:51], v[44:47], v[96:111]
    v_mfma_f32_32x32x16_bf16 v[112:127], v[52:55], v[44:47], v[112:127]
    s_waitcnt lgkmcnt(14)
    v_mfma_f32_32x32x16_bf16 v[128:143], v[56:59], v[44:47], v[128:143]
    s_waitcnt lgkmcnt(12)
    v_mfma_f32_32x32x16_bf16 v[144:159], v[60:63], v[44:47], v[144:159]
    s_waitcnt lgkmcnt(10)
    v_mfma_f32_32x32x16_bf16 v[160:175], v[64:67], v[44:47], v[160:175]
    s_waitcnt lgkmcnt(8)
    v_mfma_f32_32x32x16_bf16 v[176:191], v[68:71], v[44:47], v[176:191]
    s_waitcnt lgkmcnt(6)
    v_mfma_f32_32x32x16_bf16 v[192:207], v[72:75], v[44:47], v[192:207]
    s_waitcnt lgkmcnt(4)
    v_mfma_f32_32x32x16_bf16 v[208:223], v[76:79], v[44:47], v[208:223]
    s_waitcnt lgkmcnt(2)
    v_mfma_f32_32x32x16_bf16 v[224:239], v[80:83], v[44:47], v[224:239]
    s_waitcnt lgkmcnt(0)
    v_mfma_f32_32x32x16_bf16 v[240:255], v[84:87], v[44:47], v[240:255]
    s_waitcnt vmcnt(15)
    s_waitcnt vmcnt(10)
    s_waitcnt vmcnt(5)
    s_waitcnt vmcnt(0)
    s_barrier
    ds_read_b128 v[32:35], v10 offset:0
    ds_read_b128 v[36:39], v11 offset:0
    ds_read_b128 v[40:43], v12 offset:0
    ds_read_b128 v[44:47], v13 offset:0
    v_lshlrev_b32 v14, 4, v0
    s_mul_i32 s68, s4, 20480
    v_add_u32 v20, 139264, v6
    v_add_u32 v21, 139264, v7
    v_add_u32 v22, 139264, v8
    v_add_u32 v23, 139264, v9
    ds_read_b64_tr_b16 v[48:49], v20 offset:0
    ds_read_b64_tr_b16 v[50:51], v20 offset:5120
    ds_read_b64_tr_b16 v[52:53], v6 offset:0
    ds_read_b64_tr_b16 v[54:55], v6 offset:5120
    ds_read_b64_tr_b16 v[56:57], v6 offset:20480
    ds_read_b64_tr_b16 v[58:59], v6 offset:25600
    ds_read_b64_tr_b16 v[60:61], v6 offset:40960
    ds_read_b64_tr_b16 v[62:63], v6 offset:46080
    ds_read_b64_tr_b16 v[64:65], v21 offset:0
    ds_read_b64_tr_b16 v[66:67], v21 offset:5120
    ds_read_b64_tr_b16 v[68:69], v7 offset:0
    s_waitcnt lgkmcnt(14)
    ds_read_b64_tr_b16 v[70:71], v7 offset:5120
    s_waitcnt lgkmcnt(14)
    ds_read_b64_tr_b16 v[72:73], v7 offset:20480
    s_waitcnt lgkmcnt(14)
    ds_read_b64_tr_b16 v[74:75], v7 offset:25600
    s_waitcnt lgkmcnt(14)
    ds_read_b64_tr_b16 v[76:77], v7 offset:40960
    s_waitcnt lgkmcnt(14)
    ds_read_b64_tr_b16 v[78:79], v7 offset:46080
    s_waitcnt lgkmcnt(14)
    ds_read_b64_tr_b16 v[80:81], v22 offset:0
    s_waitcnt lgkmcnt(14)
    ds_read_b64_tr_b16 v[82:83], v22 offset:5120
    s_waitcnt lgkmcnt(14)
    ds_read_b64_tr_b16 v[84:85], v8 offset:0
    s_waitcnt lgkmcnt(14)
    ds_read_b64_tr_b16 v[86:87], v8 offset:5120
    s_waitcnt lgkmcnt(14)
    ds_read_b64_tr_b16 v[88:89], v8 offset:20480
    s_waitcnt lgkmcnt(14)
    ds_read_b64_tr_b16 v[90:91], v8 offset:25600
    s_waitcnt lgkmcnt(14)
    ds_read_b64_tr_b16 v[92:93], v8 offset:40960
    s_waitcnt lgkmcnt(14)
    ds_read_b64_tr_b16 v[94:95], v8 offset:46080
    v_mfma_f32_32x32x16_bf16 v[96:111], v[48:51], v[32:35], v[96:111]
    v_mfma_f32_32x32x16_bf16 v[96:111], v[52:55], v[36:39], v[96:111]
    v_mfma_f32_32x32x16_bf16 v[96:111], v[56:59], v[40:43], v[96:111]
    v_mfma_f32_32x32x16_bf16 v[96:111], v[60:63], v[44:47], v[96:111]
    s_waitcnt lgkmcnt(14)
    ds_read_b64_tr_b16 v[48:49], v23 offset:0
    s_waitcnt lgkmcnt(14)
    ds_read_b64_tr_b16 v[50:51], v23 offset:5120
    s_waitcnt lgkmcnt(14)
    ds_read_b64_tr_b16 v[52:53], v9 offset:0
    s_waitcnt lgkmcnt(14)
    ds_read_b64_tr_b16 v[54:55], v9 offset:5120
    s_waitcnt lgkmcnt(14)
    ds_read_b64_tr_b16 v[56:57], v9 offset:20480
    s_waitcnt lgkmcnt(14)
    ds_read_b64_tr_b16 v[58:59], v9 offset:25600
    s_waitcnt lgkmcnt(14)
    ds_read_b64_tr_b16 v[60:61], v9 offset:40960
    s_waitcnt lgkmcnt(14)
    ds_read_b64_tr_b16 v[62:63], v9 offset:46080
    v_mfma_f32_32x32x16_bf16 v[112:127], v[64:67], v[32:35], v[112:127]
    v_mfma_f32_32x32x16_bf16 v[112:127], v[68:71], v[36:39], v[112:127]
    v_mfma_f32_32x32x16_bf16 v[112:127], v[72:75], v[40:43], v[112:127]
    v_mfma_f32_32x32x16_bf16 v[112:127], v[76:79], v[44:47], v[112:127]
    s_waitcnt lgkmcnt(14)
    ds_read_b64_tr_b16 v[64:65], v20 offset:256
    s_waitcnt lgkmcnt(14)
    ds_read_b64_tr_b16 v[66:67], v20 offset:5376
    s_waitcnt lgkmcnt(14)
    ds_read_b64_tr_b16 v[68:69], v6 offset:256
    s_waitcnt lgkmcnt(14)
    ds_read_b64_tr_b16 v[70:71], v6 offset:5376
    s_waitcnt lgkmcnt(14)
    ds_read_b64_tr_b16 v[72:73], v6 offset:20736
    s_waitcnt lgkmcnt(14)
    ds_read_b64_tr_b16 v[74:75], v6 offset:25856
    s_waitcnt lgkmcnt(14)
    ds_read_b64_tr_b16 v[76:77], v6 offset:41216
    s_waitcnt lgkmcnt(14)
    ds_read_b64_tr_b16 v[78:79], v6 offset:46336
    v_mfma_f32_32x32x16_bf16 v[128:143], v[80:83], v[32:35], v[128:143]
    v_mfma_f32_32x32x16_bf16 v[128:143], v[84:87], v[36:39], v[128:143]
    v_mfma_f32_32x32x16_bf16 v[128:143], v[88:91], v[40:43], v[128:143]
    v_mfma_f32_32x32x16_bf16 v[128:143], v[92:95], v[44:47], v[128:143]
    v_cvt_pk_bf16_f32 v96, v96, v97
    v_cvt_pk_bf16_f32 v97, v98, v99
    v_cvt_pk_bf16_f32 v98, v100, v101
    v_cvt_pk_bf16_f32 v99, v102, v103
    s_add_u32 s69, s68, 0
    buffer_store_dwordx4 v[96:99], v14, s[52:55], s69 offen
    v_cvt_pk_bf16_f32 v104, v104, v105
    v_cvt_pk_bf16_f32 v105, v106, v107
    v_cvt_pk_bf16_f32 v106, v108, v109
    v_cvt_pk_bf16_f32 v107, v110, v111
    s_add_u32 s69, s68, 1024
    buffer_store_dwordx4 v[104:107], v14, s[52:55], s69 offen
    s_waitcnt lgkmcnt(14)
    ds_read_b64_tr_b16 v[80:81], v21 offset:256
    s_waitcnt lgkmcnt(14)
    ds_read_b64_tr_b16 v[82:83], v21 offset:5376
    s_waitcnt lgkmcnt(14)
    ds_read_b64_tr_b16 v[84:85], v7 offset:256
    s_waitcnt lgkmcnt(14)
    ds_read_b64_tr_b16 v[86:87], v7 offset:5376
    s_waitcnt lgkmcnt(14)
    ds_read_b64_tr_b16 v[88:89], v7 offset:20736
    s_waitcnt lgkmcnt(14)
    ds_read_b64_tr_b16 v[90:91], v7 offset:25856
    s_waitcnt lgkmcnt(14)
    ds_read_b64_tr_b16 v[92:93], v7 offset:41216
    s_waitcnt lgkmcnt(14)
    ds_read_b64_tr_b16 v[94:95], v7 offset:46336
    v_mfma_f32_32x32x16_bf16 v[144:159], v[48:51], v[32:35], v[144:159]
    v_mfma_f32_32x32x16_bf16 v[144:159], v[52:55], v[36:39], v[144:159]
    v_mfma_f32_32x32x16_bf16 v[144:159], v[56:59], v[40:43], v[144:159]
    v_mfma_f32_32x32x16_bf16 v[144:159], v[60:63], v[44:47], v[144:159]
    v_cvt_pk_bf16_f32 v112, v112, v113
    v_cvt_pk_bf16_f32 v113, v114, v115
    v_cvt_pk_bf16_f32 v114, v116, v117
    v_cvt_pk_bf16_f32 v115, v118, v119
    s_add_u32 s69, s68, 2048
    buffer_store_dwordx4 v[112:115], v14, s[52:55], s69 offen
    v_cvt_pk_bf16_f32 v120, v120, v121
    v_cvt_pk_bf16_f32 v121, v122, v123
    v_cvt_pk_bf16_f32 v122, v124, v125
    v_cvt_pk_bf16_f32 v123, v126, v127
    s_add_u32 s69, s68, 3072
    buffer_store_dwordx4 v[120:123], v14, s[52:55], s69 offen
    s_waitcnt lgkmcnt(14)
    ds_read_b64_tr_b16 v[48:49], v22 offset:256
    s_waitcnt lgkmcnt(14)
    ds_read_b64_tr_b16 v[50:51], v22 offset:5376
    s_waitcnt lgkmcnt(14)
    ds_read_b64_tr_b16 v[52:53], v8 offset:256
    s_waitcnt lgkmcnt(14)
    ds_read_b64_tr_b16 v[54:55], v8 offset:5376
    s_waitcnt lgkmcnt(14)
    ds_read_b64_tr_b16 v[56:57], v8 offset:20736
    s_waitcnt lgkmcnt(14)
    ds_read_b64_tr_b16 v[58:59], v8 offset:25856
    s_waitcnt lgkmcnt(14)
    ds_read_b64_tr_b16 v[60:61], v8 offset:41216
    s_waitcnt lgkmcnt(14)
    ds_read_b64_tr_b16 v[62:63], v8 offset:46336
    v_mfma_f32_32x32x16_bf16 v[160:175], v[64:67], v[32:35], v[160:175]
    v_mfma_f32_32x32x16_bf16 v[160:175], v[68:71], v[36:39], v[160:175]
    v_mfma_f32_32x32x16_bf16 v[160:175], v[72:75], v[40:43], v[160:175]
    v_mfma_f32_32x32x16_bf16 v[160:175], v[76:79], v[44:47], v[160:175]
    v_cvt_pk_bf16_f32 v128, v128, v129
    v_cvt_pk_bf16_f32 v129, v130, v131
    v_cvt_pk_bf16_f32 v130, v132, v133
    v_cvt_pk_bf16_f32 v131, v134, v135
    s_add_u32 s69, s68, 4096
    buffer_store_dwordx4 v[128:131], v14, s[52:55], s69 offen
    v_cvt_pk_bf16_f32 v136, v136, v137
    v_cvt_pk_bf16_f32 v137, v138, v139
    v_cvt_pk_bf16_f32 v138, v140, v141
    v_cvt_pk_bf16_f32 v139, v142, v143
    s_add_u32 s69, s68, 5120
    buffer_store_dwordx4 v[136:139], v14, s[52:55], s69 offen
    s_waitcnt lgkmcnt(14)
    ds_read_b64_tr_b16 v[64:65], v23 offset:256
    s_waitcnt lgkmcnt(14)
    ds_read_b64_tr_b16 v[66:67], v23 offset:5376
    s_waitcnt lgkmcnt(14)
    ds_read_b64_tr_b16 v[68:69], v9 offset:256
    s_waitcnt lgkmcnt(14)
    ds_read_b64_tr_b16 v[70:71], v9 offset:5376
    s_waitcnt lgkmcnt(14)
    ds_read_b64_tr_b16 v[72:73], v9 offset:20736
    s_waitcnt lgkmcnt(14)
    ds_read_b64_tr_b16 v[74:75], v9 offset:25856
    s_waitcnt lgkmcnt(14)
    ds_read_b64_tr_b16 v[76:77], v9 offset:41216
    s_waitcnt lgkmcnt(14)
    ds_read_b64_tr_b16 v[78:79], v9 offset:46336
    v_mfma_f32_32x32x16_bf16 v[176:191], v[80:83], v[32:35], v[176:191]
    v_mfma_f32_32x32x16_bf16 v[176:191], v[84:87], v[36:39], v[176:191]
    v_mfma_f32_32x32x16_bf16 v[176:191], v[88:91], v[40:43], v[176:191]
    v_mfma_f32_32x32x16_bf16 v[176:191], v[92:95], v[44:47], v[176:191]
    v_cvt_pk_bf16_f32 v144, v144, v145
    v_cvt_pk_bf16_f32 v145, v146, v147
    v_cvt_pk_bf16_f32 v146, v148, v149
    v_cvt_pk_bf16_f32 v147, v150, v151
    s_add_u32 s69, s68, 6144
    buffer_store_dwordx4 v[144:147], v14, s[52:55], s69 offen
    v_cvt_pk_bf16_f32 v152, v152, v153
    v_cvt_pk_bf16_f32 v153, v154, v155
    v_cvt_pk_bf16_f32 v154, v156, v157
    v_cvt_pk_bf16_f32 v155, v158, v159
    s_add_u32 s69, s68, 7168
    buffer_store_dwordx4 v[152:155], v14, s[52:55], s69 offen
    s_waitcnt lgkmcnt(14)
    ds_read_b64_tr_b16 v[80:81], v20 offset:512
    s_waitcnt lgkmcnt(14)
    ds_read_b64_tr_b16 v[82:83], v20 offset:5632
    s_waitcnt lgkmcnt(14)
    ds_read_b64_tr_b16 v[84:85], v6 offset:512
    s_waitcnt lgkmcnt(14)
    ds_read_b64_tr_b16 v[86:87], v6 offset:5632
    s_waitcnt lgkmcnt(14)
    ds_read_b64_tr_b16 v[88:89], v6 offset:20992
    s_waitcnt lgkmcnt(14)
    ds_read_b64_tr_b16 v[90:91], v6 offset:26112
    s_waitcnt lgkmcnt(14)
    ds_read_b64_tr_b16 v[92:93], v6 offset:41472
    s_waitcnt lgkmcnt(14)
    ds_read_b64_tr_b16 v[94:95], v6 offset:46592
    v_mfma_f32_32x32x16_bf16 v[192:207], v[48:51], v[32:35], v[192:207]
    v_mfma_f32_32x32x16_bf16 v[192:207], v[52:55], v[36:39], v[192:207]
    v_mfma_f32_32x32x16_bf16 v[192:207], v[56:59], v[40:43], v[192:207]
    v_mfma_f32_32x32x16_bf16 v[192:207], v[60:63], v[44:47], v[192:207]
    v_cvt_pk_bf16_f32 v160, v160, v161
    v_cvt_pk_bf16_f32 v161, v162, v163
    v_cvt_pk_bf16_f32 v162, v164, v165
    v_cvt_pk_bf16_f32 v163, v166, v167
    s_add_u32 s69, s68, 8192
    buffer_store_dwordx4 v[160:163], v14, s[52:55], s69 offen
    v_cvt_pk_bf16_f32 v168, v168, v169
    v_cvt_pk_bf16_f32 v169, v170, v171
    v_cvt_pk_bf16_f32 v170, v172, v173
    v_cvt_pk_bf16_f32 v171, v174, v175
    s_add_u32 s69, s68, 9216
    buffer_store_dwordx4 v[168:171], v14, s[52:55], s69 offen
    s_waitcnt lgkmcnt(14)
    ds_read_b64_tr_b16 v[48:49], v21 offset:512
    s_waitcnt lgkmcnt(14)
    ds_read_b64_tr_b16 v[50:51], v21 offset:5632
    s_waitcnt lgkmcnt(14)
    ds_read_b64_tr_b16 v[52:53], v7 offset:512
    s_waitcnt lgkmcnt(14)
    ds_read_b64_tr_b16 v[54:55], v7 offset:5632
    s_waitcnt lgkmcnt(14)
    ds_read_b64_tr_b16 v[56:57], v7 offset:20992
    s_waitcnt lgkmcnt(14)
    ds_read_b64_tr_b16 v[58:59], v7 offset:26112
    s_waitcnt lgkmcnt(14)
    ds_read_b64_tr_b16 v[60:61], v7 offset:41472
    s_waitcnt lgkmcnt(14)
    ds_read_b64_tr_b16 v[62:63], v7 offset:46592
    v_mfma_f32_32x32x16_bf16 v[208:223], v[64:67], v[32:35], v[208:223]
    v_mfma_f32_32x32x16_bf16 v[208:223], v[68:71], v[36:39], v[208:223]
    v_mfma_f32_32x32x16_bf16 v[208:223], v[72:75], v[40:43], v[208:223]
    v_mfma_f32_32x32x16_bf16 v[208:223], v[76:79], v[44:47], v[208:223]
    v_cvt_pk_bf16_f32 v176, v176, v177
    v_cvt_pk_bf16_f32 v177, v178, v179
    v_cvt_pk_bf16_f32 v178, v180, v181
    v_cvt_pk_bf16_f32 v179, v182, v183
    s_add_u32 s69, s68, 10240
    buffer_store_dwordx4 v[176:179], v14, s[52:55], s69 offen
    v_cvt_pk_bf16_f32 v184, v184, v185
    v_cvt_pk_bf16_f32 v185, v186, v187
    v_cvt_pk_bf16_f32 v186, v188, v189
    v_cvt_pk_bf16_f32 v187, v190, v191
    s_add_u32 s69, s68, 11264
    buffer_store_dwordx4 v[184:187], v14, s[52:55], s69 offen
    s_waitcnt lgkmcnt(14)
    v_mfma_f32_32x32x16_bf16 v[224:239], v[80:83], v[32:35], v[224:239]
    s_waitcnt lgkmcnt(12)
    v_mfma_f32_32x32x16_bf16 v[224:239], v[84:87], v[36:39], v[224:239]
    s_waitcnt lgkmcnt(10)
    v_mfma_f32_32x32x16_bf16 v[224:239], v[88:91], v[40:43], v[224:239]
    s_waitcnt lgkmcnt(8)
    v_mfma_f32_32x32x16_bf16 v[224:239], v[92:95], v[44:47], v[224:239]
    v_cvt_pk_bf16_f32 v192, v192, v193
    v_cvt_pk_bf16_f32 v193, v194, v195
    v_cvt_pk_bf16_f32 v194, v196, v197
    v_cvt_pk_bf16_f32 v195, v198, v199
    s_add_u32 s69, s68, 12288
    buffer_store_dwordx4 v[192:195], v14, s[52:55], s69 offen
    v_cvt_pk_bf16_f32 v200, v200, v201
    v_cvt_pk_bf16_f32 v201, v202, v203
    v_cvt_pk_bf16_f32 v202, v204, v205
    v_cvt_pk_bf16_f32 v203, v206, v207
    s_add_u32 s69, s68, 13312
    buffer_store_dwordx4 v[200:203], v14, s[52:55], s69 offen
    s_waitcnt lgkmcnt(6)
    v_mfma_f32_32x32x16_bf16 v[240:255], v[48:51], v[32:35], v[240:255]
    s_waitcnt lgkmcnt(4)
    v_mfma_f32_32x32x16_bf16 v[240:255], v[52:55], v[36:39], v[240:255]
    s_waitcnt lgkmcnt(2)
    v_mfma_f32_32x32x16_bf16 v[240:255], v[56:59], v[40:43], v[240:255]
    s_waitcnt lgkmcnt(0)
    v_mfma_f32_32x32x16_bf16 v[240:255], v[60:63], v[44:47], v[240:255]
    v_cvt_pk_bf16_f32 v208, v208, v209
    v_cvt_pk_bf16_f32 v209, v210, v211
    v_cvt_pk_bf16_f32 v210, v212, v213
    v_cvt_pk_bf16_f32 v211, v214, v215
    s_add_u32 s69, s68, 14336
    buffer_store_dwordx4 v[208:211], v14, s[52:55], s69 offen
    v_cvt_pk_bf16_f32 v216, v216, v217
    v_cvt_pk_bf16_f32 v217, v218, v219
    v_cvt_pk_bf16_f32 v218, v220, v221
    v_cvt_pk_bf16_f32 v219, v222, v223
    s_add_u32 s69, s68, 15360
    buffer_store_dwordx4 v[216:219], v14, s[52:55], s69 offen
    v_cvt_pk_bf16_f32 v224, v224, v225
    v_cvt_pk_bf16_f32 v225, v226, v227
    v_cvt_pk_bf16_f32 v226, v228, v229
    v_cvt_pk_bf16_f32 v227, v230, v231
    s_add_u32 s69, s68, 16384
    buffer_store_dwordx4 v[224:227], v14, s[52:55], s69 offen
    v_cvt_pk_bf16_f32 v232, v232, v233
    v_cvt_pk_bf16_f32 v233, v234, v235
    v_cvt_pk_bf16_f32 v234, v236, v237
    v_cvt_pk_bf16_f32 v235, v238, v239
    s_add_u32 s69, s68, 17408
    buffer_store_dwordx4 v[232:235], v14, s[52:55], s69 offen
    v_cvt_pk_bf16_f32 v240, v240, v241
    v_cvt_pk_bf16_f32 v241, v242, v243
    v_cvt_pk_bf16_f32 v242, v244, v245
    v_cvt_pk_bf16_f32 v243, v246, v247
    s_add_u32 s69, s68, 18432
    buffer_store_dwordx4 v[240:243], v14, s[52:55], s69 offen
    v_cvt_pk_bf16_f32 v248, v248, v249
    v_cvt_pk_bf16_f32 v249, v250, v251
    v_cvt_pk_bf16_f32 v250, v252, v253
    v_cvt_pk_bf16_f32 v251, v254, v255
    s_add_u32 s69, s68, 19456
    buffer_store_dwordx4 v[248:251], v14, s[52:55], s69 offen
    s_endpgm
L_B:
    s_mul_i32 s66, s4, 20480
    v_lshrrev_b32 v27, 3, v0
    v_lshrrev_b32 v28, 4, v0
    v_xor_b32 v28, v28, v0
    v_and_b32 v28, 7, v28
    v_lshlrev_b32 v28, 4, v28
    v_mul_u32_u24 v27, 1280, v27
    v_add_u32 v27, v27, v28
    v_add_u32 v20, s66, v27
    v_lshrrev_b32 v27, 3, v0
    v_lshrrev_b32 v28, 4, v0
    v_add_u32 v28, 4, v28
    v_xor_b32 v28, v28, v0
    v_and_b32 v28, 7, v28
    v_lshlrev_b32 v28, 4, v28
    v_mul_u32_u24 v27, 1280, v27
    v_add_u32 v27, v27, v28
    v_add_u32 v27, 9216, v27
    v_add_u32 v21, s66, v27
    s_mul_i32 s66, s4, 98304
    s_mov_b32 s67, 12288
    v_add_u32 v27, 0, v0
    v_mul_u32_u24 v28, 171, v27
    v_lshrrev_b32 v28, 12, v28
    v_mul_u32_u24 v29, 24, v28
    v_sub_u32 v27, v27, v29
    v_and_b32 v29, 2, v28
    v_lshlrev_b32 v29, 1, v29
    v_xor_b32 v27, v27, v29
    v_lshlrev_b32 v27, 4, v27
    v_mul_lo_u32 v28, v28, s67
    v_add_u32 v27, v27, v28
    v_add_u32 v27, s66, v27
    v_mov_b32 v4, v27
    v_add_u32 v27, 64, v0
    v_mul_u32_u24 v28, 171, v27
    v_lshrrev_b32 v28, 12, v28
    v_mul_u32_u24 v29, 24, v28
    v_sub_u32 v27, v27, v29
    v_and_b32 v29, 2, v28
    v_lshlrev_b32 v29, 1, v29
    v_xor_b32 v27, v27, v29
    v_lshlrev_b32 v27, 4, v27
    v_mul_lo_u32 v28, v28, s67
    v_add_u32 v27, v27, v28
    v_add_u32 v27, s66, v27
    v_subrev_u32 v5, 1024, v27
    v_add_u32 v27, 128, v0
    v_mul_u32_u24 v28, 171, v27
    v_lshrrev_b32 v28, 12, v28
    v_mul_u32_u24 v29, 24, v28
    v_sub_u32 v27, v27, v29
    v_and_b32 v29, 2, v28
    v_lshlrev_b32 v29, 1, v29
    v_xor_b32 v27, v27, v29
    v_lshlrev_b32 v27, 4, v27
    v_mul_lo_u32 v28, v28, s67
    v_add_u32 v27, v27, v28
    v_add_u32 v27, s66, v27
    v_subrev_u32 v6, 2048, v27
    s_waitcnt lgkmcnt(0)
    s_add_u32 s44, s16, s58
    s_addc_u32 s45, s17, 0
    s_and_b32 s45, s45, 0xffff
    s_mov_b32 s46, 81920
    s_mov_b32 s47, 0x20000
    s_mov_b32 s40, s22
    s_and_b32 s41, s23, 0xffff
    s_mov_b32 s42, 7864320
    s_mov_b32 s43, 0x20000
    s_add_u32 s70, s7, 0
    s_sub_u32 s67, s70, 20
    s_cmp_ge_u32 s70, 20
    s_cselect_b32 s70, s67, s70
    s_lshl_b32 s66, s70, 6
    s_add_u32 m0, s62, 122880
    s_nop 0
    buffer_load_dwordx4 v20, s[44:47], s66 offen lds
    buffer_load_dwordx4 v21, s[44:47], s66 offen offset:1024 lds
    s_add_u32 s70, s7, 0
    s_sub_u32 s67, s70, 20
    s_cmp_ge_u32 s70, 20
    s_cselect_b32 s70, s67, s70
    s_mul_i32 s66, s70, 393216
    s_add_u32 s66, s66, s64
    s_add_u32 m0, s60, 0
    s_nop 0
    buffer_load_dwordx4 v4, s[40:43], s66 offen lds
    buffer_load_dwordx4 v5, s[40:43], s66 offen offset:1024 lds
    buffer_load_dwordx4 v6, s[40:43], s66 offen offset:2048 lds
    s_add_u32 s70, s7, 1
    s_sub_u32 s67, s70, 20
    s_cmp_ge_u32 s70, 20
    s_cselect_b32 s70, s67, s70
    s_mul_i32 s66, s70, 393216
    s_add_u32 s66, s66, s64
    s_add_u32 m0, s60, 12288
    s_nop 0
    buffer_load_dwordx4 v4, s[40:43], s66 offen lds
    buffer_load_dwordx4 v5, s[40:43], s66 offen offset:1024 lds
    buffer_load_dwordx4 v6, s[40:43], s66 offen offset:2048 lds
    s_add_u32 s70, s7, 2
    s_sub_u32 s67, s70, 20
    s_cmp_ge_u32 s70, 20
    s_cselect_b32 s70, s67, s70
    s_lshl_b32 s66, s70, 6
    s_add_u32 m0, s62, 131072
    s_nop 0
    buffer_load_dwordx4 v20, s[44:47], s66 offen lds
    buffer_load_dwordx4 v21, s[44:47], s66 offen offset:1024 lds
    s_add_u32 s70, s7, 4
    s_sub_u32 s67, s70, 20
    s_cmp_ge_u32 s70, 20
    s_cselect_b32 s70, s67, s70
    s_lshl_b32 s66, s70, 6
    s_add_u32 m0, s62, 139264
    s_nop 0
    buffer_load_dwordx4 v20, s[44:47], s66 offen lds
    buffer_load_dwordx4 v21, s[44:47], s66 offen offset:1024 lds
    s_add_u32 s32, s18, s56
    s_addc_u32 s33, s19, 0
    s_and_b32 s33, s33, 0xffff
    s_mov_b32 s34, 393216
    s_mov_b32 s35, 0x20000
    s_add_u32 s36, s20, s56
    s_addc_u32 s37, s21, 0
    s_and_b32 s37, s37, 0xffff
    s_mov_b32 s38, 393216
    s_mov_b32 s39, 0x20000
    s_add_u32 s48, s24, s59
    s_addc_u32 s49, s25, 0
    s_and_b32 s49, s49, 0xffff
    s_mov_b32 s50, 491520
    s_mov_b32 s51, 0x20000
    s_add_u32 s52, s30, s57
    s_addc_u32 s53, s31, 0
    s_and_b32 s53, s53, 0xffff
    s_mov_b32 s54, 81920
    s_mov_b32 s55, 0x20000
    v_lshlrev_b32 v7, 4, v0
    s_lshl_b32 s66, s4, 2
    v_add_u32 v27, 0, v0
    v_mul_u32_u24 v27, 171, v27
    v_lshrrev_b32 v27, 13, v27
    v_add_u32 v27, s66, v27
    v_and_b32 v27, 7, v27
    v_xor_b32 v27, v27, v0
    v_lshlrev_b32 v27, 4, v27
    v_add_u32 v1, s60, v27
    v_add_u32 v27, 64, v0
    v_mul_u32_u24 v27, 171, v27
    v_lshrrev_b32 v27, 13, v27
    v_add_u32 v27, s66, v27
    v_and_b32 v27, 7, v27
    v_xor_b32 v27, v27, v0
    v_lshlrev_b32 v27, 4, v27
    v_add_u32 v2, s60, v27
    v_add_u32 v27, 128, v0
    v_mul_u32_u24 v27, 171, v27
    v_lshrrev_b32 v27, 13, v27
    v_add_u32 v27, s66, v27
    v_and_b32 v27, 7, v27
    v_xor_b32 v27, v27, v0
    v_lshlrev_b32 v27, 4, v27
    v_add_u32 v3, s60, v27
    s_mul_i32 s66, s4, 6144
    v_lshrrev_b32 v27, 3, v0
    v_and_b32 v28, 6, v27
    v_xor_b32 v28, v28, v0
    v_and_b32 v28, 7, v28
    v_lshlrev_b32 v28, 4, v28
    v_mul_u32_u24 v27, 384, v27
    v_add_u32 v27, v27, v28
    v_add_u32 v8, s66, v27
    v_add_u32 v9, 2048, v8
    v_and_b32 v27, 15, v0
    v_lshrrev_b32 v28, 1, v27
    v_lshrrev_b32 v29, 4, v0
    v_xor_b32 v29, v29, v28
    v_lshlrev_b32 v29, 4, v29
    v_mul_u32_u24 v10, 384, v27
    v_add_u32 v10, v10, v29
    v_xor_b32 v29, 64, v29
    v_mul_u32_u24 v11, 384, v27
    v_add_u32 v11, v11, v29
    v_lshlrev_b32 v29, 7, v27
    v_add_u32 v29, s62, v29
    v_add_u32 v29, 81920, v29
    v_lshrrev_b32 v24, 4, v0
    v_and_b32 v25, 1, v24
    v_lshlrev_b32 v25, 3, v25
    v_add_u32 v29, v29, v25
    v_lshrrev_b32 v24, 1, v24
    v_add_u32 v25, 0, v24
    v_xor_b32 v25, v25, v28
    v_lshlrev_b32 v25, 4, v25
    v_add_u32 v16, v29, v25
    v_add_u32 v25, 2, v24
    v_xor_b32 v25, v25, v28
    v_lshlrev_b32 v25, 4, v25
    v_add_u32 v17, v29, v25
    v_add_u32 v25, 4, v24
    v_xor_b32 v25, v25, v28
    v_lshlrev_b32 v25, 4, v25
    v_add_u32 v18, v29, v25
    v_add_u32 v25, 6, v24
    v_xor_b32 v25, v25, v28
    v_lshlrev_b32 v25, 4, v25
    v_add_u32 v19, v29, v25
    v_lshrrev_b32 v27, 2, v0
    v_and_b32 v28, 6, v27
    v_lshlrev_b32 v27, 7, v27
    v_and_b32 v29, 3, v0
    v_lshlrev_b32 v29, 3, v29
    v_add_u32 v27, v27, v29
    v_xor_b32 v29, 0, v28
    v_lshlrev_b32 v29, 4, v29
    v_add_u32 v12, v27, v29
    v_xor_b32 v29, 2, v28
    v_lshlrev_b32 v29, 4, v29
    v_add_u32 v13, v27, v29
    v_xor_b32 v29, 4, v28
    v_lshlrev_b32 v29, 4, v29
    v_add_u32 v14, v27, v29
    v_xor_b32 v29, 6, v28
    v_lshlrev_b32 v29, 4, v29
    v_add_u32 v15, v27, v29
    v_mov_b32 v32, 0x3f803f80
    v_mov_b32 v33, 0x3f803f80
    v_mov_b32 v34, 0x3f803f80
    v_mov_b32 v35, 0x3f803f80
    s_waitcnt vmcnt(7)
    s_waitcnt vmcnt(4)
    s_barrier
    s_add_u32 s70, s7, 2
    s_sub_u32 s67, s70, 20
    s_cmp_ge_u32 s70, 20
    s_cselect_b32 s70, s67, s70
    s_mul_i32 s66, s70, 393216
    s_add_u32 s66, s66, s64
    s_add_u32 m0, s60, 24576
    s_nop 0
    buffer_load_dwordx4 v4, s[40:43], s66 offen lds
    buffer_load_dwordx4 v5, s[40:43], s66 offen offset:1024 lds
    buffer_load_dwordx4 v6, s[40:43], s66 offen offset:2048 lds
    s_add_u32 s70, s7, 3
    s_sub_u32 s67, s70, 20
    s_cmp_ge_u32 s70, 20
    s_cselect_b32 s70, s67, s70
    s_mul_i32 s66, s70, 393216
    s_add_u32 s66, s66, s64
    s_add_u32 m0, s60, 36864
    s_nop 0
    buffer_load_dwordx4 v4, s[40:43], s66 offen lds
    buffer_load_dwordx4 v5, s[40:43], s66 offen offset:1024 lds
    buffer_load_dwordx4 v6, s[40:43], s66 offen offset:2048 lds
    s_add_u32 s70, s7, 6
    s_sub_u32 s67, s70, 20
    s_cmp_ge_u32 s70, 20
    s_cselect_b32 s70, s67, s70
    s_lshl_b32 s66, s70, 6
    s_add_u32 m0, s62, 147456
    s_nop 0
    buffer_load_dwordx4 v20, s[44:47], s66 offen lds
    buffer_load_dwordx4 v21, s[44:47], s66 offen offset:1024 lds
    s_add_u32 s70, s7, 8
    s_sub_u32 s67, s70, 20
    s_cmp_ge_u32 s70, 20
    s_cselect_b32 s70, s67, s70
    s_lshl_b32 s66, s70, 6
    s_add_u32 m0, s62, 155648
    s_nop 0
    buffer_load_dwordx4 v20, s[44:47], s66 offen lds
    buffer_load_dwordx4 v21, s[44:47], s66 offen offset:1024 lds
    s_add_u32 s70, s7, 4
    s_sub_u32 s67, s70, 20
    s_cmp_ge_u32 s70, 20
    s_cselect_b32 s70, s67, s70
    s_mul_i32 s66, s70, 393216
    s_add_u32 s66, s66, s64
    s_add_u32 m0, s60, 49152
    s_nop 0
    buffer_load_dwordx4 v4, s[40:43], s66 offen lds
    buffer_load_dwordx4 v5, s[40:43], s66 offen offset:1024 lds
    buffer_load_dwordx4 v6, s[40:43], s66 offen offset:2048 lds
    s_add_u32 s70, s7, 5
    s_sub_u32 s67, s70, 20
    s_cmp_ge_u32 s70, 20
    s_cselect_b32 s70, s67, s70
    s_mul_i32 s66, s70, 393216
    s_add_u32 s66, s66, s64
    s_add_u32 m0, s60, 61440
    s_nop 0
    buffer_load_dwordx4 v4, s[40:43], s66 offen lds
    buffer_load_dwordx4 v5, s[40:43], s66 offen offset:1024 lds
    buffer_load_dwordx4 v6, s[40:43], s66 offen offset:2048 lds
    s_add_u32 m0, s60, 90112
    s_mov_b32 s66, 0
    buffer_load_dwordx4 v1, s[32:35], s66 offen nt lds
    buffer_load_dwordx4 v2, s[32:35], s66 offen offset:1024 nt lds
    buffer_load_dwordx4 v3, s[32:35], s66 offen offset:2048 nt lds
    s_add_u32 m0, s60, 102400
    s_mov_b32 s66, 12288
    buffer_load_dwordx4 v1, s[32:35], s66 offen nt lds
    buffer_load_dwordx4 v2, s[32:35], s66 offen offset:1024 nt lds
    buffer_load_dwordx4 v3, s[32:35], s66 offen offset:2048 nt lds
    s_waitcnt vmcnt(19)
    s_waitcnt vmcnt(16)
    s_barrier
    s_add_u32 s70, s7, 6
    s_sub_u32 s67, s70, 20
    s_cmp_ge_u32 s70, 20
    s_cselect_b32 s70, s67, s70
    s_mul_i32 s66, s70, 393216
    s_add_u32 s66, s66, s64
    s_add_u32 m0, s60, 0
    s_nop 0
    buffer_load_dwordx4 v4, s[40:43], s66 offen lds
    buffer_load_dwordx4 v5, s[40:43], s66 offen offset:1024 lds
    buffer_load_dwordx4 v6, s[40:43], s66 offen offset:2048 lds
    s_add_u32 s70, s7, 7
    s_sub_u32 s67, s70, 20
    s_cmp_ge_u32 s70, 20
    s_cselect_b32 s70, s67, s70
    s_mul_i32 s66, s70, 393216
    s_add_u32 s66, s66, s64
    s_add_u32 m0, s60, 12288
    s_nop 0
    buffer_load_dwordx4 v4, s[40:43], s66 offen lds
    buffer_load_dwordx4 v5, s[40:43], s66 offen offset:1024 lds
    buffer_load_dwordx4 v6, s[40:43], s66 offen offset:2048 lds
    s_waitcnt vmcnt(15)
    s_waitcnt vmcnt(12)
    s_barrier
    s_add_u32 s70, s7, 10
    s_sub_u32 s67, s70, 20
    s_cmp_ge_u32 s70, 20
    s_cselect_b32 s70, s67, s70
    s_lshl_b32 s66, s70, 6
    s_add_u32 m0, s62, 122880
    s_nop 0
    buffer_load_dwordx4 v20, s[44:47], s66 offen lds
    buffer_load_dwordx4 v21, s[44:47], s66 offen offset:1024 lds
    s_add_u32 s70, s7, 8
    s_sub_u32 s67, s70, 20
    s_cmp_ge_u32 s70, 20
    s_cselect_b32 s70, s67, s70
    s_mul_i32 s66, s70, 393216
    s_add_u32 s66, s66, s64
    s_add_u32 m0, s60, 24576
    s_nop 0
    buffer_load_dwordx4 v4, s[40:43], s66 offen lds
    buffer_load_dwordx4 v5, s[40:43], s66 offen offset:1024 lds
    buffer_load_dwordx4 v6, s[40:43], s66 offen offset:2048 lds
    s_add_u32 s70, s7, 9
    s_sub_u32 s67, s70, 20
    s_cmp_ge_u32 s70, 20
    s_cselect_b32 s70, s67, s70
    s_mul_i32 s66, s70, 393216
    s_add_u32 s66, s66, s64
    s_add_u32 m0, s60, 36864
    s_nop 0
    buffer_load_dwordx4 v4, s[40:43], s66 offen lds
    buffer_load_dwordx4 v5, s[40:43], s66 offen offset:1024 lds
    buffer_load_dwordx4 v6, s[40:43], s66 offen offset:2048 lds
    s_waitcnt vmcnt(11)
    s_waitcnt vmcnt(8)
    s_barrier
    s_add_u32 s70, s7, 12
    s_sub_u32 s67, s70, 20
    s_cmp_ge_u32 s70, 20
    s_cselect_b32 s70, s67, s70
    s_lshl_b32 s66, s70, 6
    s_add_u32 m0, s62, 131072
    s_nop 0
    buffer_load_dwordx4 v20, s[44:47], s66 offen lds
    buffer_load_dwordx4 v21, s[44:47], s66 offen offset:1024 lds
    s_add_u32 s70, s7, 10
    s_sub_u32 s67, s70, 20
    s_cmp_ge_u32 s70, 20
    s_cselect_b32 s70, s67, s70
    s_mul_i32 s66, s70, 393216
    s_add_u32 s66, s66, s64
    s_add_u32 m0, s60, 49152
    s_nop 0
    buffer_load_dwordx4 v4, s[40:43], s66 offen lds
    buffer_load_dwordx4 v5, s[40:43], s66 offen offset:1024 lds
    buffer_load_dwordx4 v6, s[40:43], s66 offen offset:2048 lds
    s_add_u32 s70, s7, 11
    s_sub_u32 s67, s70, 20
    s_cmp_ge_u32 s70, 20
    s_cselect_b32 s70, s67, s70
    s_mul_i32 s66, s70, 393216
    s_add_u32 s66, s66, s64
    s_add_u32 m0, s60, 61440
    s_nop 0
    buffer_load_dwordx4 v4, s[40:43], s66 offen lds
    buffer_load_dwordx4 v5, s[40:43], s66 offen offset:1024 lds
    buffer_load_dwordx4 v6, s[40:43], s66 offen offset:2048 lds
    s_waitcnt vmcnt(11)
    s_waitcnt vmcnt(8)
    s_barrier
    s_add_u32 s70, s7, 14
    s_sub_u32 s67, s70, 20
    s_cmp_ge_u32 s70, 20
    s_cselect_b32 s70, s67, s70
    s_lshl_b32 s66, s70, 6
    s_add_u32 m0, s62, 139264
    s_nop 0
    buffer_load_dwordx4 v20, s[44:47], s66 offen lds
    buffer_load_dwordx4 v21, s[44:47], s66 offen offset:1024 lds
    s_add_u32 s70, s7, 12
    s_sub_u32 s67, s70, 20
    s_cmp_ge_u32 s70, 20
    s_cselect_b32 s70, s67, s70
    s_mul_i32 s66, s70, 393216
    s_add_u32 s66, s66, s64
    s_add_u32 m0, s60, 0
    s_nop 0
    buffer_load_dwordx4 v4, s[40:43], s66 offen lds
    buffer_load_dwordx4 v5, s[40:43], s66 offen offset:1024 lds
    buffer_load_dwordx4 v6, s[40:43], s66 offen offset:2048 lds
    s_add_u32 s70, s7, 13
    s_sub_u32 s67, s70, 20
    s_cmp_ge_u32 s70, 20
    s_cselect_b32 s70, s67, s70
    s_mul_i32 s66, s70, 393216
    s_add_u32 s66, s66, s64
    s_add_u32 m0, s60, 12288
    s_nop 0
    buffer_load_dwordx4 v4, s[40:43], s66 offen lds
    buffer_load_dwordx4 v5, s[40:43], s66 offen offset:1024 lds
    buffer_load_dwordx4 v6, s[40:43], s66 offen offset:2048 lds
    s_waitcnt vmcnt(11)
    s_waitcnt vmcnt(8)
    s_barrier
    s_add_u32 s70, s7, 16
    s_sub_u32 s67, s70, 20
    s_cmp_ge_u32 s70, 20
    s_cselect_b32 s70, s67, s70
    s_lshl_b32 s66, s70, 6
    s_add_u32 m0, s62, 147456
    s_nop 0
    buffer_load_dwordx4 v20, s[44:47], s66 offen lds
    buffer_load_dwordx4 v21, s[44:47], s66 offen offset:1024 lds
    s_add_u32 s70, s7, 14
    s_sub_u32 s67, s70, 20
    s_cmp_ge_u32 s70, 20
    s_cselect_b32 s70, s67, s70
    s_mul_i32 s66, s70, 393216
    s_add_u32 s66, s66, s64
    s_add_u32 m0, s60, 24576
    s_nop 0
    buffer_load_dwordx4 v4, s[40:43], s66 offen lds
    buffer_load_dwordx4 v5, s[40:43], s66 offen offset:1024 lds
    buffer_load_dwordx4 v6, s[40:43], s66 offen offset:2048 lds
    s_add_u32 s70, s7, 15
    s_sub_u32 s67, s70, 20
    s_cmp_ge_u32 s70, 20
    s_cselect_b32 s70, s67, s70
    s_mul_i32 s66, s70, 393216
    s_add_u32 s66, s66, s64
    s_add_u32 m0, s60, 36864
    s_nop 0
    buffer_load_dwordx4 v4, s[40:43], s66 offen lds
    buffer_load_dwordx4 v5, s[40:43], s66 offen offset:1024 lds
    buffer_load_dwordx4 v6, s[40:43], s66 offen offset:2048 lds
    s_waitcnt vmcnt(11)
    s_waitcnt vmcnt(8)
    s_barrier
    s_add_u32 s70, s7, 18
    s_sub_u32 s67, s70, 20
    s_cmp_ge_u32 s70, 20
    s_cselect_b32 s70, s67, s70
    s_lshl_b32 s66, s70, 6
    s_add_u32 m0, s62, 155648
    s_nop 0
    buffer_load_dwordx4 v20, s[44:47], s66 offen lds
    buffer_load_dwordx4 v21, s[44:47], s66 offen offset:1024 lds
    s_add_u32 s70, s7, 16
    s_sub_u32 s67, s70, 20
    s_cmp_ge_u32 s70, 20
    s_cselect_b32 s70, s67, s70
    s_mul_i32 s66, s70, 393216
    s_add_u32 s66, s66, s64
    s_add_u32 m0, s60, 49152
    s_nop 0
    buffer_load_dwordx4 v4, s[40:43], s66 offen lds
    buffer_load_dwordx4 v5, s[40:43], s66 offen offset:1024 lds
    buffer_load_dwordx4 v6, s[40:43], s66 offen offset:2048 lds
    s_add_u32 s70, s7, 17
    s_sub_u32 s67, s70, 20
    s_cmp_ge_u32 s70, 20
    s_cselect_b32 s70, s67, s70
    s_mul_i32 s66, s70, 393216
    s_add_u32 s66, s66, s64
    s_add_u32 m0, s60, 61440
    s_nop 0
    buffer_load_dwordx4 v4, s[40:43], s66 offen lds
    buffer_load_dwordx4 v5, s[40:43], s66 offen offset:1024 lds
    buffer_load_dwordx4 v6, s[40:43], s66 offen offset:2048 lds
    s_waitcnt vmcnt(11)
    s_waitcnt vmcnt(8)
    s_barrier
    s_add_u32 s70, s7, 18
    s_sub_u32 s67, s70, 20
    s_cmp_ge_u32 s70, 20
    s_cselect_b32 s70, s67, s70
    s_mul_i32 s66, s70, 393216
    s_add_u32 s66, s66, s64
    s_add_u32 m0, s60, 0
    s_nop 0
    buffer_load_dwordx4 v4, s[40:43], s66 offen lds
    buffer_load_dwordx4 v5, s[40:43], s66 offen offset:1024 lds
    buffer_load_dwordx4 v6, s[40:43], s66 offen offset:2048 lds
    s_add_u32 s70, s7, 19
    s_sub_u32 s67, s70, 20
    s_cmp_ge_u32 s70, 20
    s_cselect_b32 s70, s67, s70
    s_mul_i32 s66, s70, 393216
    s_add_u32 s66, s66, s64
    s_add_u32 m0, s60, 12288
    s_nop 0
    buffer_load_dwordx4 v4, s[40:43], s66 offen lds
    buffer_load_dwordx4 v5, s[40:43], s66 offen offset:1024 lds
    buffer_load_dwordx4 v6, s[40:43], s66 offen offset:2048 lds
    s_add_u32 m0, s60, 114688
    s_mov_b32 s66, 24576
    buffer_load_dwordx4 v1, s[32:35], s66 offen nt lds
    buffer_load_dwordx4 v2, s[32:35], s66 offen offset:1024 nt lds
    buffer_load_dwordx4 v3, s[32:35], s66 offen offset:2048 nt lds
    s_add_u32 m0, s60, 126976
    s_mov_b32 s66, 36864
    buffer_load_dwordx4 v1, s[32:35], s66 offen nt lds
    buffer_load_dwordx4 v2, s[32:35], s66 offen offset:1024 nt lds
    buffer_load_dwordx4 v3, s[32:35], s66 offen offset:2048 nt lds
    s_waitcnt vmcnt(15)
    s_waitcnt vmcnt(12)
    s_barrier
    s_waitcnt vmcnt(9)
    s_waitcnt vmcnt(6)
    s_barrier
    s_barrier
    s_add_u32 m0, s60, 139264
    s_mov_b32 s66, 49152
    buffer_load_dwordx4 v1, s[32:35], s66 offen nt lds
    buffer_load_dwordx4 v2, s[32:35], s66 offen offset:1024 nt lds
    buffer_load_dwordx4 v3, s[32:35], s66 offen offset:2048 nt lds
    s_add_u32 m0, s60, 151552
    s_mov_b32 s66, 61440
    buffer_load_dwordx4 v1, s[32:35], s66 offen nt lds
    buffer_load_dwordx4 v2, s[32:35], s66 offen offset:1024 nt lds
    buffer_load_dwordx4 v3, s[32:35], s66 offen offset:2048 nt lds
    s_barrier
    v_add_u32 v27, s71, v10
    v_add_u32 v28, s71, v11
    ds_read_b128 v[56:59], v27 offset:0
    ds_read_b128 v[60:63], v28 offset:0
    ds_read_b128 v[64:67], v27 offset:128
    ds_read_b128 v[68:71], v28 offset:128
    ds_read_b128 v[72:75], v27 offset:256
    ds_read_b128 v[76:79], v28 offset:256
    v_add_u32 v20, 90112, v10
    v_add_u32 v21, 90112, v11
    v_add_u32 v22, 102400, v10
    v_add_u32 v23, 102400, v11
    ds_read_b128 v[80:83], v20 offset:0
    ds_read_b128 v[84:87], v20 offset:6144
    ds_read_b128 v[88:91], v21 offset:0
    ds_read_b128 v[92:95], v21 offset:6144
    ds_read_b128 v[96:99], v20 offset:128
    ds_read_b128 v[100:103], v20 offset:6272
    ds_read_b128 v[104:107], v21 offset:128
    ds_read_b128 v[108:111], v21 offset:6272
    ds_read_b128 v[112:115], v20 offset:256
    s_waitcnt lgkmcnt(14)
    ds_read_b128 v[116:119], v20 offset:6400
    s_waitcnt lgkmcnt(14)
    ds_read_b128 v[120:123], v21 offset:256
    s_waitcnt lgkmcnt(14)
    ds_read_b128 v[124:127], v21 offset:6400
    s_waitcnt lgkmcnt(11)
    v_mfma_f32_16x16x32_bf16 v[128:131], v[80:83], v[56:59], 0
    ds_read_b128 v[80:83], v22 offset:0
    s_waitcnt lgkmcnt(11)
    v_mfma_f32_16x16x32_bf16 v[132:135], v[84:87], v[56:59], 0
    ds_read_b128 v[84:87], v22 offset:6144
    s_waitcnt lgkmcnt(11)
    v_mfma_f32_16x16x32_bf16 v[128:131], v[88:91], v[60:63], v[128:131]
    ds_read_b128 v[88:91], v23 offset:0
    s_waitcnt lgkmcnt(11)
    v_mfma_f32_16x16x32_bf16 v[132:135], v[92:95], v[60:63], v[132:135]
    ds_read_b128 v[92:95], v23 offset:6144
    s_waitcnt lgkmcnt(11)
    v_mfma_f32_16x16x32_bf16 v[128:131], v[96:99], v[64:67], v[128:131]
    ds_read_b128 v[96:99], v22 offset:128
    s_waitcnt lgkmcnt(11)
    v_mfma_f32_16x16x32_bf16 v[132:135], v[100:103], v[64:67], v[132:135]
    ds_read_b128 v[100:103], v22 offset:6272
    s_waitcnt lgkmcnt(11)
    v_mfma_f32_16x16x32_bf16 v[128:131], v[104:107], v[68:71], v[128:131]
    ds_read_b128 v[104:107], v23 offset:128
    s_waitcnt lgkmcnt(11)
    v_mfma_f32_16x16x32_bf16 v[132:135], v[108:111], v[68:71], v[132:135]
    ds_read_b128 v[108:111], v23 offset:6272
    s_waitcnt lgkmcnt(11)
    v_mfma_f32_16x16x32_bf16 v[128:131], v[112:115], v[72:75], v[128:131]
    ds_read_b128 v[112:115], v22 offset:256
    s_waitcnt lgkmcnt(11)
    v_mfma_f32_16x16x32_bf16 v[132:135], v[116:119], v[72:75], v[132:135]
    ds_read_b128 v[116:119], v22 offset:6400
    s_waitcnt lgkmcnt(11)
    v_mfma_f32_16x16x32_bf16 v[128:131], v[120:123], v[76:79], v[128:131]
    ds_read_b128 v[120:123], v23 offset:256
    s_waitcnt lgkmcnt(11)
    v_mfma_f32_16x16x32_bf16 v[132:135], v[124:127], v[76:79], v[132:135]
    ds_read_b128 v[124:127], v23 offset:6400
    s_waitcnt lgkmcnt(11)
    v_mfma_f32_16x16x32_bf16 v[136:139], v[80:83], v[56:59], 0
    s_waitcnt lgkmcnt(10)
    v_mfma_f32_16x16x32_bf16 v[140:143], v[84:87], v[56:59], 0
    s_waitcnt lgkmcnt(9)
    v_mfma_f32_16x16x32_bf16 v[136:139], v[88:91], v[60:63], v[136:139]
    s_waitcnt lgkmcnt(8)
    v_mfma_f32_16x16x32_bf16 v[140:143], v[92:95], v[60:63], v[140:143]
    s_waitcnt lgkmcnt(7)
    v_mfma_f32_16x16x32_bf16 v[136:139], v[96:99], v[64:67], v[136:139]
    s_waitcnt lgkmcnt(6)
    v_mfma_f32_16x16x32_bf16 v[140:143], v[100:103], v[64:67], v[140:143]
    s_waitcnt lgkmcnt(5)
    v_mfma_f32_16x16x32_bf16 v[136:139], v[104:107], v[68:71], v[136:139]
    s_waitcnt lgkmcnt(4)
    v_mfma_f32_16x16x32_bf16 v[140:143], v[108:111], v[68:71], v[140:143]
    s_waitcnt lgkmcnt(3)
    v_mfma_f32_16x16x32_bf16 v[136:139], v[112:115], v[72:75], v[136:139]
    s_waitcnt lgkmcnt(2)
    v_mfma_f32_16x16x32_bf16 v[140:143], v[116:119], v[72:75], v[140:143]
    s_waitcnt lgkmcnt(1)
    v_mfma_f32_16x16x32_bf16 v[136:139], v[120:123], v[76:79], v[136:139]
    s_waitcnt lgkmcnt(0)
    v_mfma_f32_16x16x32_bf16 v[140:143], v[124:127], v[76:79], v[140:143]
    s_waitcnt vmcnt(9)
    s_waitcnt vmcnt(6)
    s_barrier
    v_add_u32 v20, 114688, v10
    v_add_u32 v21, 114688, v11
    v_add_u32 v22, 126976, v10
    v_add_u32 v23, 126976, v11
    ds_read_b128 v[80:83], v20 offset:0
    ds_read_b128 v[84:87], v20 offset:6144
    ds_read_b128 v[88:91], v21 offset:0
    ds_read_b128 v[92:95], v21 offset:6144
    ds_read_b128 v[96:99], v20 offset:128
    ds_read_b128 v[100:103], v20 offset:6272
    ds_read_b128 v[104:107], v21 offset:128
    ds_read_b128 v[108:111], v21 offset:6272
    ds_read_b128 v[112:115], v20 offset:256
    ds_read_b128 v[116:119], v20 offset:6400
    ds_read_b128 v[120:123], v21 offset:256
    ds_read_b128 v[124:127], v21 offset:6400
    s_waitcnt lgkmcnt(11)
    v_mfma_f32_16x16x32_bf16 v[144:147], v[80:83], v[56:59], 0
    ds_read_b128 v[80:83], v22 offset:0
    v_max3_f32 v24, v128, v129, v130
    s_waitcnt lgkmcnt(11)
    v_mfma_f32_16x16x32_bf16 v[148:151], v[84:87], v[56:59], 0
    ds_read_b128 v[84:87], v22 offset:6144
    v_max3_f32 v24, v24, v131, v132
    s_waitcnt lgkmcnt(11)
    v_mfma_f32_16x16x32_bf16 v[144:147], v[88:91], v[60:63], v[144:147]
    ds_read_b128 v[88:91], v23 offset:0
    v_max3_f32 v24, v24, v133, v134
    s_waitcnt lgkmcnt(11)
    v_mfma_f32_16x16x32_bf16 v[148:151], v[92:95], v[60:63], v[148:151]
    ds_read_b128 v[92:95], v23 offset:6144
    v_max_f32 v24, v24, v135
    s_waitcnt lgkmcnt(11)
    v_mfma_f32_16x16x32_bf16 v[144:147], v[96:99], v[64:67], v[144:147]
    ds_read_b128 v[96:99], v22 offset:128
    v_max3_f32 v24, v24, v136, v137
    s_waitcnt lgkmcnt(11)
    v_mfma_f32_16x16x32_bf16 v[148:151], v[100:103], v[64:67], v[148:151]
    ds_read_b128 v[100:103], v22 offset:6272
    v_max3_f32 v24, v24, v138, v139
    s_waitcnt lgkmcnt(11)
    v_mfma_f32_16x16x32_bf16 v[144:147], v[104:107], v[68:71], v[144:147]
    ds_read_b128 v[104:107], v23 offset:128
    v_max3_f32 v24, v24, v140, v141
    s_waitcnt lgkmcnt(11)
    v_mfma_f32_16x16x32_bf16 v[148:151], v[108:111], v[68:71], v[148:151]
    ds_read_b128 v[108:111], v23 offset:6272
    v_max3_f32 v24, v24, v142, v143
    s_waitcnt lgkmcnt(11)
    v_mfma_f32_16x16x32_bf16 v[144:147], v[112:115], v[72:75], v[144:147]
    ds_read_b128 v[112:115], v22 offset:256
    s_waitcnt lgkmcnt(11)
    v_mfma_f32_16x16x32_bf16 v[148:151], v[116:119], v[72:75], v[148:151]
    ds_read_b128 v[116:119], v22 offset:6400
    s_waitcnt lgkmcnt(11)
    v_mfma_f32_16x16x32_bf16 v[144:147], v[120:123], v[76:79], v[144:147]
    ds_read_b128 v[120:123], v23 offset:256
    s_waitcnt lgkmcnt(11)
    v_mfma_f32_16x16x32_bf16 v[148:151], v[124:127], v[76:79], v[148:151]
    ds_read_b128 v[124:127], v23 offset:6400
    s_waitcnt lgkmcnt(11)
    v_mfma_f32_16x16x32_bf16 v[152:155], v[80:83], v[56:59], 0
    s_waitcnt lgkmcnt(10)
    v_mfma_f32_16x16x32_bf16 v[156:159], v[84:87], v[56:59], 0
    s_waitcnt lgkmcnt(9)
    v_mfma_f32_16x16x32_bf16 v[152:155], v[88:91], v[60:63], v[152:155]
    s_waitcnt lgkmcnt(8)
    v_mfma_f32_16x16x32_bf16 v[156:159], v[92:95], v[60:63], v[156:159]
    s_waitcnt lgkmcnt(7)
    v_mfma_f32_16x16x32_bf16 v[152:155], v[96:99], v[64:67], v[152:155]
    s_waitcnt lgkmcnt(6)
    v_mfma_f32_16x16x32_bf16 v[156:159], v[100:103], v[64:67], v[156:159]
    s_waitcnt lgkmcnt(5)
    v_mfma_f32_16x16x32_bf16 v[152:155], v[104:107], v[68:71], v[152:155]
    s_waitcnt lgkmcnt(4)
    v_mfma_f32_16x16x32_bf16 v[156:159], v[108:111], v[68:71], v[156:159]
    s_waitcnt lgkmcnt(3)
    v_mfma_f32_16x16x32_bf16 v[152:155], v[112:115], v[72:75], v[152:155]
    s_waitcnt lgkmcnt(2)
    v_mfma_f32_16x16x32_bf16 v[156:159], v[116:119], v[72:75], v[156:159]
    s_waitcnt lgkmcnt(1)
    v_mfma_f32_16x16x32_bf16 v[152:155], v[120:123], v[76:79], v[152:155]
    s_waitcnt lgkmcnt(0)
    v_mfma_f32_16x16x32_bf16 v[156:159], v[124:127], v[76:79], v[156:159]
    s_waitcnt vmcnt(3)
    s_waitcnt vmcnt(0)
    s_barrier
    v_add_u32 v20, 139264, v10
    v_add_u32 v21, 139264, v11
    v_add_u32 v22, 151552, v10
    v_add_u32 v23, 151552, v11
    ds_read_b128 v[80:83], v20 offset:0
    ds_read_b128 v[84:87], v20 offset:6144
    ds_read_b128 v[88:91], v21 offset:0
    ds_read_b128 v[92:95], v21 offset:6144
    ds_read_b128 v[96:99], v20 offset:128
    ds_read_b128 v[100:103], v20 offset:6272
    ds_read_b128 v[104:107], v21 offset:128
    ds_read_b128 v[108:111], v21 offset:6272
    ds_read_b128 v[112:115], v20 offset:256
    ds_read_b128 v[116:119], v20 offset:6400
    ds_read_b128 v[120:123], v21 offset:256
    ds_read_b128 v[124:127], v21 offset:6400
    s_waitcnt lgkmcnt(11)
    v_mfma_f32_16x16x32_bf16 v[160:163], v[80:83], v[56:59], 0
    ds_read_b128 v[80:83], v22 offset:0
    v_max3_f32 v24, v24, v144, v145
    s_waitcnt lgkmcnt(11)
    v_mfma_f32_16x16x32_bf16 v[164:167], v[84:87], v[56:59], 0
    ds_read_b128 v[84:87], v22 offset:6144
    v_max3_f32 v24, v24, v146, v147
    s_waitcnt lgkmcnt(11)
    v_mfma_f32_16x16x32_bf16 v[160:163], v[88:91], v[60:63], v[160:163]
    ds_read_b128 v[88:91], v23 offset:0
    v_max3_f32 v24, v24, v148, v149
    s_waitcnt lgkmcnt(11)
    v_mfma_f32_16x16x32_bf16 v[164:167], v[92:95], v[60:63], v[164:167]
    ds_read_b128 v[92:95], v23 offset:6144
    v_max3_f32 v24, v24, v150, v151
    s_waitcnt lgkmcnt(11)
    v_mfma_f32_16x16x32_bf16 v[160:163], v[96:99], v[64:67], v[160:163]
    ds_read_b128 v[96:99], v22 offset:128
    v_max3_f32 v24, v24, v152, v153
    s_waitcnt lgkmcnt(11)
    v_mfma_f32_16x16x32_bf16 v[164:167], v[100:103], v[64:67], v[164:167]
    ds_read_b128 v[100:103], v22 offset:6272
    v_max3_f32 v24, v24, v154, v155
    s_waitcnt lgkmcnt(11)
    v_mfma_f32_16x16x32_bf16 v[160:163], v[104:107], v[68:71], v[160:163]
    ds_read_b128 v[104:107], v23 offset:128
    v_max3_f32 v24, v24, v156, v157
    s_waitcnt lgkmcnt(11)
    v_mfma_f32_16x16x32_bf16 v[164:167], v[108:111], v[68:71], v[164:167]
    ds_read_b128 v[108:111], v23 offset:6272
    v_max3_f32 v24, v24, v158, v159
    s_waitcnt lgkmcnt(11)
    v_mfma_f32_16x16x32_bf16 v[160:163], v[112:115], v[72:75], v[160:163]
    ds_read_b128 v[112:115], v22 offset:256
    s_waitcnt lgkmcnt(11)
    v_mfma_f32_16x16x32_bf16 v[164:167], v[116:119], v[72:75], v[164:167]
    ds_read_b128 v[116:119], v22 offset:6400
    s_waitcnt lgkmcnt(11)
    v_mfma_f32_16x16x32_bf16 v[160:163], v[120:123], v[76:79], v[160:163]
    ds_read_b128 v[120:123], v23 offset:256
    s_waitcnt lgkmcnt(11)
    v_mfma_f32_16x16x32_bf16 v[164:167], v[124:127], v[76:79], v[164:167]
    ds_read_b128 v[124:127], v23 offset:6400
    s_waitcnt lgkmcnt(11)
    v_mfma_f32_16x16x32_bf16 v[168:171], v[80:83], v[56:59], 0
    s_waitcnt lgkmcnt(10)
    v_mfma_f32_16x16x32_bf16 v[172:175], v[84:87], v[56:59], 0
    s_waitcnt lgkmcnt(9)
    v_mfma_f32_16x16x32_bf16 v[168:171], v[88:91], v[60:63], v[168:171]
    s_waitcnt lgkmcnt(8)
    v_mfma_f32_16x16x32_bf16 v[172:175], v[92:95], v[60:63], v[172:175]
    s_waitcnt lgkmcnt(7)
    v_mfma_f32_16x16x32_bf16 v[168:171], v[96:99], v[64:67], v[168:171]
    s_waitcnt lgkmcnt(6)
    v_mfma_f32_16x16x32_bf16 v[172:175], v[100:103], v[64:67], v[172:175]
    s_waitcnt lgkmcnt(5)
    v_mfma_f32_16x16x32_bf16 v[168:171], v[104:107], v[68:71], v[168:171]
    s_waitcnt lgkmcnt(4)
    v_mfma_f32_16x16x32_bf16 v[172:175], v[108:111], v[68:71], v[172:175]
    s_waitcnt lgkmcnt(3)
    v_mfma_f32_16x16x32_bf16 v[168:171], v[112:115], v[72:75], v[168:171]
    s_waitcnt lgkmcnt(2)
    v_mfma_f32_16x16x32_bf16 v[172:175], v[116:119], v[72:75], v[172:175]
    s_waitcnt lgkmcnt(1)
    v_mfma_f32_16x16x32_bf16 v[168:171], v[120:123], v[76:79], v[168:171]
    s_waitcnt lgkmcnt(0)
    v_mfma_f32_16x16x32_bf16 v[172:175], v[124:127], v[76:79], v[172:175]
    s_barrier
    v_add_u32 v20, 90112, v10
    v_add_u32 v21, 90112, v11
    v_add_u32 v22, 102400, v10
    v_add_u32 v23, 102400, v11
    ds_read_b128 v[80:83], v20 offset:0
    ds_read_b128 v[84:87], v20 offset:6144
    ds_read_b128 v[88:91], v21 offset:0
    ds_read_b128 v[92:95], v21 offset:6144
    ds_read_b128 v[96:99], v20 offset:128
    ds_read_b128 v[100:103], v20 offset:6272
    ds_read_b128 v[104:107], v21 offset:128
    ds_read_b128 v[108:111], v21 offset:6272
    ds_read_b128 v[112:115], v20 offset:256
    ds_read_b128 v[116:119], v20 offset:6400
    ds_read_b128 v[120:123], v21 offset:256
    ds_read_b128 v[124:127], v21 offset:6400
    s_waitcnt lgkmcnt(11)
    v_mfma_f32_16x16x32_bf16 v[176:179], v[80:83], v[56:59], 0
    ds_read_b128 v[80:83], v22 offset:0
    v_max3_f32 v24, v24, v160, v161
    s_waitcnt lgkmcnt(11)
    v_mfma_f32_16x16x32_bf16 v[180:183], v[84:87], v[56:59], 0
    ds_read_b128 v[84:87], v22 offset:6144
    v_max3_f32 v24, v24, v162, v163
    s_waitcnt lgkmcnt(11)
    v_mfma_f32_16x16x32_bf16 v[176:179], v[88:91], v[60:63], v[176:179]
    ds_read_b128 v[88:91], v23 offset:0
    v_max3_f32 v24, v24, v164, v165
    s_waitcnt lgkmcnt(11)
    v_mfma_f32_16x16x32_bf16 v[180:183], v[92:95], v[60:63], v[180:183]
    ds_read_b128 v[92:95], v23 offset:6144
    v_max3_f32 v24, v24, v166, v167
    s_waitcnt lgkmcnt(11)
    v_mfma_f32_16x16x32_bf16 v[176:179], v[96:99], v[64:67], v[176:179]
    ds_read_b128 v[96:99], v22 offset:128
    v_max3_f32 v24, v24, v168, v169
    s_waitcnt lgkmcnt(11)
    v_mfma_f32_16x16x32_bf16 v[180:183], v[100:103], v[64:67], v[180:183]
    ds_read_b128 v[100:103], v22 offset:6272
    v_max3_f32 v24, v24, v170, v171
    s_waitcnt lgkmcnt(11)
    v_mfma_f32_16x16x32_bf16 v[176:179], v[104:107], v[68:71], v[176:179]
    ds_read_b128 v[104:107], v23 offset:128
    v_max3_f32 v24, v24, v172, v173
    s_waitcnt lgkmcnt(11)
    v_mfma_f32_16x16x32_bf16 v[180:183], v[108:111], v[68:71], v[180:183]
    ds_read_b128 v[108:111], v23 offset:6272
    v_max3_f32 v24, v24, v174, v175
    s_waitcnt lgkmcnt(11)
    v_mfma_f32_16x16x32_bf16 v[176:179], v[112:115], v[72:75], v[176:179]
    ds_read_b128 v[112:115], v22 offset:256
    s_waitcnt lgkmcnt(11)
    v_mfma_f32_16x16x32_bf16 v[180:183], v[116:119], v[72:75], v[180:183]
    ds_read_b128 v[116:119], v22 offset:6400
    s_waitcnt lgkmcnt(11)
    v_mfma_f32_16x16x32_bf16 v[176:179], v[120:123], v[76:79], v[176:179]
    ds_read_b128 v[120:123], v23 offset:256
    s_waitcnt lgkmcnt(11)
    v_mfma_f32_16x16x32_bf16 v[180:183], v[124:127], v[76:79], v[180:183]
    ds_read_b128 v[124:127], v23 offset:6400
    s_waitcnt lgkmcnt(11)
    v_mfma_f32_16x16x32_bf16 v[184:187], v[80:83], v[56:59], 0
    s_waitcnt lgkmcnt(10)
    v_mfma_f32_16x16x32_bf16 v[188:191], v[84:87], v[56:59], 0
    s_waitcnt lgkmcnt(9)
    v_mfma_f32_16x16x32_bf16 v[184:187], v[88:91], v[60:63], v[184:187]
    s_waitcnt lgkmcnt(8)
    v_mfma_f32_16x16x32_bf16 v[188:191], v[92:95], v[60:63], v[188:191]
    s_waitcnt lgkmcnt(7)
    v_mfma_f32_16x16x32_bf16 v[184:187], v[96:99], v[64:67], v[184:187]
    s_waitcnt lgkmcnt(6)
    v_mfma_f32_16x16x32_bf16 v[188:191], v[100:103], v[64:67], v[188:191]
    s_waitcnt lgkmcnt(5)
    v_mfma_f32_16x16x32_bf16 v[184:187], v[104:107], v[68:71], v[184:187]
    s_waitcnt lgkmcnt(4)
    v_mfma_f32_16x16x32_bf16 v[188:191], v[108:111], v[68:71], v[188:191]
    s_waitcnt lgkmcnt(3)
    v_mfma_f32_16x16x32_bf16 v[184:187], v[112:115], v[72:75], v[184:187]
    s_waitcnt lgkmcnt(2)
    v_mfma_f32_16x16x32_bf16 v[188:191], v[116:119], v[72:75], v[188:191]
    s_waitcnt lgkmcnt(1)
    v_mfma_f32_16x16x32_bf16 v[184:187], v[120:123], v[76:79], v[184:187]
    s_waitcnt lgkmcnt(0)
    v_mfma_f32_16x16x32_bf16 v[188:191], v[124:127], v[76:79], v[188:191]
    s_barrier
    v_add_u32 v20, 114688, v10
    v_add_u32 v21, 114688, v11
    v_add_u32 v22, 126976, v10
    v_add_u32 v23, 126976, v11
    ds_read_b128 v[80:83], v20 offset:0
    ds_read_b128 v[84:87], v20 offset:6144
    ds_read_b128 v[88:91], v21 offset:0
    ds_read_b128 v[92:95], v21 offset:6144
    ds_read_b128 v[96:99], v20 offset:128
    ds_read_b128 v[100:103], v20 offset:6272
    ds_read_b128 v[104:107], v21 offset:128
    ds_read_b128 v[108:111], v21 offset:6272
    ds_read_b128 v[112:115], v20 offset:256
    ds_read_b128 v[116:119], v20 offset:6400
    ds_read_b128 v[120:123], v21 offset:256
    ds_read_b128 v[124:127], v21 offset:6400
    s_waitcnt lgkmcnt(11)
    v_mfma_f32_16x16x32_bf16 v[192:195], v[80:83], v[56:59], 0
    ds_read_b128 v[80:83], v22 offset:0
    v_max3_f32 v24, v24, v176, v177
    s_waitcnt lgkmcnt(11)
    v_mfma_f32_16x16x32_bf16 v[196:199], v[84:87], v[56:59], 0
    ds_read_b128 v[84:87], v22 offset:6144
    v_max3_f32 v24, v24, v178, v179
    s_waitcnt lgkmcnt(11)
    v_mfma_f32_16x16x32_bf16 v[192:195], v[88:91], v[60:63], v[192:195]
    ds_read_b128 v[88:91], v23 offset:0
    v_max3_f32 v24, v24, v180, v181
    s_waitcnt lgkmcnt(11)
    v_mfma_f32_16x16x32_bf16 v[196:199], v[92:95], v[60:63], v[196:199]
    ds_read_b128 v[92:95], v23 offset:6144
    v_max3_f32 v24, v24, v182, v183
    s_waitcnt lgkmcnt(11)
    v_mfma_f32_16x16x32_bf16 v[192:195], v[96:99], v[64:67], v[192:195]
    ds_read_b128 v[96:99], v22 offset:128
    v_max3_f32 v24, v24, v184, v185
    s_waitcnt lgkmcnt(11)
    v_mfma_f32_16x16x32_bf16 v[196:199], v[100:103], v[64:67], v[196:199]
    ds_read_b128 v[100:103], v22 offset:6272
    v_max3_f32 v24, v24, v186, v187
    s_waitcnt lgkmcnt(11)
    v_mfma_f32_16x16x32_bf16 v[192:195], v[104:107], v[68:71], v[192:195]
    ds_read_b128 v[104:107], v23 offset:128
    v_max3_f32 v24, v24, v188, v189
    s_waitcnt lgkmcnt(11)
    v_mfma_f32_16x16x32_bf16 v[196:199], v[108:111], v[68:71], v[196:199]
    ds_read_b128 v[108:111], v23 offset:6272
    v_max3_f32 v24, v24, v190, v191
    s_waitcnt lgkmcnt(11)
    v_mfma_f32_16x16x32_bf16 v[192:195], v[112:115], v[72:75], v[192:195]
    ds_read_b128 v[112:115], v22 offset:256
    s_waitcnt lgkmcnt(11)
    v_mfma_f32_16x16x32_bf16 v[196:199], v[116:119], v[72:75], v[196:199]
    ds_read_b128 v[116:119], v22 offset:6400
    s_waitcnt lgkmcnt(11)
    v_mfma_f32_16x16x32_bf16 v[192:195], v[120:123], v[76:79], v[192:195]
    ds_read_b128 v[120:123], v23 offset:256
    s_waitcnt lgkmcnt(11)
    v_mfma_f32_16x16x32_bf16 v[196:199], v[124:127], v[76:79], v[196:199]
    ds_read_b128 v[124:127], v23 offset:6400
    s_waitcnt lgkmcnt(11)
    v_mfma_f32_16x16x32_bf16 v[200:203], v[80:83], v[56:59], 0
    s_waitcnt lgkmcnt(10)
    v_mfma_f32_16x16x32_bf16 v[204:207], v[84:87], v[56:59], 0
    s_waitcnt lgkmcnt(9)
    v_mfma_f32_16x16x32_bf16 v[200:203], v[88:91], v[60:63], v[200:203]
    s_waitcnt lgkmcnt(8)
    v_mfma_f32_16x16x32_bf16 v[204:207], v[92:95], v[60:63], v[204:207]
    s_waitcnt lgkmcnt(7)
    v_mfma_f32_16x16x32_bf16 v[200:203], v[96:99], v[64:67], v[200:203]
    s_waitcnt lgkmcnt(6)
    v_mfma_f32_16x16x32_bf16 v[204:207], v[100:103], v[64:67], v[204:207]
    s_waitcnt lgkmcnt(5)
    v_mfma_f32_16x16x32_bf16 v[200:203], v[104:107], v[68:71], v[200:203]
    s_waitcnt lgkmcnt(4)
    v_mfma_f32_16x16x32_bf16 v[204:207], v[108:111], v[68:71], v[204:207]
    s_waitcnt lgkmcnt(3)
    v_mfma_f32_16x16x32_bf16 v[200:203], v[112:115], v[72:75], v[200:203]
    s_waitcnt lgkmcnt(2)
    v_mfma_f32_16x16x32_bf16 v[204:207], v[116:119], v[72:75], v[204:207]
    s_waitcnt lgkmcnt(1)
    v_mfma_f32_16x16x32_bf16 v[200:203], v[120:123], v[76:79], v[200:203]
    s_waitcnt lgkmcnt(0)
    v_mfma_f32_16x16x32_bf16 v[204:207], v[124:127], v[76:79], v[204:207]
    s_barrier
    v_add_u32 v20, 139264, v10
    v_add_u32 v21, 139264, v11
    v_add_u32 v22, 151552, v10
    v_add_u32 v23, 151552, v11
    ds_read_b128 v[80:83], v20 offset:0
    ds_read_b128 v[84:87], v20 offset:6144
    ds_read_b128 v[88:91], v21 offset:0
    ds_read_b128 v[92:95], v21 offset:6144
    ds_read_b128 v[96:99], v20 offset:128
    ds_read_b128 v[100:103], v20 offset:6272
    ds_read_b128 v[104:107], v21 offset:128
    ds_read_b128 v[108:111], v21 offset:6272
    ds_read_b128 v[112:115], v20 offset:256
    ds_read_b128 v[116:119], v20 offset:6400
    ds_read_b128 v[120:123], v21 offset:256
    ds_read_b128 v[124:127], v21 offset:6400
    s_waitcnt lgkmcnt(11)
    v_mfma_f32_16x16x32_bf16 v[208:211], v[80:83], v[56:59], 0
    ds_read_b128 v[80:83], v22 offset:0
    v_max3_f32 v24, v24, v192, v193
    s_waitcnt lgkmcnt(11)
    v_mfma_f32_16x16x32_bf16 v[212:215], v[84:87], v[56:59], 0
    ds_read_b128 v[84:87], v22 offset:6144
    v_max3_f32 v24, v24, v194, v195
    s_waitcnt lgkmcnt(11)
    v_mfma_f32_16x16x32_bf16 v[208:211], v[88:91], v[60:63], v[208:211]
    ds_read_b128 v[88:91], v23 offset:0
    v_max3_f32 v24, v24, v196, v197
    s_waitcnt lgkmcnt(11)
    v_mfma_f32_16x16x32_bf16 v[212:215], v[92:95], v[60:63], v[212:215]
    ds_read_b128 v[92:95], v23 offset:6144
    v_max3_f32 v24, v24, v198, v199
    s_waitcnt lgkmcnt(11)
    v_mfma_f32_16x16x32_bf16 v[208:211], v[96:99], v[64:67], v[208:211]
    ds_read_b128 v[96:99], v22 offset:128
    v_max3_f32 v24, v24, v200, v201
    s_waitcnt lgkmcnt(11)
    v_mfma_f32_16x16x32_bf16 v[212:215], v[100:103], v[64:67], v[212:215]
    ds_read_b128 v[100:103], v22 offset:6272
    v_max3_f32 v24, v24, v202, v203
    s_waitcnt lgkmcnt(11)
    v_mfma_f32_16x16x32_bf16 v[208:211], v[104:107], v[68:71], v[208:211]
    ds_read_b128 v[104:107], v23 offset:128
    v_max3_f32 v24, v24, v204, v205
    s_waitcnt lgkmcnt(11)
    v_mfma_f32_16x16x32_bf16 v[212:215], v[108:111], v[68:71], v[212:215]
    ds_read_b128 v[108:111], v23 offset:6272
    v_max3_f32 v24, v24, v206, v207
    s_waitcnt lgkmcnt(11)
    v_mfma_f32_16x16x32_bf16 v[208:211], v[112:115], v[72:75], v[208:211]
    ds_read_b128 v[112:115], v22 offset:256
    s_waitcnt lgkmcnt(11)
    v_mfma_f32_16x16x32_bf16 v[212:215], v[116:119], v[72:75], v[212:215]
    ds_read_b128 v[116:119], v22 offset:6400
    s_waitcnt lgkmcnt(11)
    v_mfma_f32_16x16x32_bf16 v[208:211], v[120:123], v[76:79], v[208:211]
    ds_read_b128 v[120:123], v23 offset:256
    s_waitcnt lgkmcnt(11)
    v_mfma_f32_16x16x32_bf16 v[212:215], v[124:127], v[76:79], v[212:215]
    ds_read_b128 v[124:127], v23 offset:6400
    s_waitcnt lgkmcnt(11)
    v_mfma_f32_16x16x32_bf16 v[216:219], v[80:83], v[56:59], 0
    s_waitcnt lgkmcnt(10)
    v_mfma_f32_16x16x32_bf16 v[220:223], v[84:87], v[56:59], 0
    s_waitcnt lgkmcnt(9)
    v_mfma_f32_16x16x32_bf16 v[216:219], v[88:91], v[60:63], v[216:219]
    s_waitcnt lgkmcnt(8)
    v_mfma_f32_16x16x32_bf16 v[220:223], v[92:95], v[60:63], v[220:223]
    s_waitcnt lgkmcnt(7)
    v_mfma_f32_16x16x32_bf16 v[216:219], v[96:99], v[64:67], v[216:219]
    s_waitcnt lgkmcnt(6)
    v_mfma_f32_16x16x32_bf16 v[220:223], v[100:103], v[64:67], v[220:223]
    s_waitcnt lgkmcnt(5)
    v_mfma_f32_16x16x32_bf16 v[216:219], v[104:107], v[68:71], v[216:219]
    s_waitcnt lgkmcnt(4)
    v_mfma_f32_16x16x32_bf16 v[220:223], v[108:111], v[68:71], v[220:223]
    s_waitcnt lgkmcnt(3)
    v_mfma_f32_16x16x32_bf16 v[216:219], v[112:115], v[72:75], v[216:219]
    s_waitcnt lgkmcnt(2)
    v_mfma_f32_16x16x32_bf16 v[220:223], v[116:119], v[72:75], v[220:223]
    s_waitcnt lgkmcnt(1)
    v_mfma_f32_16x16x32_bf16 v[216:219], v[120:123], v[76:79], v[216:219]
    s_waitcnt lgkmcnt(0)
    v_mfma_f32_16x16x32_bf16 v[220:223], v[124:127], v[76:79], v[220:223]
    s_barrier
    v_add_u32 v20, 90112, v10
    v_add_u32 v21, 90112, v11
    v_add_u32 v22, 102400, v10
    v_add_u32 v23, 102400, v11
    ds_read_b128 v[80:83], v20 offset:0
    ds_read_b128 v[84:87], v20 offset:6144
    ds_read_b128 v[88:91], v21 offset:0
    ds_read_b128 v[92:95], v21 offset:6144
    ds_read_b128 v[96:99], v20 offset:128
    ds_read_b128 v[100:103], v20 offset:6272
    ds_read_b128 v[104:107], v21 offset:128
    ds_read_b128 v[108:111], v21 offset:6272
    ds_read_b128 v[112:115], v20 offset:256
    ds_read_b128 v[116:119], v20 offset:6400
    ds_read_b128 v[120:123], v21 offset:256
    ds_read_b128 v[124:127], v21 offset:6400
    s_waitcnt lgkmcnt(11)
    v_mfma_f32_16x16x32_bf16 v[224:227], v[80:83], v[56:59], 0
    ds_read_b128 v[80:83], v22 offset:0
    v_max3_f32 v24, v24, v208, v209
    s_waitcnt lgkmcnt(11)
    v_mfma_f32_16x16x32_bf16 v[228:231], v[84:87], v[56:59], 0
    ds_read_b128 v[84:87], v22 offset:6144
    v_max3_f32 v24, v24, v210, v211
    s_waitcnt lgkmcnt(11)
    v_mfma_f32_16x16x32_bf16 v[224:227], v[88:91], v[60:63], v[224:227]
    ds_read_b128 v[88:91], v23 offset:0
    v_max3_f32 v24, v24, v212, v213
    s_waitcnt lgkmcnt(11)
    v_mfma_f32_16x16x32_bf16 v[228:231], v[92:95], v[60:63], v[228:231]
    ds_read_b128 v[92:95], v23 offset:6144
    v_max3_f32 v24, v24, v214, v215
    s_waitcnt lgkmcnt(11)
    v_mfma_f32_16x16x32_bf16 v[224:227], v[96:99], v[64:67], v[224:227]
    ds_read_b128 v[96:99], v22 offset:128
    v_max3_f32 v24, v24, v216, v217
    s_waitcnt lgkmcnt(11)
    v_mfma_f32_16x16x32_bf16 v[228:231], v[100:103], v[64:67], v[228:231]
    ds_read_b128 v[100:103], v22 offset:6272
    v_max3_f32 v24, v24, v218, v219
    s_waitcnt lgkmcnt(11)
    v_mfma_f32_16x16x32_bf16 v[224:227], v[104:107], v[68:71], v[224:227]
    ds_read_b128 v[104:107], v23 offset:128
    v_max3_f32 v24, v24, v220, v221
    s_waitcnt lgkmcnt(11)
    v_mfma_f32_16x16x32_bf16 v[228:231], v[108:111], v[68:71], v[228:231]
    ds_read_b128 v[108:111], v23 offset:6272
    v_max3_f32 v24, v24, v222, v223
    s_waitcnt lgkmcnt(11)
    v_mfma_f32_16x16x32_bf16 v[224:227], v[112:115], v[72:75], v[224:227]
    ds_read_b128 v[112:115], v22 offset:256
    s_waitcnt lgkmcnt(11)
    v_mfma_f32_16x16x32_bf16 v[228:231], v[116:119], v[72:75], v[228:231]
    ds_read_b128 v[116:119], v22 offset:6400
    s_waitcnt lgkmcnt(11)
    v_mfma_f32_16x16x32_bf16 v[224:227], v[120:123], v[76:79], v[224:227]
    ds_read_b128 v[120:123], v23 offset:256
    s_waitcnt lgkmcnt(11)
    v_mfma_f32_16x16x32_bf16 v[228:231], v[124:127], v[76:79], v[228:231]
    ds_read_b128 v[124:127], v23 offset:6400
    s_waitcnt lgkmcnt(11)
    v_mfma_f32_16x16x32_bf16 v[232:235], v[80:83], v[56:59], 0
    s_waitcnt lgkmcnt(10)
    v_mfma_f32_16x16x32_bf16 v[236:239], v[84:87], v[56:59], 0
    s_waitcnt lgkmcnt(9)
    v_mfma_f32_16x16x32_bf16 v[232:235], v[88:91], v[60:63], v[232:235]
    s_waitcnt lgkmcnt(8)
    v_mfma_f32_16x16x32_bf16 v[236:239], v[92:95], v[60:63], v[236:239]
    s_waitcnt lgkmcnt(7)
    v_mfma_f32_16x16x32_bf16 v[232:235], v[96:99], v[64:67], v[232:235]
    s_waitcnt lgkmcnt(6)
    v_mfma_f32_16x16x32_bf16 v[236:239], v[100:103], v[64:67], v[236:239]
    s_waitcnt lgkmcnt(5)
    v_mfma_f32_16x16x32_bf16 v[232:235], v[104:107], v[68:71], v[232:235]
    s_waitcnt lgkmcnt(4)
    v_mfma_f32_16x16x32_bf16 v[236:239], v[108:111], v[68:71], v[236:239]
    s_waitcnt lgkmcnt(3)
    v_mfma_f32_16x16x32_bf16 v[232:235], v[112:115], v[72:75], v[232:235]
    s_waitcnt lgkmcnt(2)
    v_mfma_f32_16x16x32_bf16 v[236:239], v[116:119], v[72:75], v[236:239]
    s_waitcnt lgkmcnt(1)
    v_mfma_f32_16x16x32_bf16 v[232:235], v[120:123], v[76:79], v[232:235]
    s_waitcnt lgkmcnt(0)
    v_mfma_f32_16x16x32_bf16 v[236:239], v[124:127], v[76:79], v[236:239]
    s_barrier
    v_add_u32 v20, 114688, v10
    v_add_u32 v21, 114688, v11
    v_add_u32 v22, 126976, v10
    v_add_u32 v23, 126976, v11
    ds_read_b128 v[80:83], v20 offset:0
    ds_read_b128 v[84:87], v20 offset:6144
    ds_read_b128 v[88:91], v21 offset:0
    ds_read_b128 v[92:95], v21 offset:6144
    ds_read_b128 v[96:99], v20 offset:128
    ds_read_b128 v[100:103], v20 offset:6272
    ds_read_b128 v[104:107], v21 offset:128
    ds_read_b128 v[108:111], v21 offset:6272
    ds_read_b128 v[112:115], v20 offset:256
    ds_read_b128 v[116:119], v20 offset:6400
    ds_read_b128 v[120:123], v21 offset:256
    ds_read_b128 v[124:127], v21 offset:6400
    s_waitcnt lgkmcnt(11)
    v_mfma_f32_16x16x32_bf16 v[240:243], v[80:83], v[56:59], 0
    ds_read_b128 v[80:83], v22 offset:0
    v_max3_f32 v24, v24, v224, v225
    s_waitcnt lgkmcnt(11)
    v_mfma_f32_16x16x32_bf16 v[244:247], v[84:87], v[56:59], 0
    ds_read_b128 v[84:87], v22 offset:6144
    v_max3_f32 v24, v24, v226, v227
    s_waitcnt lgkmcnt(11)
    v_mfma_f32_16x16x32_bf16 v[240:243], v[88:91], v[60:63], v[240:243]
    ds_read_b128 v[88:91], v23 offset:0
    v_max3_f32 v24, v24, v228, v229
    s_waitcnt lgkmcnt(11)
    v_mfma_f32_16x16x32_bf16 v[244:247], v[92:95], v[60:63], v[244:247]
    ds_read_b128 v[92:95], v23 offset:6144
    v_max3_f32 v24, v24, v230, v231
    s_waitcnt lgkmcnt(11)
    v_mfma_f32_16x16x32_bf16 v[240:243], v[96:99], v[64:67], v[240:243]
    ds_read_b128 v[96:99], v22 offset:128
    v_max3_f32 v24, v24, v232, v233
    s_waitcnt lgkmcnt(11)
    v_mfma_f32_16x16x32_bf16 v[244:247], v[100:103], v[64:67], v[244:247]
    ds_read_b128 v[100:103], v22 offset:6272
    v_max3_f32 v24, v24, v234, v235
    s_waitcnt lgkmcnt(11)
    v_mfma_f32_16x16x32_bf16 v[240:243], v[104:107], v[68:71], v[240:243]
    ds_read_b128 v[104:107], v23 offset:128
    v_max3_f32 v24, v24, v236, v237
    s_waitcnt lgkmcnt(11)
    v_mfma_f32_16x16x32_bf16 v[244:247], v[108:111], v[68:71], v[244:247]
    ds_read_b128 v[108:111], v23 offset:6272
    v_max3_f32 v24, v24, v238, v239
    s_waitcnt lgkmcnt(11)
    v_mfma_f32_16x16x32_bf16 v[240:243], v[112:115], v[72:75], v[240:243]
    ds_read_b128 v[112:115], v22 offset:256
    s_waitcnt lgkmcnt(11)
    v_mfma_f32_16x16x32_bf16 v[244:247], v[116:119], v[72:75], v[244:247]
    ds_read_b128 v[116:119], v22 offset:6400
    s_waitcnt lgkmcnt(11)
    v_mfma_f32_16x16x32_bf16 v[240:243], v[120:123], v[76:79], v[240:243]
    ds_read_b128 v[120:123], v23 offset:256
    s_waitcnt lgkmcnt(11)
    v_mfma_f32_16x16x32_bf16 v[244:247], v[124:127], v[76:79], v[244:247]
    ds_read_b128 v[124:127], v23 offset:6400
    s_waitcnt lgkmcnt(11)
    v_mfma_f32_16x16x32_bf16 v[248:251], v[80:83], v[56:59], 0
    s_waitcnt lgkmcnt(10)
    v_mfma_f32_16x16x32_bf16 v[252:255], v[84:87], v[56:59], 0
    s_waitcnt lgkmcnt(9)
    v_mfma_f32_16x16x32_bf16 v[248:251], v[88:91], v[60:63], v[248:251]
    s_waitcnt lgkmcnt(8)
    v_mfma_f32_16x16x32_bf16 v[252:255], v[92:95], v[60:63], v[252:255]
    s_waitcnt lgkmcnt(7)
    v_mfma_f32_16x16x32_bf16 v[248:251], v[96:99], v[64:67], v[248:251]
    s_waitcnt lgkmcnt(6)
    v_mfma_f32_16x16x32_bf16 v[252:255], v[100:103], v[64:67], v[252:255]
    s_waitcnt lgkmcnt(5)
    v_mfma_f32_16x16x32_bf16 v[248:251], v[104:107], v[68:71], v[248:251]
    s_waitcnt lgkmcnt(4)
    v_mfma_f32_16x16x32_bf16 v[252:255], v[108:111], v[68:71], v[252:255]
    s_waitcnt lgkmcnt(3)
    v_mfma_f32_16x16x32_bf16 v[248:251], v[112:115], v[72:75], v[248:251]
    s_waitcnt lgkmcnt(2)
    v_mfma_f32_16x16x32_bf16 v[252:255], v[116:119], v[72:75], v[252:255]
    s_waitcnt lgkmcnt(1)
    v_mfma_f32_16x16x32_bf16 v[248:251], v[120:123], v[76:79], v[248:251]
    s_waitcnt lgkmcnt(0)
    v_mfma_f32_16x16x32_bf16 v[252:255], v[124:127], v[76:79], v[252:255]
    s_barrier
    v_add_u32 v20, 139264, v12
    v_add_u32 v21, 139264, v13
    v_add_u32 v22, 139264, v14
    v_add_u32 v23, 139264, v15
    v_add_u32 v4, 147456, v12
    v_add_u32 v5, 147456, v13
    v_add_u32 v6, 147456, v14
    v_add_u32 v7, 147456, v15
    ds_read_b64_tr_b16 v[80:81], v20 offset:0
    ds_read_b64_tr_b16 v[82:83], v20 offset:2048
    ds_read_b64_tr_b16 v[84:85], v21 offset:0
    ds_read_b64_tr_b16 v[86:87], v21 offset:2048
    ds_read_b64_tr_b16 v[88:89], v22 offset:0
    ds_read_b64_tr_b16 v[90:91], v22 offset:2048
    ds_read_b64_tr_b16 v[92:93], v23 offset:0
    ds_read_b64_tr_b16 v[94:95], v23 offset:2048
    ds_read_b64_tr_b16 v[96:97], v20 offset:4096
    ds_read_b64_tr_b16 v[98:99], v20 offset:6144
    ds_read_b64_tr_b16 v[100:101], v21 offset:4096
    ds_read_b64_tr_b16 v[102:103], v21 offset:6144
    ds_read_b64_tr_b16 v[104:105], v22 offset:4096
    ds_read_b64_tr_b16 v[106:107], v22 offset:6144
    ds_read_b64_tr_b16 v[108:109], v23 offset:4096
    s_waitcnt lgkmcnt(14)
    ds_read_b64_tr_b16 v[110:111], v23 offset:6144
    s_waitcnt lgkmcnt(14)
    ds_read_b64_tr_b16 v[112:113], v4 offset:0
    s_waitcnt lgkmcnt(14)
    ds_read_b64_tr_b16 v[114:115], v4 offset:2048
    s_waitcnt lgkmcnt(14)
    ds_read_b64_tr_b16 v[116:117], v5 offset:0
    s_waitcnt lgkmcnt(14)
    ds_read_b64_tr_b16 v[118:119], v5 offset:2048
    s_waitcnt lgkmcnt(14)
    ds_read_b64_tr_b16 v[120:121], v6 offset:0
    s_waitcnt lgkmcnt(14)
    ds_read_b64_tr_b16 v[122:123], v6 offset:2048
    s_waitcnt lgkmcnt(14)
    ds_read_b64_tr_b16 v[124:125], v7 offset:0
    s_waitcnt lgkmcnt(14)
    ds_read_b64_tr_b16 v[126:127], v7 offset:2048
    v_max3_f32 v24, v24, v240, v241
    v_max3_f32 v24, v24, v242, v243
    v_max3_f32 v24, v24, v244, v245
    v_max3_f32 v24, v24, v246, v247
    v_max3_f32 v24, v24, v248, v249
    v_max3_f32 v24, v24, v250, v251
    v_max3_f32 v24, v24, v252, v253
    v_max3_f32 v24, v24, v254, v255
    v_mov_b32 v27, v24
    s_nop 1
    v_permlane32_swap_b32 v27, v24
    v_max_f32 v24, v24, v27
    v_mov_b32 v27, v24
    s_nop 1
    v_permlane16_swap_b32 v27, v24
    v_max_f32 v24, v24, v27
    v_mul_f32 v25, s65, v24
    v_fma_f32 v128, v128, s65, -v25
    v_fma_f32 v129, v129, s65, -v25
    v_fma_f32 v130, v130, s65, -v25
    v_fma_f32 v131, v131, s65, -v25
    v_fma_f32 v132, v132, s65, -v25
    v_fma_f32 v133, v133, s65, -v25
    v_fma_f32 v134, v134, s65, -v25
    v_fma_f32 v135, v135, s65, -v25
    v_exp_f32 v128, v128
    v_exp_f32 v129, v129
    v_exp_f32 v130, v130
    v_exp_f32 v131, v131
    v_exp_f32 v132, v132
    v_exp_f32 v133, v133
    v_exp_f32 v134, v134
    v_exp_f32 v135, v135
    v_cvt_pk_bf16_f32 v128, v128, v129
    v_cvt_pk_bf16_f32 v129, v130, v131
    v_cvt_pk_bf16_f32 v130, v132, v133
    v_cvt_pk_bf16_f32 v131, v134, v135
    s_nop 1
    v_mfma_f32_16x16x32_bf16 v[40:43], v[80:83], v[128:131], 0
    s_waitcnt lgkmcnt(14)
    ds_read_b64_tr_b16 v[80:81], v4 offset:4096
    s_waitcnt lgkmcnt(14)
    ds_read_b64_tr_b16 v[82:83], v4 offset:6144
    v_fma_f32 v136, v136, s65, -v25
    v_fma_f32 v137, v137, s65, -v25
    v_fma_f32 v138, v138, s65, -v25
    v_fma_f32 v139, v139, s65, -v25
    v_fma_f32 v140, v140, s65, -v25
    v_mfma_f32_16x16x32_bf16 v[44:47], v[84:87], v[128:131], 0
    s_waitcnt lgkmcnt(14)
    ds_read_b64_tr_b16 v[84:85], v5 offset:4096
    s_waitcnt lgkmcnt(14)
    ds_read_b64_tr_b16 v[86:87], v5 offset:6144
    v_fma_f32 v141, v141, s65, -v25
    v_fma_f32 v142, v142, s65, -v25
    v_fma_f32 v143, v143, s65, -v25
    v_exp_f32 v136, v136
    v_exp_f32 v137, v137
    v_mfma_f32_16x16x32_bf16 v[48:51], v[88:91], v[128:131], 0
    s_waitcnt lgkmcnt(14)
    ds_read_b64_tr_b16 v[88:89], v6 offset:4096
    s_waitcnt lgkmcnt(14)
    ds_read_b64_tr_b16 v[90:91], v6 offset:6144
    v_exp_f32 v138, v138
    v_exp_f32 v139, v139
    v_exp_f32 v140, v140
    v_exp_f32 v141, v141
    v_exp_f32 v142, v142
    v_mfma_f32_16x16x32_bf16 v[52:55], v[92:95], v[128:131], 0
    v_mfma_f32_16x16x32_bf16 v[36:39], v[32:35], v[128:131], 0
    s_waitcnt lgkmcnt(14)
    ds_read_b64_tr_b16 v[92:93], v7 offset:4096
    s_waitcnt lgkmcnt(14)
    ds_read_b64_tr_b16 v[94:95], v7 offset:6144
    v_exp_f32 v143, v143
    v_cvt_pk_bf16_f32 v136, v136, v137
    v_cvt_pk_bf16_f32 v137, v138, v139
    v_cvt_pk_bf16_f32 v138, v140, v141
    v_cvt_pk_bf16_f32 v139, v142, v143
    s_nop 1
    v_mfma_f32_16x16x32_bf16 v[40:43], v[96:99], v[136:139], v[40:43]
    v_fma_f32 v144, v144, s65, -v25
    v_fma_f32 v145, v145, s65, -v25
    v_fma_f32 v146, v146, s65, -v25
    v_fma_f32 v147, v147, s65, -v25
    v_fma_f32 v148, v148, s65, -v25
    v_mfma_f32_16x16x32_bf16 v[44:47], v[100:103], v[136:139], v[44:47]
    v_fma_f32 v149, v149, s65, -v25
    v_fma_f32 v150, v150, s65, -v25
    v_fma_f32 v151, v151, s65, -v25
    v_exp_f32 v144, v144
    v_exp_f32 v145, v145
    v_mfma_f32_16x16x32_bf16 v[48:51], v[104:107], v[136:139], v[48:51]
    v_exp_f32 v146, v146
    v_exp_f32 v147, v147
    v_exp_f32 v148, v148
    v_exp_f32 v149, v149
    v_exp_f32 v150, v150
    v_mfma_f32_16x16x32_bf16 v[52:55], v[108:111], v[136:139], v[52:55]
    v_mfma_f32_16x16x32_bf16 v[36:39], v[32:35], v[136:139], v[36:39]
    v_exp_f32 v151, v151
    v_cvt_pk_bf16_f32 v144, v144, v145
    v_cvt_pk_bf16_f32 v145, v146, v147
    v_cvt_pk_bf16_f32 v146, v148, v149
    v_cvt_pk_bf16_f32 v147, v150, v151
    s_waitcnt lgkmcnt(14)
    s_nop 0
    v_mfma_f32_16x16x32_bf16 v[40:43], v[112:115], v[144:147], v[40:43]
    v_fma_f32 v152, v152, s65, -v25
    v_fma_f32 v153, v153, s65, -v25
    v_fma_f32 v154, v154, s65, -v25
    v_fma_f32 v155, v155, s65, -v25
    v_fma_f32 v156, v156, s65, -v25
    s_waitcnt lgkmcnt(12)
    v_mfma_f32_16x16x32_bf16 v[44:47], v[116:119], v[144:147], v[44:47]
    v_fma_f32 v157, v157, s65, -v25
    v_fma_f32 v158, v158, s65, -v25
    v_fma_f32 v159, v159, s65, -v25
    v_exp_f32 v152, v152
    v_exp_f32 v153, v153
    s_waitcnt lgkmcnt(10)
    v_mfma_f32_16x16x32_bf16 v[48:51], v[120:123], v[144:147], v[48:51]
    v_exp_f32 v154, v154
    v_exp_f32 v155, v155
    v_exp_f32 v156, v156
    v_exp_f32 v157, v157
    v_exp_f32 v158, v158
    s_waitcnt lgkmcnt(8)
    v_mfma_f32_16x16x32_bf16 v[52:55], v[124:127], v[144:147], v[52:55]
    v_mfma_f32_16x16x32_bf16 v[36:39], v[32:35], v[144:147], v[36:39]
    v_exp_f32 v159, v159
    v_cvt_pk_bf16_f32 v152, v152, v153
    v_cvt_pk_bf16_f32 v153, v154, v155
    v_cvt_pk_bf16_f32 v154, v156, v157
    v_cvt_pk_bf16_f32 v155, v158, v159
    s_waitcnt lgkmcnt(6)
    s_nop 0
    v_mfma_f32_16x16x32_bf16 v[40:43], v[80:83], v[152:155], v[40:43]
    v_fma_f32 v160, v160, s65, -v25
    v_fma_f32 v161, v161, s65, -v25
    v_fma_f32 v162, v162, s65, -v25
    v_fma_f32 v163, v163, s65, -v25
    v_fma_f32 v164, v164, s65, -v25
    s_waitcnt lgkmcnt(4)
    v_mfma_f32_16x16x32_bf16 v[44:47], v[84:87], v[152:155], v[44:47]
    v_fma_f32 v165, v165, s65, -v25
    v_fma_f32 v166, v166, s65, -v25
    v_fma_f32 v167, v167, s65, -v25
    v_exp_f32 v160, v160
    v_exp_f32 v161, v161
    s_waitcnt lgkmcnt(2)
    v_mfma_f32_16x16x32_bf16 v[48:51], v[88:91], v[152:155], v[48:51]
    v_exp_f32 v162, v162
    v_exp_f32 v163, v163
    v_exp_f32 v164, v164
    v_exp_f32 v165, v165
    v_exp_f32 v166, v166
    s_waitcnt lgkmcnt(0)
    v_mfma_f32_16x16x32_bf16 v[52:55], v[92:95], v[152:155], v[52:55]
    v_mfma_f32_16x16x32_bf16 v[36:39], v[32:35], v[152:155], v[36:39]
    v_exp_f32 v167, v167
    v_cvt_pk_bf16_f32 v160, v160, v161
    v_cvt_pk_bf16_f32 v161, v162, v163
    v_cvt_pk_bf16_f32 v162, v164, v165
    v_cvt_pk_bf16_f32 v163, v166, v167
    s_barrier
    v_add_u32 v20, 155648, v12
    v_add_u32 v21, 155648, v13
    v_add_u32 v22, 155648, v14
    v_add_u32 v23, 155648, v15
    v_add_u32 v4, 90112, v12
    v_add_u32 v5, 90112, v13
    v_add_u32 v6, 90112, v14
    v_add_u32 v7, 90112, v15
    ds_read_b64_tr_b16 v[80:81], v20 offset:0
    ds_read_b64_tr_b16 v[82:83], v20 offset:2048
    ds_read_b64_tr_b16 v[84:85], v21 offset:0
    ds_read_b64_tr_b16 v[86:87], v21 offset:2048
    ds_read_b64_tr_b16 v[88:89], v22 offset:0
    ds_read_b64_tr_b16 v[90:91], v22 offset:2048
    ds_read_b64_tr_b16 v[92:93], v23 offset:0
    ds_read_b64_tr_b16 v[94:95], v23 offset:2048
    ds_read_b64_tr_b16 v[96:97], v20 offset:4096
    ds_read_b64_tr_b16 v[98:99], v20 offset:6144
    ds_read_b64_tr_b16 v[100:101], v21 offset:4096
    ds_read_b64_tr_b16 v[102:103], v21 offset:6144
    ds_read_b64_tr_b16 v[104:105], v22 offset:4096
    ds_read_b64_tr_b16 v[106:107], v22 offset:6144
    ds_read_b64_tr_b16 v[108:109], v23 offset:4096
    s_waitcnt lgkmcnt(14)
    ds_read_b64_tr_b16 v[110:111], v23 offset:6144
    s_waitcnt lgkmcnt(14)
    ds_read_b64_tr_b16 v[112:113], v4 offset:0
    s_waitcnt lgkmcnt(14)
    ds_read_b64_tr_b16 v[114:115], v4 offset:2048
    s_waitcnt lgkmcnt(14)
    ds_read_b64_tr_b16 v[116:117], v5 offset:0
    s_waitcnt lgkmcnt(14)
    ds_read_b64_tr_b16 v[118:119], v5 offset:2048
    s_waitcnt lgkmcnt(14)
    ds_read_b64_tr_b16 v[120:121], v6 offset:0
    s_waitcnt lgkmcnt(14)
    ds_read_b64_tr_b16 v[122:123], v6 offset:2048
    s_waitcnt lgkmcnt(14)
    ds_read_b64_tr_b16 v[124:125], v7 offset:0
    s_waitcnt lgkmcnt(14)
    ds_read_b64_tr_b16 v[126:127], v7 offset:2048
    v_mfma_f32_16x16x32_bf16 v[40:43], v[80:83], v[160:163], v[40:43]
    s_waitcnt lgkmcnt(14)
    ds_read_b64_tr_b16 v[80:81], v4 offset:4096
    s_waitcnt lgkmcnt(14)
    ds_read_b64_tr_b16 v[82:83], v4 offset:6144
    v_fma_f32 v168, v168, s65, -v25
    v_fma_f32 v169, v169, s65, -v25
    v_fma_f32 v170, v170, s65, -v25
    v_fma_f32 v171, v171, s65, -v25
    v_fma_f32 v172, v172, s65, -v25
    v_mfma_f32_16x16x32_bf16 v[44:47], v[84:87], v[160:163], v[44:47]
    s_waitcnt lgkmcnt(14)
    ds_read_b64_tr_b16 v[84:85], v5 offset:4096
    s_waitcnt lgkmcnt(14)
    ds_read_b64_tr_b16 v[86:87], v5 offset:6144
    v_fma_f32 v173, v173, s65, -v25
    v_fma_f32 v174, v174, s65, -v25
    v_fma_f32 v175, v175, s65, -v25
    v_exp_f32 v168, v168
    v_exp_f32 v169, v169
    v_mfma_f32_16x16x32_bf16 v[48:51], v[88:91], v[160:163], v[48:51]
    s_waitcnt lgkmcnt(14)
    ds_read_b64_tr_b16 v[88:89], v6 offset:4096
    s_waitcnt lgkmcnt(14)
    ds_read_b64_tr_b16 v[90:91], v6 offset:6144
    v_exp_f32 v170, v170
    v_exp_f32 v171, v171
    v_exp_f32 v172, v172
    v_exp_f32 v173, v173
    v_exp_f32 v174, v174
    v_mfma_f32_16x16x32_bf16 v[52:55], v[92:95], v[160:163], v[52:55]
    v_mfma_f32_16x16x32_bf16 v[36:39], v[32:35], v[160:163], v[36:39]
    s_waitcnt lgkmcnt(14)
    ds_read_b64_tr_b16 v[92:93], v7 offset:4096
    s_waitcnt lgkmcnt(14)
    ds_read_b64_tr_b16 v[94:95], v7 offset:6144
    v_exp_f32 v175, v175
    v_cvt_pk_bf16_f32 v168, v168, v169
    v_cvt_pk_bf16_f32 v169, v170, v171
    v_cvt_pk_bf16_f32 v170, v172, v173
    v_cvt_pk_bf16_f32 v171, v174, v175
    s_nop 1
    v_mfma_f32_16x16x32_bf16 v[40:43], v[96:99], v[168:171], v[40:43]
    v_fma_f32 v176, v176, s65, -v25
    v_fma_f32 v177, v177, s65, -v25
    v_fma_f32 v178, v178, s65, -v25
    v_fma_f32 v179, v179, s65, -v25
    v_fma_f32 v180, v180, s65, -v25
    v_mfma_f32_16x16x32_bf16 v[44:47], v[100:103], v[168:171], v[44:47]
    v_fma_f32 v181, v181, s65, -v25
    v_fma_f32 v182, v182, s65, -v25
    v_fma_f32 v183, v183, s65, -v25
    v_exp_f32 v176, v176
    v_exp_f32 v177, v177
    v_mfma_f32_16x16x32_bf16 v[48:51], v[104:107], v[168:171], v[48:51]
    v_exp_f32 v178, v178
    v_exp_f32 v179, v179
    v_exp_f32 v180, v180
    v_exp_f32 v181, v181
    v_exp_f32 v182, v182
    v_mfma_f32_16x16x32_bf16 v[52:55], v[108:111], v[168:171], v[52:55]
    v_mfma_f32_16x16x32_bf16 v[36:39], v[32:35], v[168:171], v[36:39]
    v_exp_f32 v183, v183
    v_cvt_pk_bf16_f32 v176, v176, v177
    v_cvt_pk_bf16_f32 v177, v178, v179
    v_cvt_pk_bf16_f32 v178, v180, v181
    v_cvt_pk_bf16_f32 v179, v182, v183
    s_waitcnt lgkmcnt(14)
    s_nop 0
    v_mfma_f32_16x16x32_bf16 v[40:43], v[112:115], v[176:179], v[40:43]
    v_fma_f32 v184, v184, s65, -v25
    v_fma_f32 v185, v185, s65, -v25
    v_fma_f32 v186, v186, s65, -v25
    v_fma_f32 v187, v187, s65, -v25
    v_fma_f32 v188, v188, s65, -v25
    s_waitcnt lgkmcnt(12)
    v_mfma_f32_16x16x32_bf16 v[44:47], v[116:119], v[176:179], v[44:47]
    v_fma_f32 v189, v189, s65, -v25
    v_fma_f32 v190, v190, s65, -v25
    v_fma_f32 v191, v191, s65, -v25
    v_exp_f32 v184, v184
    v_exp_f32 v185, v185
    s_waitcnt lgkmcnt(10)
    v_mfma_f32_16x16x32_bf16 v[48:51], v[120:123], v[176:179], v[48:51]
    v_exp_f32 v186, v186
    v_exp_f32 v187, v187
    v_exp_f32 v188, v188
    v_exp_f32 v189, v189
    v_exp_f32 v190, v190
    s_waitcnt lgkmcnt(8)
    v_mfma_f32_16x16x32_bf16 v[52:55], v[124:127], v[176:179], v[52:55]
    v_mfma_f32_16x16x32_bf16 v[36:39], v[32:35], v[176:179], v[36:39]
    v_exp_f32 v191, v191
    v_cvt_pk_bf16_f32 v184, v184, v185
    v_cvt_pk_bf16_f32 v185, v186, v187
    v_cvt_pk_bf16_f32 v186, v188, v189
    v_cvt_pk_bf16_f32 v187, v190, v191
    s_waitcnt lgkmcnt(6)
    s_nop 0
    v_mfma_f32_16x16x32_bf16 v[40:43], v[80:83], v[184:187], v[40:43]
    v_fma_f32 v192, v192, s65, -v25
    v_fma_f32 v193, v193, s65, -v25
    v_fma_f32 v194, v194, s65, -v25
    v_fma_f32 v195, v195, s65, -v25
    v_fma_f32 v196, v196, s65, -v25
    s_waitcnt lgkmcnt(4)
    v_mfma_f32_16x16x32_bf16 v[44:47], v[84:87], v[184:187], v[44:47]
    v_fma_f32 v197, v197, s65, -v25
    v_fma_f32 v198, v198, s65, -v25
    v_fma_f32 v199, v199, s65, -v25
    v_exp_f32 v192, v192
    v_exp_f32 v193, v193
    s_waitcnt lgkmcnt(2)
    v_mfma_f32_16x16x32_bf16 v[48:51], v[88:91], v[184:187], v[48:51]
    v_exp_f32 v194, v194
    v_exp_f32 v195, v195
    v_exp_f32 v196, v196
    v_exp_f32 v197, v197
    v_exp_f32 v198, v198
    s_waitcnt lgkmcnt(0)
    v_mfma_f32_16x16x32_bf16 v[52:55], v[92:95], v[184:187], v[52:55]
    v_mfma_f32_16x16x32_bf16 v[36:39], v[32:35], v[184:187], v[36:39]
    v_exp_f32 v199, v199
    v_cvt_pk_bf16_f32 v192, v192, v193
    v_cvt_pk_bf16_f32 v193, v194, v195
    v_cvt_pk_bf16_f32 v194, v196, v197
    v_cvt_pk_bf16_f32 v195, v198, v199
    s_barrier
    v_add_u32 v20, 98304, v12
    v_add_u32 v21, 98304, v13
    v_add_u32 v22, 98304, v14
    v_add_u32 v23, 98304, v15
    v_add_u32 v4, 106496, v12
    v_add_u32 v5, 106496, v13
    v_add_u32 v6, 106496, v14
    v_add_u32 v7, 106496, v15
    ds_read_b64_tr_b16 v[80:81], v20 offset:0
    ds_read_b64_tr_b16 v[82:83], v20 offset:2048
    ds_read_b64_tr_b16 v[84:85], v21 offset:0
    ds_read_b64_tr_b16 v[86:87], v21 offset:2048
    ds_read_b64_tr_b16 v[88:89], v22 offset:0
    ds_read_b64_tr_b16 v[90:91], v22 offset:2048
    ds_read_b64_tr_b16 v[92:93], v23 offset:0
    ds_read_b64_tr_b16 v[94:95], v23 offset:2048
    ds_read_b64_tr_b16 v[96:97], v20 offset:4096
    ds_read_b64_tr_b16 v[98:99], v20 offset:6144
    ds_read_b64_tr_b16 v[100:101], v21 offset:4096
    ds_read_b64_tr_b16 v[102:103], v21 offset:6144
    ds_read_b64_tr_b16 v[104:105], v22 offset:4096
    ds_read_b64_tr_b16 v[106:107], v22 offset:6144
    ds_read_b64_tr_b16 v[108:109], v23 offset:4096
    s_waitcnt lgkmcnt(14)
    ds_read_b64_tr_b16 v[110:111], v23 offset:6144
    s_waitcnt lgkmcnt(14)
    ds_read_b64_tr_b16 v[112:113], v4 offset:0
    s_waitcnt lgkmcnt(14)
    ds_read_b64_tr_b16 v[114:115], v4 offset:2048
    s_waitcnt lgkmcnt(14)
    ds_read_b64_tr_b16 v[116:117], v5 offset:0
    s_waitcnt lgkmcnt(14)
    ds_read_b64_tr_b16 v[118:119], v5 offset:2048
    s_waitcnt lgkmcnt(14)
    ds_read_b64_tr_b16 v[120:121], v6 offset:0
    s_waitcnt lgkmcnt(14)
    ds_read_b64_tr_b16 v[122:123], v6 offset:2048
    s_waitcnt lgkmcnt(14)
    ds_read_b64_tr_b16 v[124:125], v7 offset:0
    s_waitcnt lgkmcnt(14)
    ds_read_b64_tr_b16 v[126:127], v7 offset:2048
    v_mfma_f32_16x16x32_bf16 v[40:43], v[80:83], v[192:195], v[40:43]
    s_waitcnt lgkmcnt(14)
    ds_read_b64_tr_b16 v[80:81], v4 offset:4096
    s_waitcnt lgkmcnt(14)
    ds_read_b64_tr_b16 v[82:83], v4 offset:6144
    v_fma_f32 v200, v200, s65, -v25
    v_fma_f32 v201, v201, s65, -v25
    v_fma_f32 v202, v202, s65, -v25
    v_fma_f32 v203, v203, s65, -v25
    v_fma_f32 v204, v204, s65, -v25
    v_mfma_f32_16x16x32_bf16 v[44:47], v[84:87], v[192:195], v[44:47]
    s_waitcnt lgkmcnt(14)
    ds_read_b64_tr_b16 v[84:85], v5 offset:4096
    s_waitcnt lgkmcnt(14)
    ds_read_b64_tr_b16 v[86:87], v5 offset:6144
    v_fma_f32 v205, v205, s65, -v25
    v_fma_f32 v206, v206, s65, -v25
    v_fma_f32 v207, v207, s65, -v25
    v_exp_f32 v200, v200
    v_exp_f32 v201, v201
    v_mfma_f32_16x16x32_bf16 v[48:51], v[88:91], v[192:195], v[48:51]
    s_waitcnt lgkmcnt(14)
    ds_read_b64_tr_b16 v[88:89], v6 offset:4096
    s_waitcnt lgkmcnt(14)
    ds_read_b64_tr_b16 v[90:91], v6 offset:6144
    v_exp_f32 v202, v202
    v_exp_f32 v203, v203
    v_exp_f32 v204, v204
    v_exp_f32 v205, v205
    v_exp_f32 v206, v206
    v_mfma_f32_16x16x32_bf16 v[52:55], v[92:95], v[192:195], v[52:55]
    v_mfma_f32_16x16x32_bf16 v[36:39], v[32:35], v[192:195], v[36:39]
    s_waitcnt lgkmcnt(14)
    ds_read_b64_tr_b16 v[92:93], v7 offset:4096
    s_waitcnt lgkmcnt(14)
    ds_read_b64_tr_b16 v[94:95], v7 offset:6144
    v_exp_f32 v207, v207
    v_cvt_pk_bf16_f32 v200, v200, v201
    v_cvt_pk_bf16_f32 v201, v202, v203
    v_cvt_pk_bf16_f32 v202, v204, v205
    v_cvt_pk_bf16_f32 v203, v206, v207
    s_nop 1
    v_mfma_f32_16x16x32_bf16 v[40:43], v[96:99], v[200:203], v[40:43]
    v_fma_f32 v208, v208, s65, -v25
    v_fma_f32 v209, v209, s65, -v25
    v_fma_f32 v210, v210, s65, -v25
    v_fma_f32 v211, v211, s65, -v25
    v_fma_f32 v212, v212, s65, -v25
    v_mfma_f32_16x16x32_bf16 v[44:47], v[100:103], v[200:203], v[44:47]
    v_fma_f32 v213, v213, s65, -v25
    v_fma_f32 v214, v214, s65, -v25
    v_fma_f32 v215, v215, s65, -v25
    v_exp_f32 v208, v208
    v_exp_f32 v209, v209
    v_mfma_f32_16x16x32_bf16 v[48:51], v[104:107], v[200:203], v[48:51]
    v_exp_f32 v210, v210
    v_exp_f32 v211, v211
    v_exp_f32 v212, v212
    v_exp_f32 v213, v213
    v_exp_f32 v214, v214
    v_mfma_f32_16x16x32_bf16 v[52:55], v[108:111], v[200:203], v[52:55]
    v_mfma_f32_16x16x32_bf16 v[36:39], v[32:35], v[200:203], v[36:39]
    v_exp_f32 v215, v215
    v_cvt_pk_bf16_f32 v208, v208, v209
    v_cvt_pk_bf16_f32 v209, v210, v211
    v_cvt_pk_bf16_f32 v210, v212, v213
    v_cvt_pk_bf16_f32 v211, v214, v215
    s_waitcnt lgkmcnt(14)
    s_nop 0
    v_mfma_f32_16x16x32_bf16 v[40:43], v[112:115], v[208:211], v[40:43]
    v_fma_f32 v216, v216, s65, -v25
    v_fma_f32 v217, v217, s65, -v25
    v_fma_f32 v218, v218, s65, -v25
    v_fma_f32 v219, v219, s65, -v25
    v_fma_f32 v220, v220, s65, -v25
    s_waitcnt lgkmcnt(12)
    v_mfma_f32_16x16x32_bf16 v[44:47], v[116:119], v[208:211], v[44:47]
    v_fma_f32 v221, v221, s65, -v25
    v_fma_f32 v222, v222, s65, -v25
    v_fma_f32 v223, v223, s65, -v25
    v_exp_f32 v216, v216
    v_exp_f32 v217, v217
    s_waitcnt lgkmcnt(10)
    v_mfma_f32_16x16x32_bf16 v[48:51], v[120:123], v[208:211], v[48:51]
    v_exp_f32 v218, v218
    v_exp_f32 v219, v219
    v_exp_f32 v220, v220
    v_exp_f32 v221, v221
    v_exp_f32 v222, v222
    s_waitcnt lgkmcnt(8)
    v_mfma_f32_16x16x32_bf16 v[52:55], v[124:127], v[208:211], v[52:55]
    v_mfma_f32_16x16x32_bf16 v[36:39], v[32:35], v[208:211], v[36:39]
    v_exp_f32 v223, v223
    v_cvt_pk_bf16_f32 v216, v216, v217
    v_cvt_pk_bf16_f32 v217, v218, v219
    v_cvt_pk_bf16_f32 v218, v220, v221
    v_cvt_pk_bf16_f32 v219, v222, v223
    s_waitcnt lgkmcnt(6)
    s_nop 0
    v_mfma_f32_16x16x32_bf16 v[40:43], v[80:83], v[216:219], v[40:43]
    v_fma_f32 v224, v224, s65, -v25
    v_fma_f32 v225, v225, s65, -v25
    v_fma_f32 v226, v226, s65, -v25
    v_fma_f32 v227, v227, s65, -v25
    v_fma_f32 v228, v228, s65, -v25
    s_waitcnt lgkmcnt(4)
    v_mfma_f32_16x16x32_bf16 v[44:47], v[84:87], v[216:219], v[44:47]
    v_fma_f32 v229, v229, s65, -v25
    v_fma_f32 v230, v230, s65, -v25
    v_fma_f32 v231, v231, s65, -v25
    v_exp_f32 v224, v224
    v_exp_f32 v225, v225
    s_waitcnt lgkmcnt(2)
    v_mfma_f32_16x16x32_bf16 v[48:51], v[88:91], v[216:219], v[48:51]
    v_exp_f32 v226, v226
    v_exp_f32 v227, v227
    v_exp_f32 v228, v228
    v_exp_f32 v229, v229
    v_exp_f32 v230, v230
    s_waitcnt lgkmcnt(0)
    v_mfma_f32_16x16x32_bf16 v[52:55], v[92:95], v[216:219], v[52:55]
    v_mfma_f32_16x16x32_bf16 v[36:39], v[32:35], v[216:219], v[36:39]
    v_exp_f32 v231, v231
    v_cvt_pk_bf16_f32 v224, v224, v225
    v_cvt_pk_bf16_f32 v225, v226, v227
    v_cvt_pk_bf16_f32 v226, v228, v229
    v_cvt_pk_bf16_f32 v227, v230, v231
    s_barrier
    v_add_u32 v20, 114688, v12
    v_add_u32 v21, 114688, v13
    v_add_u32 v22, 114688, v14
    v_add_u32 v23, 114688, v15
    v_add_u32 v4, 122880, v12
    v_add_u32 v5, 122880, v13
    v_add_u32 v6, 122880, v14
    v_add_u32 v7, 122880, v15
    ds_read_b64_tr_b16 v[80:81], v20 offset:0
    ds_read_b64_tr_b16 v[82:83], v20 offset:2048
    ds_read_b64_tr_b16 v[84:85], v21 offset:0
    ds_read_b64_tr_b16 v[86:87], v21 offset:2048
    ds_read_b64_tr_b16 v[88:89], v22 offset:0
    ds_read_b64_tr_b16 v[90:91], v22 offset:2048
    ds_read_b64_tr_b16 v[92:93], v23 offset:0
    ds_read_b64_tr_b16 v[94:95], v23 offset:2048
    ds_read_b64_tr_b16 v[96:97], v20 offset:4096
    ds_read_b64_tr_b16 v[98:99], v20 offset:6144
    ds_read_b64_tr_b16 v[100:101], v21 offset:4096
    ds_read_b64_tr_b16 v[102:103], v21 offset:6144
    ds_read_b64_tr_b16 v[104:105], v22 offset:4096
    ds_read_b64_tr_b16 v[106:107], v22 offset:6144
    ds_read_b64_tr_b16 v[108:109], v23 offset:4096
    s_waitcnt lgkmcnt(14)
    ds_read_b64_tr_b16 v[110:111], v23 offset:6144
    s_waitcnt lgkmcnt(14)
    ds_read_b64_tr_b16 v[112:113], v4 offset:0
    s_waitcnt lgkmcnt(14)
    ds_read_b64_tr_b16 v[114:115], v4 offset:2048
    s_waitcnt lgkmcnt(14)
    ds_read_b64_tr_b16 v[116:117], v5 offset:0
    s_waitcnt lgkmcnt(14)
    ds_read_b64_tr_b16 v[118:119], v5 offset:2048
    s_waitcnt lgkmcnt(14)
    ds_read_b64_tr_b16 v[120:121], v6 offset:0
    s_waitcnt lgkmcnt(14)
    ds_read_b64_tr_b16 v[122:123], v6 offset:2048
    s_waitcnt lgkmcnt(14)
    ds_read_b64_tr_b16 v[124:125], v7 offset:0
    s_waitcnt lgkmcnt(14)
    ds_read_b64_tr_b16 v[126:127], v7 offset:2048
    v_mfma_f32_16x16x32_bf16 v[40:43], v[80:83], v[224:227], v[40:43]
    s_waitcnt lgkmcnt(14)
    ds_read_b64_tr_b16 v[80:81], v4 offset:4096
    s_waitcnt lgkmcnt(14)
    ds_read_b64_tr_b16 v[82:83], v4 offset:6144
    v_fma_f32 v232, v232, s65, -v25
    v_fma_f32 v233, v233, s65, -v25
    v_fma_f32 v234, v234, s65, -v25
    v_fma_f32 v235, v235, s65, -v25
    v_fma_f32 v236, v236, s65, -v25
    v_mfma_f32_16x16x32_bf16 v[44:47], v[84:87], v[224:227], v[44:47]
    s_waitcnt lgkmcnt(14)
    ds_read_b64_tr_b16 v[84:85], v5 offset:4096
    s_waitcnt lgkmcnt(14)
    ds_read_b64_tr_b16 v[86:87], v5 offset:6144
    v_fma_f32 v237, v237, s65, -v25
    v_fma_f32 v238, v238, s65, -v25
    v_fma_f32 v239, v239, s65, -v25
    v_exp_f32 v232, v232
    v_exp_f32 v233, v233
    v_mfma_f32_16x16x32_bf16 v[48:51], v[88:91], v[224:227], v[48:51]
    s_waitcnt lgkmcnt(14)
    ds_read_b64_tr_b16 v[88:89], v6 offset:4096
    s_waitcnt lgkmcnt(14)
    ds_read_b64_tr_b16 v[90:91], v6 offset:6144
    v_exp_f32 v234, v234
    v_exp_f32 v235, v235
    v_exp_f32 v236, v236
    v_exp_f32 v237, v237
    v_exp_f32 v238, v238
    v_mfma_f32_16x16x32_bf16 v[52:55], v[92:95], v[224:227], v[52:55]
    v_mfma_f32_16x16x32_bf16 v[36:39], v[32:35], v[224:227], v[36:39]
    s_waitcnt lgkmcnt(14)
    ds_read_b64_tr_b16 v[92:93], v7 offset:4096
    s_waitcnt lgkmcnt(14)
    ds_read_b64_tr_b16 v[94:95], v7 offset:6144
    v_exp_f32 v239, v239
    v_cvt_pk_bf16_f32 v232, v232, v233
    v_cvt_pk_bf16_f32 v233, v234, v235
    v_cvt_pk_bf16_f32 v234, v236, v237
    v_cvt_pk_bf16_f32 v235, v238, v239
    s_nop 1
    v_mfma_f32_16x16x32_bf16 v[40:43], v[96:99], v[232:235], v[40:43]
    v_fma_f32 v240, v240, s65, -v25
    v_fma_f32 v241, v241, s65, -v25
    v_fma_f32 v242, v242, s65, -v25
    v_fma_f32 v243, v243, s65, -v25
    v_fma_f32 v244, v244, s65, -v25
    v_mfma_f32_16x16x32_bf16 v[44:47], v[100:103], v[232:235], v[44:47]
    v_fma_f32 v245, v245, s65, -v25
    v_fma_f32 v246, v246, s65, -v25
    v_fma_f32 v247, v247, s65, -v25
    v_exp_f32 v240, v240
    v_exp_f32 v241, v241
    v_mfma_f32_16x16x32_bf16 v[48:51], v[104:107], v[232:235], v[48:51]
    v_exp_f32 v242, v242
    v_exp_f32 v243, v243
    v_exp_f32 v244, v244
    v_exp_f32 v245, v245
    v_exp_f32 v246, v246
    v_mfma_f32_16x16x32_bf16 v[52:55], v[108:111], v[232:235], v[52:55]
    v_mfma_f32_16x16x32_bf16 v[36:39], v[32:35], v[232:235], v[36:39]
    v_exp_f32 v247, v247
    v_cvt_pk_bf16_f32 v240, v240, v241
    v_cvt_pk_bf16_f32 v241, v242, v243
    v_cvt_pk_bf16_f32 v242, v244, v245
    v_cvt_pk_bf16_f32 v243, v246, v247
    s_waitcnt lgkmcnt(14)
    s_nop 0
    v_mfma_f32_16x16x32_bf16 v[40:43], v[112:115], v[240:243], v[40:43]
    v_fma_f32 v248, v248, s65, -v25
    v_fma_f32 v249, v249, s65, -v25
    v_fma_f32 v250, v250, s65, -v25
    v_fma_f32 v251, v251, s65, -v25
    v_fma_f32 v252, v252, s65, -v25
    s_waitcnt lgkmcnt(12)
    v_mfma_f32_16x16x32_bf16 v[44:47], v[116:119], v[240:243], v[44:47]
    v_fma_f32 v253, v253, s65, -v25
    v_fma_f32 v254, v254, s65, -v25
    v_fma_f32 v255, v255, s65, -v25
    v_exp_f32 v248, v248
    v_exp_f32 v249, v249
    s_waitcnt lgkmcnt(10)
    v_mfma_f32_16x16x32_bf16 v[48:51], v[120:123], v[240:243], v[48:51]
    v_exp_f32 v250, v250
    v_exp_f32 v251, v251
    v_exp_f32 v252, v252
    v_exp_f32 v253, v253
    v_exp_f32 v254, v254
    s_waitcnt lgkmcnt(8)
    v_mfma_f32_16x16x32_bf16 v[52:55], v[124:127], v[240:243], v[52:55]
    v_mfma_f32_16x16x32_bf16 v[36:39], v[32:35], v[240:243], v[36:39]
    v_exp_f32 v255, v255
    v_cvt_pk_bf16_f32 v248, v248, v249
    v_cvt_pk_bf16_f32 v249, v250, v251
    v_cvt_pk_bf16_f32 v250, v252, v253
    v_cvt_pk_bf16_f32 v251, v254, v255
    s_waitcnt lgkmcnt(6)
    s_nop 0
    v_mfma_f32_16x16x32_bf16 v[40:43], v[80:83], v[248:251], v[40:43]
    s_waitcnt lgkmcnt(4)
    v_mfma_f32_16x16x32_bf16 v[44:47], v[84:87], v[248:251], v[44:47]
    s_waitcnt lgkmcnt(2)
    v_mfma_f32_16x16x32_bf16 v[48:51], v[88:91], v[248:251], v[48:51]
    s_waitcnt lgkmcnt(0)
    v_mfma_f32_16x16x32_bf16 v[52:55], v[92:95], v[248:251], v[52:55]
    v_mfma_f32_16x16x32_bf16 v[36:39], v[32:35], v[248:251], v[36:39]
    s_nop 7
    v_rcp_f32 v26, v36
    s_nop 0
    v_mul_f32 v40, v40, v26
    v_mul_f32 v41, v41, v26
    v_mul_f32 v42, v42, v26
    v_mul_f32 v43, v43, v26
    v_cvt_pk_bf16_f32 v40, v40, v41
    v_cvt_pk_bf16_f32 v41, v42, v43
    ds_write_b64 v16, v[40:41] offset:0
    v_mul_f32 v44, v44, v26
    v_mul_f32 v45, v45, v26
    v_mul_f32 v46, v46, v26
    v_mul_f32 v47, v47, v26
    v_cvt_pk_bf16_f32 v44, v44, v45
    v_cvt_pk_bf16_f32 v45, v46, v47
    ds_write_b64 v17, v[44:45] offset:0
    v_mul_f32 v48, v48, v26
    v_mul_f32 v49, v49, v26
    v_mul_f32 v50, v50, v26
    v_mul_f32 v51, v51, v26
    v_cvt_pk_bf16_f32 v48, v48, v49
    v_cvt_pk_bf16_f32 v49, v50, v51
    ds_write_b64 v18, v[48:49] offset:0
    v_mul_f32 v52, v52, v26
    v_mul_f32 v53, v53, v26
    v_mul_f32 v54, v54, v26
    v_mul_f32 v55, v55, v26
    v_cvt_pk_bf16_f32 v52, v52, v53
    v_cvt_pk_bf16_f32 v53, v54, v55
    ds_write_b64 v19, v[52:53] offset:0
    s_waitcnt lgkmcnt(0)
    s_barrier
    v_add_u32 v20, 131072, v12
    v_add_u32 v21, 131072, v13
    v_add_u32 v22, 131072, v14
    v_add_u32 v23, 131072, v15
    v_add_u32 v4, 139264, v12
    v_add_u32 v5, 139264, v13
    v_add_u32 v6, 139264, v14
    v_add_u32 v7, 139264, v15
    ds_read_b64_tr_b16 v[80:81], v20 offset:0
    ds_read_b64_tr_b16 v[82:83], v20 offset:2048
    ds_read_b64_tr_b16 v[84:85], v21 offset:0
    ds_read_b64_tr_b16 v[86:87], v21 offset:2048
    ds_read_b64_tr_b16 v[88:89], v22 offset:0
    ds_read_b64_tr_b16 v[90:91], v22 offset:2048
    ds_read_b64_tr_b16 v[92:93], v23 offset:0
    ds_read_b64_tr_b16 v[94:95], v23 offset:2048
    ds_read_b64_tr_b16 v[96:97], v20 offset:4096
    ds_read_b64_tr_b16 v[98:99], v20 offset:6144
    ds_read_b64_tr_b16 v[100:101], v21 offset:4096
    ds_read_b64_tr_b16 v[102:103], v21 offset:6144
    ds_read_b64_tr_b16 v[104:105], v22 offset:4096
    ds_read_b64_tr_b16 v[106:107], v22 offset:6144
    ds_read_b64_tr_b16 v[108:109], v23 offset:4096
    s_waitcnt lgkmcnt(14)
    ds_read_b64_tr_b16 v[110:111], v23 offset:6144
    s_waitcnt lgkmcnt(14)
    ds_read_b64_tr_b16 v[112:113], v4 offset:0
    s_waitcnt lgkmcnt(14)
    ds_read_b64_tr_b16 v[114:115], v4 offset:2048
    s_waitcnt lgkmcnt(14)
    ds_read_b64_tr_b16 v[116:117], v5 offset:0
    s_waitcnt lgkmcnt(14)
    ds_read_b64_tr_b16 v[118:119], v5 offset:2048
    s_waitcnt lgkmcnt(14)
    ds_read_b64_tr_b16 v[120:121], v6 offset:0
    s_waitcnt lgkmcnt(14)
    ds_read_b64_tr_b16 v[122:123], v6 offset:2048
    s_waitcnt lgkmcnt(14)
    ds_read_b64_tr_b16 v[124:125], v7 offset:0
    s_waitcnt lgkmcnt(14)
    ds_read_b64_tr_b16 v[126:127], v7 offset:2048
    v_mfma_f32_16x16x32_bf16 v[40:43], v[80:83], v[128:131], 0
    s_waitcnt lgkmcnt(14)
    ds_read_b64_tr_b16 v[80:81], v4 offset:4096
    s_waitcnt lgkmcnt(14)
    ds_read_b64_tr_b16 v[82:83], v4 offset:6144
    v_mfma_f32_16x16x32_bf16 v[44:47], v[84:87], v[128:131], 0
    s_waitcnt lgkmcnt(14)
    ds_read_b64_tr_b16 v[84:85], v5 offset:4096
    s_waitcnt lgkmcnt(14)
    ds_read_b64_tr_b16 v[86:87], v5 offset:6144
    v_mfma_f32_16x16x32_bf16 v[48:51], v[88:91], v[128:131], 0
    s_waitcnt lgkmcnt(14)
    ds_read_b64_tr_b16 v[88:89], v6 offset:4096
    s_waitcnt lgkmcnt(14)
    ds_read_b64_tr_b16 v[90:91], v6 offset:6144
    v_mfma_f32_16x16x32_bf16 v[52:55], v[92:95], v[128:131], 0
    s_waitcnt lgkmcnt(14)
    ds_read_b64_tr_b16 v[92:93], v7 offset:4096
    s_waitcnt lgkmcnt(14)
    ds_read_b64_tr_b16 v[94:95], v7 offset:6144
    v_mfma_f32_16x16x32_bf16 v[40:43], v[96:99], v[136:139], v[40:43]
    v_mfma_f32_16x16x32_bf16 v[44:47], v[100:103], v[136:139], v[44:47]
    v_mfma_f32_16x16x32_bf16 v[48:51], v[104:107], v[136:139], v[48:51]
    v_mfma_f32_16x16x32_bf16 v[52:55], v[108:111], v[136:139], v[52:55]
    s_waitcnt lgkmcnt(14)
    v_mfma_f32_16x16x32_bf16 v[40:43], v[112:115], v[144:147], v[40:43]
    s_waitcnt lgkmcnt(12)
    v_mfma_f32_16x16x32_bf16 v[44:47], v[116:119], v[144:147], v[44:47]
    s_waitcnt lgkmcnt(10)
    v_mfma_f32_16x16x32_bf16 v[48:51], v[120:123], v[144:147], v[48:51]
    s_waitcnt lgkmcnt(8)
    v_mfma_f32_16x16x32_bf16 v[52:55], v[124:127], v[144:147], v[52:55]
    s_waitcnt lgkmcnt(6)
    v_mfma_f32_16x16x32_bf16 v[40:43], v[80:83], v[152:155], v[40:43]
    s_waitcnt lgkmcnt(4)
    v_mfma_f32_16x16x32_bf16 v[44:47], v[84:87], v[152:155], v[44:47]
    s_waitcnt lgkmcnt(2)
    v_mfma_f32_16x16x32_bf16 v[48:51], v[88:91], v[152:155], v[48:51]
    s_waitcnt lgkmcnt(0)
    v_mfma_f32_16x16x32_bf16 v[52:55], v[92:95], v[152:155], v[52:55]
    s_barrier
    v_add_u32 v27, s71, v10
    v_add_u32 v28, s71, v11
    v_add_u32 v27, 57344, v27
    v_add_u32 v28, 57344, v28
    ds_read_b128 v[56:59], v27 offset:0
    ds_read_b128 v[60:63], v28 offset:0
    ds_read_b128 v[64:67], v27 offset:128
    ds_read_b128 v[68:71], v28 offset:128
    ds_read_b128 v[72:75], v27 offset:256
    ds_read_b128 v[76:79], v28 offset:256
    v_add_u32 v20, 147456, v12
    v_add_u32 v21, 147456, v13
    v_add_u32 v22, 147456, v14
    v_add_u32 v23, 147456, v15
    v_add_u32 v4, 155648, v12
    v_add_u32 v5, 155648, v13
    v_add_u32 v6, 155648, v14
    v_add_u32 v7, 155648, v15
    ds_read_b64_tr_b16 v[80:81], v20 offset:0
    ds_read_b64_tr_b16 v[82:83], v20 offset:2048
    ds_read_b64_tr_b16 v[84:85], v21 offset:0
    ds_read_b64_tr_b16 v[86:87], v21 offset:2048
    ds_read_b64_tr_b16 v[88:89], v22 offset:0
    ds_read_b64_tr_b16 v[90:91], v22 offset:2048
    ds_read_b64_tr_b16 v[92:93], v23 offset:0
    ds_read_b64_tr_b16 v[94:95], v23 offset:2048
    ds_read_b64_tr_b16 v[96:97], v20 offset:4096
    s_waitcnt lgkmcnt(14)
    ds_read_b64_tr_b16 v[98:99], v20 offset:6144
    s_waitcnt lgkmcnt(14)
    ds_read_b64_tr_b16 v[100:101], v21 offset:4096
    s_waitcnt lgkmcnt(14)
    ds_read_b64_tr_b16 v[102:103], v21 offset:6144
    s_waitcnt lgkmcnt(14)
    ds_read_b64_tr_b16 v[104:105], v22 offset:4096
    s_waitcnt lgkmcnt(14)
    ds_read_b64_tr_b16 v[106:107], v22 offset:6144
    s_waitcnt lgkmcnt(14)
    ds_read_b64_tr_b16 v[108:109], v23 offset:4096
    s_waitcnt lgkmcnt(14)
    ds_read_b64_tr_b16 v[110:111], v23 offset:6144
    s_waitcnt lgkmcnt(14)
    ds_read_b64_tr_b16 v[112:113], v4 offset:0
    s_waitcnt lgkmcnt(14)
    ds_read_b64_tr_b16 v[114:115], v4 offset:2048
    s_waitcnt lgkmcnt(14)
    ds_read_b64_tr_b16 v[116:117], v5 offset:0
    s_waitcnt lgkmcnt(14)
    ds_read_b64_tr_b16 v[118:119], v5 offset:2048
    s_waitcnt lgkmcnt(14)
    ds_read_b64_tr_b16 v[120:121], v6 offset:0
    s_waitcnt lgkmcnt(14)
    ds_read_b64_tr_b16 v[122:123], v6 offset:2048
    s_waitcnt lgkmcnt(14)
    ds_read_b64_tr_b16 v[124:125], v7 offset:0
    s_waitcnt lgkmcnt(14)
    ds_read_b64_tr_b16 v[126:127], v7 offset:2048
    v_mfma_f32_16x16x32_bf16 v[40:43], v[80:83], v[160:163], v[40:43]
    s_waitcnt lgkmcnt(14)
    ds_read_b64_tr_b16 v[80:81], v4 offset:4096
    s_waitcnt lgkmcnt(14)
    ds_read_b64_tr_b16 v[82:83], v4 offset:6144
    v_mfma_f32_16x16x32_bf16 v[44:47], v[84:87], v[160:163], v[44:47]
    s_waitcnt lgkmcnt(14)
    ds_read_b64_tr_b16 v[84:85], v5 offset:4096
    s_waitcnt lgkmcnt(14)
    ds_read_b64_tr_b16 v[86:87], v5 offset:6144
    v_mfma_f32_16x16x32_bf16 v[48:51], v[88:91], v[160:163], v[48:51]
    s_waitcnt lgkmcnt(14)
    ds_read_b64_tr_b16 v[88:89], v6 offset:4096
    s_waitcnt lgkmcnt(14)
    ds_read_b64_tr_b16 v[90:91], v6 offset:6144
    v_mfma_f32_16x16x32_bf16 v[52:55], v[92:95], v[160:163], v[52:55]
    s_waitcnt lgkmcnt(14)
    ds_read_b64_tr_b16 v[92:93], v7 offset:4096
    s_waitcnt lgkmcnt(14)
    ds_read_b64_tr_b16 v[94:95], v7 offset:6144
    v_mfma_f32_16x16x32_bf16 v[40:43], v[96:99], v[168:171], v[40:43]
    v_mfma_f32_16x16x32_bf16 v[44:47], v[100:103], v[168:171], v[44:47]
    v_mfma_f32_16x16x32_bf16 v[48:51], v[104:107], v[168:171], v[48:51]
    v_mfma_f32_16x16x32_bf16 v[52:55], v[108:111], v[168:171], v[52:55]
    s_waitcnt lgkmcnt(14)
    v_mfma_f32_16x16x32_bf16 v[40:43], v[112:115], v[176:179], v[40:43]
    s_waitcnt lgkmcnt(12)
    v_mfma_f32_16x16x32_bf16 v[44:47], v[116:119], v[176:179], v[44:47]
    s_waitcnt lgkmcnt(10)
    v_mfma_f32_16x16x32_bf16 v[48:51], v[120:123], v[176:179], v[48:51]
    s_waitcnt lgkmcnt(8)
    v_mfma_f32_16x16x32_bf16 v[52:55], v[124:127], v[176:179], v[52:55]
    s_waitcnt lgkmcnt(6)
    v_mfma_f32_16x16x32_bf16 v[40:43], v[80:83], v[184:187], v[40:43]
    s_waitcnt lgkmcnt(4)
    v_mfma_f32_16x16x32_bf16 v[44:47], v[84:87], v[184:187], v[44:47]
    s_waitcnt lgkmcnt(2)
    v_mfma_f32_16x16x32_bf16 v[48:51], v[88:91], v[184:187], v[48:51]
    s_waitcnt lgkmcnt(0)
    v_mfma_f32_16x16x32_bf16 v[52:55], v[92:95], v[184:187], v[52:55]
    s_barrier
    v_add_u32 v20, 90112, v12
    v_add_u32 v21, 90112, v13
    v_add_u32 v22, 90112, v14
    v_add_u32 v23, 90112, v15
    v_add_u32 v4, 98304, v12
    v_add_u32 v5, 98304, v13
    v_add_u32 v6, 98304, v14
    v_add_u32 v7, 98304, v15
    ds_read_b64_tr_b16 v[80:81], v20 offset:0
    ds_read_b64_tr_b16 v[82:83], v20 offset:2048
    ds_read_b64_tr_b16 v[84:85], v21 offset:0
    ds_read_b64_tr_b16 v[86:87], v21 offset:2048
    ds_read_b64_tr_b16 v[88:89], v22 offset:0
    ds_read_b64_tr_b16 v[90:91], v22 offset:2048
    ds_read_b64_tr_b16 v[92:93], v23 offset:0
    ds_read_b64_tr_b16 v[94:95], v23 offset:2048
    ds_read_b64_tr_b16 v[96:97], v20 offset:4096
    ds_read_b64_tr_b16 v[98:99], v20 offset:6144
    ds_read_b64_tr_b16 v[100:101], v21 offset:4096
    ds_read_b64_tr_b16 v[102:103], v21 offset:6144
    ds_read_b64_tr_b16 v[104:105], v22 offset:4096
    ds_read_b64_tr_b16 v[106:107], v22 offset:6144
    ds_read_b64_tr_b16 v[108:109], v23 offset:4096
    s_waitcnt lgkmcnt(14)
    ds_read_b64_tr_b16 v[110:111], v23 offset:6144
    s_waitcnt lgkmcnt(14)
    ds_read_b64_tr_b16 v[112:113], v4 offset:0
    s_waitcnt lgkmcnt(14)
    ds_read_b64_tr_b16 v[114:115], v4 offset:2048
    s_waitcnt lgkmcnt(14)
    ds_read_b64_tr_b16 v[116:117], v5 offset:0
    s_waitcnt lgkmcnt(14)
    ds_read_b64_tr_b16 v[118:119], v5 offset:2048
    s_waitcnt lgkmcnt(14)
    ds_read_b64_tr_b16 v[120:121], v6 offset:0
    s_waitcnt lgkmcnt(14)
    ds_read_b64_tr_b16 v[122:123], v6 offset:2048
    s_waitcnt lgkmcnt(14)
    ds_read_b64_tr_b16 v[124:125], v7 offset:0
    s_waitcnt lgkmcnt(14)
    ds_read_b64_tr_b16 v[126:127], v7 offset:2048
    v_mfma_f32_16x16x32_bf16 v[40:43], v[80:83], v[192:195], v[40:43]
    s_waitcnt lgkmcnt(14)
    ds_read_b64_tr_b16 v[80:81], v4 offset:4096
    s_waitcnt lgkmcnt(14)
    ds_read_b64_tr_b16 v[82:83], v4 offset:6144
    v_mfma_f32_16x16x32_bf16 v[44:47], v[84:87], v[192:195], v[44:47]
    s_waitcnt lgkmcnt(14)
    ds_read_b64_tr_b16 v[84:85], v5 offset:4096
    s_waitcnt lgkmcnt(14)
    ds_read_b64_tr_b16 v[86:87], v5 offset:6144
    v_mfma_f32_16x16x32_bf16 v[48:51], v[88:91], v[192:195], v[48:51]
    s_waitcnt lgkmcnt(14)
    ds_read_b64_tr_b16 v[88:89], v6 offset:4096
    s_waitcnt lgkmcnt(14)
    ds_read_b64_tr_b16 v[90:91], v6 offset:6144
    v_mfma_f32_16x16x32_bf16 v[52:55], v[92:95], v[192:195], v[52:55]
    s_waitcnt lgkmcnt(14)
    ds_read_b64_tr_b16 v[92:93], v7 offset:4096
    s_waitcnt lgkmcnt(14)
    ds_read_b64_tr_b16 v[94:95], v7 offset:6144
    v_mfma_f32_16x16x32_bf16 v[40:43], v[96:99], v[200:203], v[40:43]
    v_mfma_f32_16x16x32_bf16 v[44:47], v[100:103], v[200:203], v[44:47]
    v_mfma_f32_16x16x32_bf16 v[48:51], v[104:107], v[200:203], v[48:51]
    v_mfma_f32_16x16x32_bf16 v[52:55], v[108:111], v[200:203], v[52:55]
    s_waitcnt lgkmcnt(14)
    v_mfma_f32_16x16x32_bf16 v[40:43], v[112:115], v[208:211], v[40:43]
    s_waitcnt lgkmcnt(12)
    v_mfma_f32_16x16x32_bf16 v[44:47], v[116:119], v[208:211], v[44:47]
    s_waitcnt lgkmcnt(10)
    v_mfma_f32_16x16x32_bf16 v[48:51], v[120:123], v[208:211], v[48:51]
    s_waitcnt lgkmcnt(8)
    v_mfma_f32_16x16x32_bf16 v[52:55], v[124:127], v[208:211], v[52:55]
    s_waitcnt lgkmcnt(6)
    v_mfma_f32_16x16x32_bf16 v[40:43], v[80:83], v[216:219], v[40:43]
    s_waitcnt lgkmcnt(4)
    v_mfma_f32_16x16x32_bf16 v[44:47], v[84:87], v[216:219], v[44:47]
    s_waitcnt lgkmcnt(2)
    v_mfma_f32_16x16x32_bf16 v[48:51], v[88:91], v[216:219], v[48:51]
    s_waitcnt lgkmcnt(0)
    v_mfma_f32_16x16x32_bf16 v[52:55], v[92:95], v[216:219], v[52:55]
    s_barrier
    v_add_u32 v20, 106496, v12
    v_add_u32 v21, 106496, v13
    v_add_u32 v22, 106496, v14
    v_add_u32 v23, 106496, v15
    v_add_u32 v4, 114688, v12
    v_add_u32 v5, 114688, v13
    v_add_u32 v6, 114688, v14
    v_add_u32 v7, 114688, v15
    ds_read_b64_tr_b16 v[80:81], v20 offset:0
    ds_read_b64_tr_b16 v[82:83], v20 offset:2048
    ds_read_b64_tr_b16 v[84:85], v21 offset:0
    ds_read_b64_tr_b16 v[86:87], v21 offset:2048
    ds_read_b64_tr_b16 v[88:89], v22 offset:0
    ds_read_b64_tr_b16 v[90:91], v22 offset:2048
    ds_read_b64_tr_b16 v[92:93], v23 offset:0
    ds_read_b64_tr_b16 v[94:95], v23 offset:2048
    ds_read_b64_tr_b16 v[96:97], v20 offset:4096
    ds_read_b64_tr_b16 v[98:99], v20 offset:6144
    ds_read_b64_tr_b16 v[100:101], v21 offset:4096
    ds_read_b64_tr_b16 v[102:103], v21 offset:6144
    ds_read_b64_tr_b16 v[104:105], v22 offset:4096
    ds_read_b64_tr_b16 v[106:107], v22 offset:6144
    ds_read_b64_tr_b16 v[108:109], v23 offset:4096
    s_waitcnt lgkmcnt(14)
    ds_read_b64_tr_b16 v[110:111], v23 offset:6144
    s_waitcnt lgkmcnt(14)
    ds_read_b64_tr_b16 v[112:113], v4 offset:0
    s_waitcnt lgkmcnt(14)
    ds_read_b64_tr_b16 v[114:115], v4 offset:2048
    s_waitcnt lgkmcnt(14)
    ds_read_b64_tr_b16 v[116:117], v5 offset:0
    s_waitcnt lgkmcnt(14)
    ds_read_b64_tr_b16 v[118:119], v5 offset:2048
    s_waitcnt lgkmcnt(14)
    ds_read_b64_tr_b16 v[120:121], v6 offset:0
    s_waitcnt lgkmcnt(14)
    ds_read_b64_tr_b16 v[122:123], v6 offset:2048
    s_waitcnt lgkmcnt(14)
    ds_read_b64_tr_b16 v[124:125], v7 offset:0
    s_waitcnt lgkmcnt(14)
    ds_read_b64_tr_b16 v[126:127], v7 offset:2048
    v_mfma_f32_16x16x32_bf16 v[40:43], v[80:83], v[224:227], v[40:43]
    s_waitcnt lgkmcnt(14)
    ds_read_b64_tr_b16 v[80:81], v4 offset:4096
    s_waitcnt lgkmcnt(14)
    ds_read_b64_tr_b16 v[82:83], v4 offset:6144
    v_mfma_f32_16x16x32_bf16 v[44:47], v[84:87], v[224:227], v[44:47]
    s_waitcnt lgkmcnt(14)
    ds_read_b64_tr_b16 v[84:85], v5 offset:4096
    s_waitcnt lgkmcnt(14)
    ds_read_b64_tr_b16 v[86:87], v5 offset:6144
    v_mfma_f32_16x16x32_bf16 v[48:51], v[88:91], v[224:227], v[48:51]
    s_waitcnt lgkmcnt(14)
    ds_read_b64_tr_b16 v[88:89], v6 offset:4096
    s_waitcnt lgkmcnt(14)
    ds_read_b64_tr_b16 v[90:91], v6 offset:6144
    v_mfma_f32_16x16x32_bf16 v[52:55], v[92:95], v[224:227], v[52:55]
    s_waitcnt lgkmcnt(14)
    ds_read_b64_tr_b16 v[92:93], v7 offset:4096
    s_waitcnt lgkmcnt(14)
    ds_read_b64_tr_b16 v[94:95], v7 offset:6144
    v_mfma_f32_16x16x32_bf16 v[40:43], v[96:99], v[232:235], v[40:43]
    v_mfma_f32_16x16x32_bf16 v[44:47], v[100:103], v[232:235], v[44:47]
    v_mfma_f32_16x16x32_bf16 v[48:51], v[104:107], v[232:235], v[48:51]
    v_mfma_f32_16x16x32_bf16 v[52:55], v[108:111], v[232:235], v[52:55]
    s_waitcnt lgkmcnt(14)
    v_mfma_f32_16x16x32_bf16 v[40:43], v[112:115], v[240:243], v[40:43]
    s_waitcnt lgkmcnt(12)
    v_mfma_f32_16x16x32_bf16 v[44:47], v[116:119], v[240:243], v[44:47]
    s_waitcnt lgkmcnt(10)
    v_mfma_f32_16x16x32_bf16 v[48:51], v[120:123], v[240:243], v[48:51]
    s_waitcnt lgkmcnt(8)
    v_mfma_f32_16x16x32_bf16 v[52:55], v[124:127], v[240:243], v[52:55]
    s_waitcnt lgkmcnt(6)
    v_mfma_f32_16x16x32_bf16 v[40:43], v[80:83], v[248:251], v[40:43]
    s_waitcnt lgkmcnt(4)
    v_mfma_f32_16x16x32_bf16 v[44:47], v[84:87], v[248:251], v[44:47]
    s_waitcnt lgkmcnt(2)
    v_mfma_f32_16x16x32_bf16 v[48:51], v[88:91], v[248:251], v[48:51]
    s_waitcnt lgkmcnt(0)
    v_mfma_f32_16x16x32_bf16 v[52:55], v[92:95], v[248:251], v[52:55]
    s_nop 1
    v_mul_f32 v40, v40, v26
    v_mul_f32 v41, v41, v26
    v_mul_f32 v42, v42, v26
    v_mul_f32 v43, v43, v26
    v_cvt_pk_bf16_f32 v40, v40, v41
    v_cvt_pk_bf16_f32 v41, v42, v43
    ds_write_b64 v16, v[40:41] offset:0
    v_mul_f32 v44, v44, v26
    v_mul_f32 v45, v45, v26
    v_mul_f32 v46, v46, v26
    v_mul_f32 v47, v47, v26
    v_cvt_pk_bf16_f32 v44, v44, v45
    v_cvt_pk_bf16_f32 v45, v46, v47
    ds_write_b64 v17, v[44:45] offset:0
    v_mul_f32 v48, v48, v26
    v_mul_f32 v49, v49, v26
    v_mul_f32 v50, v50, v26
    v_mul_f32 v51, v51, v26
    v_cvt_pk_bf16_f32 v48, v48, v49
    v_cvt_pk_bf16_f32 v49, v50, v51
    ds_write_b64 v18, v[48:49] offset:0
    v_mul_f32 v52, v52, v26
    v_mul_f32 v53, v53, v26
    v_mul_f32 v54, v54, v26
    v_mul_f32 v55, v55, v26
    v_cvt_pk_bf16_f32 v52, v52, v53
    v_cvt_pk_bf16_f32 v53, v54, v55
    ds_write_b64 v19, v[52:53] offset:0
    s_waitcnt lgkmcnt(0)
    s_barrier
    v_add_u32 v20, 122880, v12
    v_add_u32 v21, 122880, v13
    v_add_u32 v22, 122880, v14
    v_add_u32 v23, 122880, v15
    v_add_u32 v4, 131072, v12
    v_add_u32 v5, 131072, v13
    v_add_u32 v6, 131072, v14
    v_add_u32 v7, 131072, v15
    ds_read_b64_tr_b16 v[80:81], v20 offset:0
    ds_read_b64_tr_b16 v[82:83], v20 offset:2048
    ds_read_b64_tr_b16 v[84:85], v21 offset:0
    ds_read_b64_tr_b16 v[86:87], v21 offset:2048
    ds_read_b64_tr_b16 v[88:89], v22 offset:0
    ds_read_b64_tr_b16 v[90:91], v22 offset:2048
    ds_read_b64_tr_b16 v[92:93], v23 offset:0
    ds_read_b64_tr_b16 v[94:95], v23 offset:2048
    ds_read_b64_tr_b16 v[96:97], v20 offset:4096
    ds_read_b64_tr_b16 v[98:99], v20 offset:6144
    ds_read_b64_tr_b16 v[100:101], v21 offset:4096
    ds_read_b64_tr_b16 v[102:103], v21 offset:6144
    ds_read_b64_tr_b16 v[104:105], v22 offset:4096
    ds_read_b64_tr_b16 v[106:107], v22 offset:6144
    ds_read_b64_tr_b16 v[108:109], v23 offset:4096
    s_waitcnt lgkmcnt(14)
    ds_read_b64_tr_b16 v[110:111], v23 offset:6144
    s_waitcnt lgkmcnt(14)
    ds_read_b64_tr_b16 v[112:113], v4 offset:0
    s_waitcnt lgkmcnt(14)
    ds_read_b64_tr_b16 v[114:115], v4 offset:2048
    s_waitcnt lgkmcnt(14)
    ds_read_b64_tr_b16 v[116:117], v5 offset:0
    s_waitcnt lgkmcnt(14)
    ds_read_b64_tr_b16 v[118:119], v5 offset:2048
    s_waitcnt lgkmcnt(14)
    ds_read_b64_tr_b16 v[120:121], v6 offset:0
    s_waitcnt lgkmcnt(14)
    ds_read_b64_tr_b16 v[122:123], v6 offset:2048
    s_waitcnt lgkmcnt(14)
    ds_read_b64_tr_b16 v[124:125], v7 offset:0
    s_waitcnt lgkmcnt(14)
    ds_read_b64_tr_b16 v[126:127], v7 offset:2048
    v_mfma_f32_16x16x32_bf16 v[40:43], v[80:83], v[128:131], 0
    s_waitcnt lgkmcnt(14)
    ds_read_b64_tr_b16 v[80:81], v4 offset:4096
    s_waitcnt lgkmcnt(14)
    ds_read_b64_tr_b16 v[82:83], v4 offset:6144
    v_mfma_f32_16x16x32_bf16 v[44:47], v[84:87], v[128:131], 0
    s_waitcnt lgkmcnt(14)
    ds_read_b64_tr_b16 v[84:85], v5 offset:4096
    s_waitcnt lgkmcnt(14)
    ds_read_b64_tr_b16 v[86:87], v5 offset:6144
    v_mfma_f32_16x16x32_bf16 v[48:51], v[88:91], v[128:131], 0
    s_waitcnt lgkmcnt(14)
    ds_read_b64_tr_b16 v[88:89], v6 offset:4096
    s_waitcnt lgkmcnt(14)
    ds_read_b64_tr_b16 v[90:91], v6 offset:6144
    v_mfma_f32_16x16x32_bf16 v[52:55], v[92:95], v[128:131], 0
    s_waitcnt lgkmcnt(14)
    ds_read_b64_tr_b16 v[92:93], v7 offset:4096
    s_waitcnt lgkmcnt(14)
    ds_read_b64_tr_b16 v[94:95], v7 offset:6144
    v_mfma_f32_16x16x32_bf16 v[40:43], v[96:99], v[136:139], v[40:43]
    v_mfma_f32_16x16x32_bf16 v[44:47], v[100:103], v[136:139], v[44:47]
    v_mfma_f32_16x16x32_bf16 v[48:51], v[104:107], v[136:139], v[48:51]
    v_mfma_f32_16x16x32_bf16 v[52:55], v[108:111], v[136:139], v[52:55]
    s_waitcnt lgkmcnt(14)
    v_mfma_f32_16x16x32_bf16 v[40:43], v[112:115], v[144:147], v[40:43]
    s_waitcnt lgkmcnt(12)
    v_mfma_f32_16x16x32_bf16 v[44:47], v[116:119], v[144:147], v[44:47]
    s_waitcnt lgkmcnt(10)
    v_mfma_f32_16x16x32_bf16 v[48:51], v[120:123], v[144:147], v[48:51]
    s_waitcnt lgkmcnt(8)
    v_mfma_f32_16x16x32_bf16 v[52:55], v[124:127], v[144:147], v[52:55]
    s_waitcnt lgkmcnt(6)
    v_mfma_f32_16x16x32_bf16 v[40:43], v[80:83], v[152:155], v[40:43]
    s_waitcnt lgkmcnt(4)
    v_mfma_f32_16x16x32_bf16 v[44:47], v[84:87], v[152:155], v[44:47]
    s_waitcnt lgkmcnt(2)
    v_mfma_f32_16x16x32_bf16 v[48:51], v[88:91], v[152:155], v[48:51]
    s_waitcnt lgkmcnt(0)
    v_mfma_f32_16x16x32_bf16 v[52:55], v[92:95], v[152:155], v[52:55]
    s_barrier
    v_add_u32 v20, 139264, v12
    v_add_u32 v21, 139264, v13
    v_add_u32 v22, 139264, v14
    v_add_u32 v23, 139264, v15
    v_add_u32 v4, 147456, v12
    v_add_u32 v5, 147456, v13
    v_add_u32 v6, 147456, v14
    v_add_u32 v7, 147456, v15
    ds_read_b64_tr_b16 v[80:81], v20 offset:0
    ds_read_b64_tr_b16 v[82:83], v20 offset:2048
    ds_read_b64_tr_b16 v[84:85], v21 offset:0
    ds_read_b64_tr_b16 v[86:87], v21 offset:2048
    ds_read_b64_tr_b16 v[88:89], v22 offset:0
    ds_read_b64_tr_b16 v[90:91], v22 offset:2048
    ds_read_b64_tr_b16 v[92:93], v23 offset:0
    ds_read_b64_tr_b16 v[94:95], v23 offset:2048
    ds_read_b64_tr_b16 v[96:97], v20 offset:4096
    ds_read_b64_tr_b16 v[98:99], v20 offset:6144
    ds_read_b64_tr_b16 v[100:101], v21 offset:4096
    ds_read_b64_tr_b16 v[102:103], v21 offset:6144
    ds_read_b64_tr_b16 v[104:105], v22 offset:4096
    ds_read_b64_tr_b16 v[106:107], v22 offset:6144
    ds_read_b64_tr_b16 v[108:109], v23 offset:4096
    s_waitcnt lgkmcnt(14)
    ds_read_b64_tr_b16 v[110:111], v23 offset:6144
    s_waitcnt lgkmcnt(14)
    ds_read_b64_tr_b16 v[112:113], v4 offset:0
    s_waitcnt lgkmcnt(14)
    ds_read_b64_tr_b16 v[114:115], v4 offset:2048
    s_waitcnt lgkmcnt(14)
    ds_read_b64_tr_b16 v[116:117], v5 offset:0
    s_waitcnt lgkmcnt(14)
    ds_read_b64_tr_b16 v[118:119], v5 offset:2048
    s_waitcnt lgkmcnt(14)
    ds_read_b64_tr_b16 v[120:121], v6 offset:0
    s_waitcnt lgkmcnt(14)
    ds_read_b64_tr_b16 v[122:123], v6 offset:2048
    s_waitcnt lgkmcnt(14)
    ds_read_b64_tr_b16 v[124:125], v7 offset:0
    s_waitcnt lgkmcnt(14)
    ds_read_b64_tr_b16 v[126:127], v7 offset:2048
    v_mfma_f32_16x16x32_bf16 v[40:43], v[80:83], v[160:163], v[40:43]
    s_waitcnt lgkmcnt(14)
    ds_read_b64_tr_b16 v[80:81], v4 offset:4096
    s_waitcnt lgkmcnt(14)
    ds_read_b64_tr_b16 v[82:83], v4 offset:6144
    v_mfma_f32_16x16x32_bf16 v[44:47], v[84:87], v[160:163], v[44:47]
    s_waitcnt lgkmcnt(14)
    ds_read_b64_tr_b16 v[84:85], v5 offset:4096
    s_waitcnt lgkmcnt(14)
    ds_read_b64_tr_b16 v[86:87], v5 offset:6144
    v_mfma_f32_16x16x32_bf16 v[48:51], v[88:91], v[160:163], v[48:51]
    s_waitcnt lgkmcnt(14)
    ds_read_b64_tr_b16 v[88:89], v6 offset:4096
    s_waitcnt lgkmcnt(14)
    ds_read_b64_tr_b16 v[90:91], v6 offset:6144
    v_mfma_f32_16x16x32_bf16 v[52:55], v[92:95], v[160:163], v[52:55]
    s_waitcnt lgkmcnt(14)
    ds_read_b64_tr_b16 v[92:93], v7 offset:4096
    s_waitcnt lgkmcnt(14)
    ds_read_b64_tr_b16 v[94:95], v7 offset:6144
    v_mfma_f32_16x16x32_bf16 v[40:43], v[96:99], v[168:171], v[40:43]
    v_mfma_f32_16x16x32_bf16 v[44:47], v[100:103], v[168:171], v[44:47]
    v_mfma_f32_16x16x32_bf16 v[48:51], v[104:107], v[168:171], v[48:51]
    v_mfma_f32_16x16x32_bf16 v[52:55], v[108:111], v[168:171], v[52:55]
    s_waitcnt lgkmcnt(14)
    v_mfma_f32_16x16x32_bf16 v[40:43], v[112:115], v[176:179], v[40:43]
    s_waitcnt lgkmcnt(12)
    v_mfma_f32_16x16x32_bf16 v[44:47], v[116:119], v[176:179], v[44:47]
    s_waitcnt lgkmcnt(10)
    v_mfma_f32_16x16x32_bf16 v[48:51], v[120:123], v[176:179], v[48:51]
    s_waitcnt lgkmcnt(8)
    v_mfma_f32_16x16x32_bf16 v[52:55], v[124:127], v[176:179], v[52:55]
    s_waitcnt lgkmcnt(6)
    v_mfma_f32_16x16x32_bf16 v[40:43], v[80:83], v[184:187], v[40:43]
    s_waitcnt lgkmcnt(4)
    v_mfma_f32_16x16x32_bf16 v[44:47], v[84:87], v[184:187], v[44:47]
    s_waitcnt lgkmcnt(2)
    v_mfma_f32_16x16x32_bf16 v[48:51], v[88:91], v[184:187], v[48:51]
    s_waitcnt lgkmcnt(0)
    v_mfma_f32_16x16x32_bf16 v[52:55], v[92:95], v[184:187], v[52:55]
    s_barrier
    v_add_u32 v20, 155648, v12
    v_add_u32 v21, 155648, v13
    v_add_u32 v22, 155648, v14
    v_add_u32 v23, 155648, v15
    v_add_u32 v4, 90112, v12
    v_add_u32 v5, 90112, v13
    v_add_u32 v6, 90112, v14
    v_add_u32 v7, 90112, v15
    ds_read_b64_tr_b16 v[80:81], v20 offset:0
    ds_read_b64_tr_b16 v[82:83], v20 offset:2048
    ds_read_b64_tr_b16 v[84:85], v21 offset:0
    ds_read_b64_tr_b16 v[86:87], v21 offset:2048
    ds_read_b64_tr_b16 v[88:89], v22 offset:0
    ds_read_b64_tr_b16 v[90:91], v22 offset:2048
    ds_read_b64_tr_b16 v[92:93], v23 offset:0
    ds_read_b64_tr_b16 v[94:95], v23 offset:2048
    ds_read_b64_tr_b16 v[96:97], v20 offset:4096
    ds_read_b64_tr_b16 v[98:99], v20 offset:6144
    ds_read_b64_tr_b16 v[100:101], v21 offset:4096
    ds_read_b64_tr_b16 v[102:103], v21 offset:6144
    ds_read_b64_tr_b16 v[104:105], v22 offset:4096
    ds_read_b64_tr_b16 v[106:107], v22 offset:6144
    ds_read_b64_tr_b16 v[108:109], v23 offset:4096
    s_waitcnt lgkmcnt(14)
    ds_read_b64_tr_b16 v[110:111], v23 offset:6144
    s_waitcnt lgkmcnt(14)
    ds_read_b64_tr_b16 v[112:113], v4 offset:0
    s_waitcnt lgkmcnt(14)
    ds_read_b64_tr_b16 v[114:115], v4 offset:2048
    s_waitcnt lgkmcnt(14)
    ds_read_b64_tr_b16 v[116:117], v5 offset:0
    s_waitcnt lgkmcnt(14)
    ds_read_b64_tr_b16 v[118:119], v5 offset:2048
    s_waitcnt lgkmcnt(14)
    ds_read_b64_tr_b16 v[120:121], v6 offset:0
    s_waitcnt lgkmcnt(14)
    ds_read_b64_tr_b16 v[122:123], v6 offset:2048
    s_waitcnt lgkmcnt(14)
    ds_read_b64_tr_b16 v[124:125], v7 offset:0
    s_waitcnt lgkmcnt(14)
    ds_read_b64_tr_b16 v[126:127], v7 offset:2048
    v_mfma_f32_16x16x32_bf16 v[40:43], v[80:83], v[192:195], v[40:43]
    s_waitcnt lgkmcnt(14)
    ds_read_b64_tr_b16 v[80:81], v4 offset:4096
    s_waitcnt lgkmcnt(14)
    ds_read_b64_tr_b16 v[82:83], v4 offset:6144
    v_mfma_f32_16x16x32_bf16 v[44:47], v[84:87], v[192:195], v[44:47]
    s_waitcnt lgkmcnt(14)
    ds_read_b64_tr_b16 v[84:85], v5 offset:4096
    s_waitcnt lgkmcnt(14)
    ds_read_b64_tr_b16 v[86:87], v5 offset:6144
    v_mfma_f32_16x16x32_bf16 v[48:51], v[88:91], v[192:195], v[48:51]
    s_waitcnt lgkmcnt(14)
    ds_read_b64_tr_b16 v[88:89], v6 offset:4096
    s_waitcnt lgkmcnt(14)
    ds_read_b64_tr_b16 v[90:91], v6 offset:6144
    v_mfma_f32_16x16x32_bf16 v[52:55], v[92:95], v[192:195], v[52:55]
    s_waitcnt lgkmcnt(14)
    ds_read_b64_tr_b16 v[92:93], v7 offset:4096
    s_waitcnt lgkmcnt(14)
    ds_read_b64_tr_b16 v[94:95], v7 offset:6144
    v_mfma_f32_16x16x32_bf16 v[40:43], v[96:99], v[200:203], v[40:43]
    v_mfma_f32_16x16x32_bf16 v[44:47], v[100:103], v[200:203], v[44:47]
    v_mfma_f32_16x16x32_bf16 v[48:51], v[104:107], v[200:203], v[48:51]
    v_mfma_f32_16x16x32_bf16 v[52:55], v[108:111], v[200:203], v[52:55]
    s_waitcnt lgkmcnt(14)
    v_mfma_f32_16x16x32_bf16 v[40:43], v[112:115], v[208:211], v[40:43]
    s_waitcnt lgkmcnt(12)
    v_mfma_f32_16x16x32_bf16 v[44:47], v[116:119], v[208:211], v[44:47]
    s_waitcnt lgkmcnt(10)
    v_mfma_f32_16x16x32_bf16 v[48:51], v[120:123], v[208:211], v[48:51]
    s_waitcnt lgkmcnt(8)
    v_mfma_f32_16x16x32_bf16 v[52:55], v[124:127], v[208:211], v[52:55]
    s_waitcnt lgkmcnt(6)
    v_mfma_f32_16x16x32_bf16 v[40:43], v[80:83], v[216:219], v[40:43]
    s_waitcnt lgkmcnt(4)
    v_mfma_f32_16x16x32_bf16 v[44:47], v[84:87], v[216:219], v[44:47]
    s_waitcnt lgkmcnt(2)
    v_mfma_f32_16x16x32_bf16 v[48:51], v[88:91], v[216:219], v[48:51]
    s_waitcnt lgkmcnt(0)
    v_mfma_f32_16x16x32_bf16 v[52:55], v[92:95], v[216:219], v[52:55]
    s_barrier
    v_add_u32 v20, 98304, v12
    v_add_u32 v21, 98304, v13
    v_add_u32 v22, 98304, v14
    v_add_u32 v23, 98304, v15
    v_add_u32 v4, 106496, v12
    v_add_u32 v5, 106496, v13
    v_add_u32 v6, 106496, v14
    v_add_u32 v7, 106496, v15
    ds_read_b64_tr_b16 v[80:81], v20 offset:0
    ds_read_b64_tr_b16 v[82:83], v20 offset:2048
    ds_read_b64_tr_b16 v[84:85], v21 offset:0
    ds_read_b64_tr_b16 v[86:87], v21 offset:2048
    ds_read_b64_tr_b16 v[88:89], v22 offset:0
    ds_read_b64_tr_b16 v[90:91], v22 offset:2048
    ds_read_b64_tr_b16 v[92:93], v23 offset:0
    ds_read_b64_tr_b16 v[94:95], v23 offset:2048
    ds_read_b64_tr_b16 v[96:97], v20 offset:4096
    ds_read_b64_tr_b16 v[98:99], v20 offset:6144
    ds_read_b64_tr_b16 v[100:101], v21 offset:4096
    ds_read_b64_tr_b16 v[102:103], v21 offset:6144
    ds_read_b64_tr_b16 v[104:105], v22 offset:4096
    ds_read_b64_tr_b16 v[106:107], v22 offset:6144
    ds_read_b64_tr_b16 v[108:109], v23 offset:4096
    s_waitcnt lgkmcnt(14)
    ds_read_b64_tr_b16 v[110:111], v23 offset:6144
    s_waitcnt lgkmcnt(14)
    ds_read_b64_tr_b16 v[112:113], v4 offset:0
    s_waitcnt lgkmcnt(14)
    ds_read_b64_tr_b16 v[114:115], v4 offset:2048
    s_waitcnt lgkmcnt(14)
    ds_read_b64_tr_b16 v[116:117], v5 offset:0
    s_waitcnt lgkmcnt(14)
    ds_read_b64_tr_b16 v[118:119], v5 offset:2048
    s_waitcnt lgkmcnt(14)
    ds_read_b64_tr_b16 v[120:121], v6 offset:0
    s_waitcnt lgkmcnt(14)
    ds_read_b64_tr_b16 v[122:123], v6 offset:2048
    s_waitcnt lgkmcnt(14)
    ds_read_b64_tr_b16 v[124:125], v7 offset:0
    s_waitcnt lgkmcnt(14)
    ds_read_b64_tr_b16 v[126:127], v7 offset:2048
    v_mfma_f32_16x16x32_bf16 v[40:43], v[80:83], v[224:227], v[40:43]
    s_waitcnt lgkmcnt(14)
    ds_read_b64_tr_b16 v[80:81], v4 offset:4096
    s_waitcnt lgkmcnt(14)
    ds_read_b64_tr_b16 v[82:83], v4 offset:6144
    v_mfma_f32_16x16x32_bf16 v[44:47], v[84:87], v[224:227], v[44:47]
    s_waitcnt lgkmcnt(14)
    ds_read_b64_tr_b16 v[84:85], v5 offset:4096
    s_waitcnt lgkmcnt(14)
    ds_read_b64_tr_b16 v[86:87], v5 offset:6144
    v_mfma_f32_16x16x32_bf16 v[48:51], v[88:91], v[224:227], v[48:51]
    s_waitcnt lgkmcnt(14)
    ds_read_b64_tr_b16 v[88:89], v6 offset:4096
    s_waitcnt lgkmcnt(14)
    ds_read_b64_tr_b16 v[90:91], v6 offset:6144
    v_mfma_f32_16x16x32_bf16 v[52:55], v[92:95], v[224:227], v[52:55]
    s_waitcnt lgkmcnt(14)
    ds_read_b64_tr_b16 v[92:93], v7 offset:4096
    s_waitcnt lgkmcnt(14)
    ds_read_b64_tr_b16 v[94:95], v7 offset:6144
    v_mfma_f32_16x16x32_bf16 v[40:43], v[96:99], v[232:235], v[40:43]
    v_mfma_f32_16x16x32_bf16 v[44:47], v[100:103], v[232:235], v[44:47]
    v_mfma_f32_16x16x32_bf16 v[48:51], v[104:107], v[232:235], v[48:51]
    v_mfma_f32_16x16x32_bf16 v[52:55], v[108:111], v[232:235], v[52:55]
    s_waitcnt lgkmcnt(14)
    v_mfma_f32_16x16x32_bf16 v[40:43], v[112:115], v[240:243], v[40:43]
    s_waitcnt lgkmcnt(12)
    v_mfma_f32_16x16x32_bf16 v[44:47], v[116:119], v[240:243], v[44:47]
    s_waitcnt lgkmcnt(10)
    v_mfma_f32_16x16x32_bf16 v[48:51], v[120:123], v[240:243], v[48:51]
    s_waitcnt lgkmcnt(8)
    v_mfma_f32_16x16x32_bf16 v[52:55], v[124:127], v[240:243], v[52:55]
    s_waitcnt lgkmcnt(6)
    v_mfma_f32_16x16x32_bf16 v[40:43], v[80:83], v[248:251], v[40:43]
    s_waitcnt lgkmcnt(4)
    v_mfma_f32_16x16x32_bf16 v[44:47], v[84:87], v[248:251], v[44:47]
    s_waitcnt lgkmcnt(2)
    v_mfma_f32_16x16x32_bf16 v[48:51], v[88:91], v[248:251], v[48:51]
    s_waitcnt lgkmcnt(0)
    v_mfma_f32_16x16x32_bf16 v[52:55], v[92:95], v[248:251], v[52:55]
    s_nop 1
    v_mul_f32 v40, v40, v26
    v_mul_f32 v41, v41, v26
    v_mul_f32 v42, v42, v26
    v_mul_f32 v43, v43, v26
    v_cvt_pk_bf16_f32 v40, v40, v41
    v_cvt_pk_bf16_f32 v41, v42, v43
    ds_write_b64 v16, v[40:41] offset:0
    v_mul_f32 v44, v44, v26
    v_mul_f32 v45, v45, v26
    v_mul_f32 v46, v46, v26
    v_mul_f32 v47, v47, v26
    v_cvt_pk_bf16_f32 v44, v44, v45
    v_cvt_pk_bf16_f32 v45, v46, v47
    ds_write_b64 v17, v[44:45] offset:0
    v_mul_f32 v48, v48, v26
    v_mul_f32 v49, v49, v26
    v_mul_f32 v50, v50, v26
    v_mul_f32 v51, v51, v26
    v_cvt_pk_bf16_f32 v48, v48, v49
    v_cvt_pk_bf16_f32 v49, v50, v51
    ds_write_b64 v18, v[48:49] offset:0
    v_mul_f32 v52, v52, v26
    v_mul_f32 v53, v53, v26
    v_mul_f32 v54, v54, v26
    v_mul_f32 v55, v55, v26
    v_cvt_pk_bf16_f32 v52, v52, v53
    v_cvt_pk_bf16_f32 v53, v54, v55
    ds_write_b64 v19, v[52:53] offset:0
    s_waitcnt lgkmcnt(0)
    s_barrier
    v_add_u32 v20, 114688, v10
    v_add_u32 v21, 114688, v11
    v_add_u32 v22, 126976, v10
    v_add_u32 v23, 126976, v11
    ds_read_b128 v[80:83], v20 offset:0
    ds_read_b128 v[84:87], v20 offset:6144
    ds_read_b128 v[88:91], v21 offset:0
    ds_read_b128 v[92:95], v21 offset:6144
    ds_read_b128 v[96:99], v20 offset:128
    ds_read_b128 v[100:103], v20 offset:6272
    ds_read_b128 v[104:107], v21 offset:128
    ds_read_b128 v[108:111], v21 offset:6272
    ds_read_b128 v[112:115], v20 offset:256
    ds_read_b128 v[116:119], v20 offset:6400
    ds_read_b128 v[120:123], v21 offset:256
    ds_read_b128 v[124:127], v21 offset:6400
    s_waitcnt lgkmcnt(11)
    v_mfma_f32_16x16x32_bf16 v[128:131], v[80:83], v[56:59], 0
    ds_read_b128 v[80:83], v22 offset:0
    s_waitcnt lgkmcnt(11)
    v_mfma_f32_16x16x32_bf16 v[132:135], v[84:87], v[56:59], 0
    ds_read_b128 v[84:87], v22 offset:6144
    s_waitcnt lgkmcnt(11)
    v_mfma_f32_16x16x32_bf16 v[128:131], v[88:91], v[60:63], v[128:131]
    ds_read_b128 v[88:91], v23 offset:0
    s_waitcnt lgkmcnt(11)
    v_mfma_f32_16x16x32_bf16 v[132:135], v[92:95], v[60:63], v[132:135]
    ds_read_b128 v[92:95], v23 offset:6144
    s_waitcnt lgkmcnt(11)
    v_mfma_f32_16x16x32_bf16 v[128:131], v[96:99], v[64:67], v[128:131]
    ds_read_b128 v[96:99], v22 offset:128
    s_waitcnt lgkmcnt(11)
    v_mfma_f32_16x16x32_bf16 v[132:135], v[100:103], v[64:67], v[132:135]
    ds_read_b128 v[100:103], v22 offset:6272
    s_waitcnt lgkmcnt(11)
    v_mfma_f32_16x16x32_bf16 v[128:131], v[104:107], v[68:71], v[128:131]
    ds_read_b128 v[104:107], v23 offset:128
    s_waitcnt lgkmcnt(11)
    v_mfma_f32_16x16x32_bf16 v[132:135], v[108:111], v[68:71], v[132:135]
    ds_read_b128 v[108:111], v23 offset:6272
    s_waitcnt lgkmcnt(11)
    v_mfma_f32_16x16x32_bf16 v[128:131], v[112:115], v[72:75], v[128:131]
    ds_read_b128 v[112:115], v22 offset:256
    s_waitcnt lgkmcnt(11)
    v_mfma_f32_16x16x32_bf16 v[132:135], v[116:119], v[72:75], v[132:135]
    ds_read_b128 v[116:119], v22 offset:6400
    s_waitcnt lgkmcnt(11)
    v_mfma_f32_16x16x32_bf16 v[128:131], v[120:123], v[76:79], v[128:131]
    ds_read_b128 v[120:123], v23 offset:256
    s_waitcnt lgkmcnt(11)
    v_mfma_f32_16x16x32_bf16 v[132:135], v[124:127], v[76:79], v[132:135]
    ds_read_b128 v[124:127], v23 offset:6400
    s_waitcnt lgkmcnt(11)
    v_mfma_f32_16x16x32_bf16 v[136:139], v[80:83], v[56:59], 0
    s_waitcnt lgkmcnt(10)
    v_mfma_f32_16x16x32_bf16 v[140:143], v[84:87], v[56:59], 0
    s_waitcnt lgkmcnt(9)
    v_mfma_f32_16x16x32_bf16 v[136:139], v[88:91], v[60:63], v[136:139]
    s_waitcnt lgkmcnt(8)
    v_mfma_f32_16x16x32_bf16 v[140:143], v[92:95], v[60:63], v[140:143]
    s_waitcnt lgkmcnt(7)
    v_mfma_f32_16x16x32_bf16 v[136:139], v[96:99], v[64:67], v[136:139]
    s_waitcnt lgkmcnt(6)
    v_mfma_f32_16x16x32_bf16 v[140:143], v[100:103], v[64:67], v[140:143]
    s_waitcnt lgkmcnt(5)
    v_mfma_f32_16x16x32_bf16 v[136:139], v[104:107], v[68:71], v[136:139]
    s_waitcnt lgkmcnt(4)
    v_mfma_f32_16x16x32_bf16 v[140:143], v[108:111], v[68:71], v[140:143]
    s_waitcnt lgkmcnt(3)
    v_mfma_f32_16x16x32_bf16 v[136:139], v[112:115], v[72:75], v[136:139]
    s_waitcnt lgkmcnt(2)
    v_mfma_f32_16x16x32_bf16 v[140:143], v[116:119], v[72:75], v[140:143]
    s_waitcnt lgkmcnt(1)
    v_mfma_f32_16x16x32_bf16 v[136:139], v[120:123], v[76:79], v[136:139]
    s_waitcnt lgkmcnt(0)
    v_mfma_f32_16x16x32_bf16 v[140:143], v[124:127], v[76:79], v[140:143]
    s_barrier
    v_add_u32 v20, 139264, v10
    v_add_u32 v21, 139264, v11
    v_add_u32 v22, 151552, v10
    v_add_u32 v23, 151552, v11
    ds_read_b128 v[80:83], v20 offset:0
    ds_read_b128 v[84:87], v20 offset:6144
    ds_read_b128 v[88:91], v21 offset:0
    ds_read_b128 v[92:95], v21 offset:6144
    ds_read_b128 v[96:99], v20 offset:128
    ds_read_b128 v[100:103], v20 offset:6272
    ds_read_b128 v[104:107], v21 offset:128
    ds_read_b128 v[108:111], v21 offset:6272
    ds_read_b128 v[112:115], v20 offset:256
    ds_read_b128 v[116:119], v20 offset:6400
    ds_read_b128 v[120:123], v21 offset:256
    ds_read_b128 v[124:127], v21 offset:6400
    s_waitcnt lgkmcnt(11)
    v_mfma_f32_16x16x32_bf16 v[144:147], v[80:83], v[56:59], 0
    ds_read_b128 v[80:83], v22 offset:0
    v_max3_f32 v24, v128, v129, v130
    s_waitcnt lgkmcnt(11)
    v_mfma_f32_16x16x32_bf16 v[148:151], v[84:87], v[56:59], 0
    ds_read_b128 v[84:87], v22 offset:6144
    v_max3_f32 v24, v24, v131, v132
    s_waitcnt lgkmcnt(11)
    v_mfma_f32_16x16x32_bf16 v[144:147], v[88:91], v[60:63], v[144:147]
    ds_read_b128 v[88:91], v23 offset:0
    v_max3_f32 v24, v24, v133, v134
    s_waitcnt lgkmcnt(11)
    v_mfma_f32_16x16x32_bf16 v[148:151], v[92:95], v[60:63], v[148:151]
    ds_read_b128 v[92:95], v23 offset:6144
    v_max_f32 v24, v24, v135
    s_waitcnt lgkmcnt(11)
    v_mfma_f32_16x16x32_bf16 v[144:147], v[96:99], v[64:67], v[144:147]
    ds_read_b128 v[96:99], v22 offset:128
    v_max3_f32 v24, v24, v136, v137
    s_waitcnt lgkmcnt(11)
    v_mfma_f32_16x16x32_bf16 v[148:151], v[100:103], v[64:67], v[148:151]
    ds_read_b128 v[100:103], v22 offset:6272
    v_max3_f32 v24, v24, v138, v139
    s_waitcnt lgkmcnt(11)
    v_mfma_f32_16x16x32_bf16 v[144:147], v[104:107], v[68:71], v[144:147]
    ds_read_b128 v[104:107], v23 offset:128
    v_max3_f32 v24, v24, v140, v141
    s_waitcnt lgkmcnt(11)
    v_mfma_f32_16x16x32_bf16 v[148:151], v[108:111], v[68:71], v[148:151]
    ds_read_b128 v[108:111], v23 offset:6272
    v_max3_f32 v24, v24, v142, v143
    s_waitcnt lgkmcnt(11)
    v_mfma_f32_16x16x32_bf16 v[144:147], v[112:115], v[72:75], v[144:147]
    ds_read_b128 v[112:115], v22 offset:256
    s_waitcnt lgkmcnt(11)
    v_mfma_f32_16x16x32_bf16 v[148:151], v[116:119], v[72:75], v[148:151]
    ds_read_b128 v[116:119], v22 offset:6400
    s_waitcnt lgkmcnt(11)
    v_mfma_f32_16x16x32_bf16 v[144:147], v[120:123], v[76:79], v[144:147]
    ds_read_b128 v[120:123], v23 offset:256
    s_waitcnt lgkmcnt(11)
    v_mfma_f32_16x16x32_bf16 v[148:151], v[124:127], v[76:79], v[148:151]
    ds_read_b128 v[124:127], v23 offset:6400
    s_waitcnt lgkmcnt(11)
    v_mfma_f32_16x16x32_bf16 v[152:155], v[80:83], v[56:59], 0
    s_waitcnt lgkmcnt(10)
    v_mfma_f32_16x16x32_bf16 v[156:159], v[84:87], v[56:59], 0
    s_waitcnt lgkmcnt(9)
    v_mfma_f32_16x16x32_bf16 v[152:155], v[88:91], v[60:63], v[152:155]
    s_waitcnt lgkmcnt(8)
    v_mfma_f32_16x16x32_bf16 v[156:159], v[92:95], v[60:63], v[156:159]
    s_waitcnt lgkmcnt(7)
    v_mfma_f32_16x16x32_bf16 v[152:155], v[96:99], v[64:67], v[152:155]
    s_waitcnt lgkmcnt(6)
    v_mfma_f32_16x16x32_bf16 v[156:159], v[100:103], v[64:67], v[156:159]
    s_waitcnt lgkmcnt(5)
    v_mfma_f32_16x16x32_bf16 v[152:155], v[104:107], v[68:71], v[152:155]
    s_waitcnt lgkmcnt(4)
    v_mfma_f32_16x16x32_bf16 v[156:159], v[108:111], v[68:71], v[156:159]
    s_waitcnt lgkmcnt(3)
    v_mfma_f32_16x16x32_bf16 v[152:155], v[112:115], v[72:75], v[152:155]
    s_waitcnt lgkmcnt(2)
    v_mfma_f32_16x16x32_bf16 v[156:159], v[116:119], v[72:75], v[156:159]
    s_waitcnt lgkmcnt(1)
    v_mfma_f32_16x16x32_bf16 v[152:155], v[120:123], v[76:79], v[152:155]
    s_waitcnt lgkmcnt(0)
    v_mfma_f32_16x16x32_bf16 v[156:159], v[124:127], v[76:79], v[156:159]
    s_barrier
    v_add_u32 v20, 90112, v10
    v_add_u32 v21, 90112, v11
    v_add_u32 v22, 102400, v10
    v_add_u32 v23, 102400, v11
    ds_read_b128 v[80:83], v20 offset:0
    ds_read_b128 v[84:87], v20 offset:6144
    ds_read_b128 v[88:91], v21 offset:0
    ds_read_b128 v[92:95], v21 offset:6144
    ds_read_b128 v[96:99], v20 offset:128
    ds_read_b128 v[100:103], v20 offset:6272
    ds_read_b128 v[104:107], v21 offset:128
    ds_read_b128 v[108:111], v21 offset:6272
    ds_read_b128 v[112:115], v20 offset:256
    ds_read_b128 v[116:119], v20 offset:6400
    ds_read_b128 v[120:123], v21 offset:256
    ds_read_b128 v[124:127], v21 offset:6400
    s_waitcnt lgkmcnt(11)
    v_mfma_f32_16x16x32_bf16 v[160:163], v[80:83], v[56:59], 0
    ds_read_b128 v[80:83], v22 offset:0
    v_max3_f32 v24, v24, v144, v145
    s_waitcnt lgkmcnt(11)
    v_mfma_f32_16x16x32_bf16 v[164:167], v[84:87], v[56:59], 0
    ds_read_b128 v[84:87], v22 offset:6144
    v_max3_f32 v24, v24, v146, v147
    s_waitcnt lgkmcnt(11)
    v_mfma_f32_16x16x32_bf16 v[160:163], v[88:91], v[60:63], v[160:163]
    ds_read_b128 v[88:91], v23 offset:0
    v_max3_f32 v24, v24, v148, v149
    s_waitcnt lgkmcnt(11)
    v_mfma_f32_16x16x32_bf16 v[164:167], v[92:95], v[60:63], v[164:167]
    ds_read_b128 v[92:95], v23 offset:6144
    v_max3_f32 v24, v24, v150, v151
    s_waitcnt lgkmcnt(11)
    v_mfma_f32_16x16x32_bf16 v[160:163], v[96:99], v[64:67], v[160:163]
    ds_read_b128 v[96:99], v22 offset:128
    v_max3_f32 v24, v24, v152, v153
    s_waitcnt lgkmcnt(11)
    v_mfma_f32_16x16x32_bf16 v[164:167], v[100:103], v[64:67], v[164:167]
    ds_read_b128 v[100:103], v22 offset:6272
    v_max3_f32 v24, v24, v154, v155
    s_waitcnt lgkmcnt(11)
    v_mfma_f32_16x16x32_bf16 v[160:163], v[104:107], v[68:71], v[160:163]
    ds_read_b128 v[104:107], v23 offset:128
    v_max3_f32 v24, v24, v156, v157
    s_waitcnt lgkmcnt(11)
    v_mfma_f32_16x16x32_bf16 v[164:167], v[108:111], v[68:71], v[164:167]
    ds_read_b128 v[108:111], v23 offset:6272
    v_max3_f32 v24, v24, v158, v159
    s_waitcnt lgkmcnt(11)
    v_mfma_f32_16x16x32_bf16 v[160:163], v[112:115], v[72:75], v[160:163]
    ds_read_b128 v[112:115], v22 offset:256
    s_waitcnt lgkmcnt(11)
    v_mfma_f32_16x16x32_bf16 v[164:167], v[116:119], v[72:75], v[164:167]
    ds_read_b128 v[116:119], v22 offset:6400
    s_waitcnt lgkmcnt(11)
    v_mfma_f32_16x16x32_bf16 v[160:163], v[120:123], v[76:79], v[160:163]
    ds_read_b128 v[120:123], v23 offset:256
    s_waitcnt lgkmcnt(11)
    v_mfma_f32_16x16x32_bf16 v[164:167], v[124:127], v[76:79], v[164:167]
    ds_read_b128 v[124:127], v23 offset:6400
    s_waitcnt lgkmcnt(11)
    v_mfma_f32_16x16x32_bf16 v[168:171], v[80:83], v[56:59], 0
    s_waitcnt lgkmcnt(10)
    v_mfma_f32_16x16x32_bf16 v[172:175], v[84:87], v[56:59], 0
    s_waitcnt lgkmcnt(9)
    v_mfma_f32_16x16x32_bf16 v[168:171], v[88:91], v[60:63], v[168:171]
    s_waitcnt lgkmcnt(8)
    v_mfma_f32_16x16x32_bf16 v[172:175], v[92:95], v[60:63], v[172:175]
    s_waitcnt lgkmcnt(7)
    v_mfma_f32_16x16x32_bf16 v[168:171], v[96:99], v[64:67], v[168:171]
    s_waitcnt lgkmcnt(6)
    v_mfma_f32_16x16x32_bf16 v[172:175], v[100:103], v[64:67], v[172:175]
    s_waitcnt lgkmcnt(5)
    v_mfma_f32_16x16x32_bf16 v[168:171], v[104:107], v[68:71], v[168:171]
    s_waitcnt lgkmcnt(4)
    v_mfma_f32_16x16x32_bf16 v[172:175], v[108:111], v[68:71], v[172:175]
    s_waitcnt lgkmcnt(3)
    v_mfma_f32_16x16x32_bf16 v[168:171], v[112:115], v[72:75], v[168:171]
    s_waitcnt lgkmcnt(2)
    v_mfma_f32_16x16x32_bf16 v[172:175], v[116:119], v[72:75], v[172:175]
    s_waitcnt lgkmcnt(1)
    v_mfma_f32_16x16x32_bf16 v[168:171], v[120:123], v[76:79], v[168:171]
    s_waitcnt lgkmcnt(0)
    v_mfma_f32_16x16x32_bf16 v[172:175], v[124:127], v[76:79], v[172:175]
    s_barrier
    v_add_u32 v20, 114688, v10
    v_add_u32 v21, 114688, v11
    v_add_u32 v22, 126976, v10
    v_add_u32 v23, 126976, v11
    ds_read_b128 v[80:83], v20 offset:0
    ds_read_b128 v[84:87], v20 offset:6144
    ds_read_b128 v[88:91], v21 offset:0
    ds_read_b128 v[92:95], v21 offset:6144
    ds_read_b128 v[96:99], v20 offset:128
    ds_read_b128 v[100:103], v20 offset:6272
    ds_read_b128 v[104:107], v21 offset:128
    ds_read_b128 v[108:111], v21 offset:6272
    ds_read_b128 v[112:115], v20 offset:256
    ds_read_b128 v[116:119], v20 offset:6400
    ds_read_b128 v[120:123], v21 offset:256
    ds_read_b128 v[124:127], v21 offset:6400
    s_waitcnt lgkmcnt(11)
    v_mfma_f32_16x16x32_bf16 v[176:179], v[80:83], v[56:59], 0
    ds_read_b128 v[80:83], v22 offset:0
    v_max3_f32 v24, v24, v160, v161
    s_waitcnt lgkmcnt(11)
    v_mfma_f32_16x16x32_bf16 v[180:183], v[84:87], v[56:59], 0
    ds_read_b128 v[84:87], v22 offset:6144
    v_max3_f32 v24, v24, v162, v163
    s_waitcnt lgkmcnt(11)
    v_mfma_f32_16x16x32_bf16 v[176:179], v[88:91], v[60:63], v[176:179]
    ds_read_b128 v[88:91], v23 offset:0
    v_max3_f32 v24, v24, v164, v165
    s_waitcnt lgkmcnt(11)
    v_mfma_f32_16x16x32_bf16 v[180:183], v[92:95], v[60:63], v[180:183]
    ds_read_b128 v[92:95], v23 offset:6144
    v_max3_f32 v24, v24, v166, v167
    s_waitcnt lgkmcnt(11)
    v_mfma_f32_16x16x32_bf16 v[176:179], v[96:99], v[64:67], v[176:179]
    ds_read_b128 v[96:99], v22 offset:128
    v_max3_f32 v24, v24, v168, v169
    s_waitcnt lgkmcnt(11)
    v_mfma_f32_16x16x32_bf16 v[180:183], v[100:103], v[64:67], v[180:183]
    ds_read_b128 v[100:103], v22 offset:6272
    v_max3_f32 v24, v24, v170, v171
    s_waitcnt lgkmcnt(11)
    v_mfma_f32_16x16x32_bf16 v[176:179], v[104:107], v[68:71], v[176:179]
    ds_read_b128 v[104:107], v23 offset:128
    v_max3_f32 v24, v24, v172, v173
    s_waitcnt lgkmcnt(11)
    v_mfma_f32_16x16x32_bf16 v[180:183], v[108:111], v[68:71], v[180:183]
    ds_read_b128 v[108:111], v23 offset:6272
    v_max3_f32 v24, v24, v174, v175
    s_waitcnt lgkmcnt(11)
    v_mfma_f32_16x16x32_bf16 v[176:179], v[112:115], v[72:75], v[176:179]
    ds_read_b128 v[112:115], v22 offset:256
    s_waitcnt lgkmcnt(11)
    v_mfma_f32_16x16x32_bf16 v[180:183], v[116:119], v[72:75], v[180:183]
    ds_read_b128 v[116:119], v22 offset:6400
    s_waitcnt lgkmcnt(11)
    v_mfma_f32_16x16x32_bf16 v[176:179], v[120:123], v[76:79], v[176:179]
    ds_read_b128 v[120:123], v23 offset:256
    s_waitcnt lgkmcnt(11)
    v_mfma_f32_16x16x32_bf16 v[180:183], v[124:127], v[76:79], v[180:183]
    ds_read_b128 v[124:127], v23 offset:6400
    s_waitcnt lgkmcnt(11)
    v_mfma_f32_16x16x32_bf16 v[184:187], v[80:83], v[56:59], 0
    s_waitcnt lgkmcnt(10)
    v_mfma_f32_16x16x32_bf16 v[188:191], v[84:87], v[56:59], 0
    s_waitcnt lgkmcnt(9)
    v_mfma_f32_16x16x32_bf16 v[184:187], v[88:91], v[60:63], v[184:187]
    s_waitcnt lgkmcnt(8)
    v_mfma_f32_16x16x32_bf16 v[188:191], v[92:95], v[60:63], v[188:191]
    s_waitcnt lgkmcnt(7)
    v_mfma_f32_16x16x32_bf16 v[184:187], v[96:99], v[64:67], v[184:187]
    s_waitcnt lgkmcnt(6)
    v_mfma_f32_16x16x32_bf16 v[188:191], v[100:103], v[64:67], v[188:191]
    s_waitcnt lgkmcnt(5)
    v_mfma_f32_16x16x32_bf16 v[184:187], v[104:107], v[68:71], v[184:187]
    s_waitcnt lgkmcnt(4)
    v_mfma_f32_16x16x32_bf16 v[188:191], v[108:111], v[68:71], v[188:191]
    s_waitcnt lgkmcnt(3)
    v_mfma_f32_16x16x32_bf16 v[184:187], v[112:115], v[72:75], v[184:187]
    s_waitcnt lgkmcnt(2)
    v_mfma_f32_16x16x32_bf16 v[188:191], v[116:119], v[72:75], v[188:191]
    s_waitcnt lgkmcnt(1)
    v_mfma_f32_16x16x32_bf16 v[184:187], v[120:123], v[76:79], v[184:187]
    s_waitcnt lgkmcnt(0)
    v_mfma_f32_16x16x32_bf16 v[188:191], v[124:127], v[76:79], v[188:191]
    s_barrier
    v_add_u32 v20, 139264, v10
    v_add_u32 v21, 139264, v11
    v_add_u32 v22, 151552, v10
    v_add_u32 v23, 151552, v11
    ds_read_b128 v[80:83], v20 offset:0
    ds_read_b128 v[84:87], v20 offset:6144
    ds_read_b128 v[88:91], v21 offset:0
    ds_read_b128 v[92:95], v21 offset:6144
    ds_read_b128 v[96:99], v20 offset:128
    ds_read_b128 v[100:103], v20 offset:6272
    ds_read_b128 v[104:107], v21 offset:128
    ds_read_b128 v[108:111], v21 offset:6272
    ds_read_b128 v[112:115], v20 offset:256
    ds_read_b128 v[116:119], v20 offset:6400
    ds_read_b128 v[120:123], v21 offset:256
    ds_read_b128 v[124:127], v21 offset:6400
    s_waitcnt lgkmcnt(11)
    v_mfma_f32_16x16x32_bf16 v[192:195], v[80:83], v[56:59], 0
    ds_read_b128 v[80:83], v22 offset:0
    v_max3_f32 v24, v24, v176, v177
    s_waitcnt lgkmcnt(11)
    v_mfma_f32_16x16x32_bf16 v[196:199], v[84:87], v[56:59], 0
    ds_read_b128 v[84:87], v22 offset:6144
    v_max3_f32 v24, v24, v178, v179
    s_waitcnt lgkmcnt(11)
    v_mfma_f32_16x16x32_bf16 v[192:195], v[88:91], v[60:63], v[192:195]
    ds_read_b128 v[88:91], v23 offset:0
    v_max3_f32 v24, v24, v180, v181
    s_waitcnt lgkmcnt(11)
    v_mfma_f32_16x16x32_bf16 v[196:199], v[92:95], v[60:63], v[196:199]
    ds_read_b128 v[92:95], v23 offset:6144
    v_max3_f32 v24, v24, v182, v183
    s_waitcnt lgkmcnt(11)
    v_mfma_f32_16x16x32_bf16 v[192:195], v[96:99], v[64:67], v[192:195]
    ds_read_b128 v[96:99], v22 offset:128
    v_max3_f32 v24, v24, v184, v185
    s_waitcnt lgkmcnt(11)
    v_mfma_f32_16x16x32_bf16 v[196:199], v[100:103], v[64:67], v[196:199]
    ds_read_b128 v[100:103], v22 offset:6272
    v_max3_f32 v24, v24, v186, v187
    s_waitcnt lgkmcnt(11)
    v_mfma_f32_16x16x32_bf16 v[192:195], v[104:107], v[68:71], v[192:195]
    ds_read_b128 v[104:107], v23 offset:128
    v_max3_f32 v24, v24, v188, v189
    s_waitcnt lgkmcnt(11)
    v_mfma_f32_16x16x32_bf16 v[196:199], v[108:111], v[68:71], v[196:199]
    ds_read_b128 v[108:111], v23 offset:6272
    v_max3_f32 v24, v24, v190, v191
    s_waitcnt lgkmcnt(11)
    v_mfma_f32_16x16x32_bf16 v[192:195], v[112:115], v[72:75], v[192:195]
    ds_read_b128 v[112:115], v22 offset:256
    s_waitcnt lgkmcnt(11)
    v_mfma_f32_16x16x32_bf16 v[196:199], v[116:119], v[72:75], v[196:199]
    ds_read_b128 v[116:119], v22 offset:6400
    s_waitcnt lgkmcnt(11)
    v_mfma_f32_16x16x32_bf16 v[192:195], v[120:123], v[76:79], v[192:195]
    ds_read_b128 v[120:123], v23 offset:256
    s_waitcnt lgkmcnt(11)
    v_mfma_f32_16x16x32_bf16 v[196:199], v[124:127], v[76:79], v[196:199]
    ds_read_b128 v[124:127], v23 offset:6400
    s_waitcnt lgkmcnt(11)
    v_mfma_f32_16x16x32_bf16 v[200:203], v[80:83], v[56:59], 0
    s_waitcnt lgkmcnt(10)
    v_mfma_f32_16x16x32_bf16 v[204:207], v[84:87], v[56:59], 0
    s_waitcnt lgkmcnt(9)
    v_mfma_f32_16x16x32_bf16 v[200:203], v[88:91], v[60:63], v[200:203]
    s_waitcnt lgkmcnt(8)
    v_mfma_f32_16x16x32_bf16 v[204:207], v[92:95], v[60:63], v[204:207]
    s_waitcnt lgkmcnt(7)
    v_mfma_f32_16x16x32_bf16 v[200:203], v[96:99], v[64:67], v[200:203]
    s_waitcnt lgkmcnt(6)
    v_mfma_f32_16x16x32_bf16 v[204:207], v[100:103], v[64:67], v[204:207]
    s_waitcnt lgkmcnt(5)
    v_mfma_f32_16x16x32_bf16 v[200:203], v[104:107], v[68:71], v[200:203]
    s_waitcnt lgkmcnt(4)
    v_mfma_f32_16x16x32_bf16 v[204:207], v[108:111], v[68:71], v[204:207]
    s_waitcnt lgkmcnt(3)
    v_mfma_f32_16x16x32_bf16 v[200:203], v[112:115], v[72:75], v[200:203]
    s_waitcnt lgkmcnt(2)
    v_mfma_f32_16x16x32_bf16 v[204:207], v[116:119], v[72:75], v[204:207]
    s_waitcnt lgkmcnt(1)
    v_mfma_f32_16x16x32_bf16 v[200:203], v[120:123], v[76:79], v[200:203]
    s_waitcnt lgkmcnt(0)
    v_mfma_f32_16x16x32_bf16 v[204:207], v[124:127], v[76:79], v[204:207]
    s_barrier
    v_add_u32 v20, 90112, v10
    v_add_u32 v21, 90112, v11
    v_add_u32 v22, 102400, v10
    v_add_u32 v23, 102400, v11
    ds_read_b128 v[80:83], v20 offset:0
    ds_read_b128 v[84:87], v20 offset:6144
    ds_read_b128 v[88:91], v21 offset:0
    ds_read_b128 v[92:95], v21 offset:6144
    ds_read_b128 v[96:99], v20 offset:128
    ds_read_b128 v[100:103], v20 offset:6272
    ds_read_b128 v[104:107], v21 offset:128
    ds_read_b128 v[108:111], v21 offset:6272
    ds_read_b128 v[112:115], v20 offset:256
    ds_read_b128 v[116:119], v20 offset:6400
    ds_read_b128 v[120:123], v21 offset:256
    ds_read_b128 v[124:127], v21 offset:6400
    s_waitcnt lgkmcnt(11)
    v_mfma_f32_16x16x32_bf16 v[208:211], v[80:83], v[56:59], 0
    ds_read_b128 v[80:83], v22 offset:0
    v_max3_f32 v24, v24, v192, v193
    s_waitcnt lgkmcnt(11)
    v_mfma_f32_16x16x32_bf16 v[212:215], v[84:87], v[56:59], 0
    ds_read_b128 v[84:87], v22 offset:6144
    v_max3_f32 v24, v24, v194, v195
    s_waitcnt lgkmcnt(11)
    v_mfma_f32_16x16x32_bf16 v[208:211], v[88:91], v[60:63], v[208:211]
    ds_read_b128 v[88:91], v23 offset:0
    v_max3_f32 v24, v24, v196, v197
    s_waitcnt lgkmcnt(11)
    v_mfma_f32_16x16x32_bf16 v[212:215], v[92:95], v[60:63], v[212:215]
    ds_read_b128 v[92:95], v23 offset:6144
    v_max3_f32 v24, v24, v198, v199
    s_waitcnt lgkmcnt(11)
    v_mfma_f32_16x16x32_bf16 v[208:211], v[96:99], v[64:67], v[208:211]
    ds_read_b128 v[96:99], v22 offset:128
    v_max3_f32 v24, v24, v200, v201
    s_waitcnt lgkmcnt(11)
    v_mfma_f32_16x16x32_bf16 v[212:215], v[100:103], v[64:67], v[212:215]
    ds_read_b128 v[100:103], v22 offset:6272
    v_max3_f32 v24, v24, v202, v203
    s_waitcnt lgkmcnt(11)
    v_mfma_f32_16x16x32_bf16 v[208:211], v[104:107], v[68:71], v[208:211]
    ds_read_b128 v[104:107], v23 offset:128
    v_max3_f32 v24, v24, v204, v205
    s_waitcnt lgkmcnt(11)
    v_mfma_f32_16x16x32_bf16 v[212:215], v[108:111], v[68:71], v[212:215]
    ds_read_b128 v[108:111], v23 offset:6272
    v_max3_f32 v24, v24, v206, v207
    s_waitcnt lgkmcnt(11)
    v_mfma_f32_16x16x32_bf16 v[208:211], v[112:115], v[72:75], v[208:211]
    ds_read_b128 v[112:115], v22 offset:256
    s_waitcnt lgkmcnt(11)
    v_mfma_f32_16x16x32_bf16 v[212:215], v[116:119], v[72:75], v[212:215]
    ds_read_b128 v[116:119], v22 offset:6400
    s_waitcnt lgkmcnt(11)
    v_mfma_f32_16x16x32_bf16 v[208:211], v[120:123], v[76:79], v[208:211]
    ds_read_b128 v[120:123], v23 offset:256
    s_waitcnt lgkmcnt(11)
    v_mfma_f32_16x16x32_bf16 v[212:215], v[124:127], v[76:79], v[212:215]
    ds_read_b128 v[124:127], v23 offset:6400
    s_waitcnt lgkmcnt(11)
    v_mfma_f32_16x16x32_bf16 v[216:219], v[80:83], v[56:59], 0
    s_waitcnt lgkmcnt(10)
    v_mfma_f32_16x16x32_bf16 v[220:223], v[84:87], v[56:59], 0
    s_waitcnt lgkmcnt(9)
    v_mfma_f32_16x16x32_bf16 v[216:219], v[88:91], v[60:63], v[216:219]
    s_waitcnt lgkmcnt(8)
    v_mfma_f32_16x16x32_bf16 v[220:223], v[92:95], v[60:63], v[220:223]
    s_waitcnt lgkmcnt(7)
    v_mfma_f32_16x16x32_bf16 v[216:219], v[96:99], v[64:67], v[216:219]
    s_waitcnt lgkmcnt(6)
    v_mfma_f32_16x16x32_bf16 v[220:223], v[100:103], v[64:67], v[220:223]
    s_waitcnt lgkmcnt(5)
    v_mfma_f32_16x16x32_bf16 v[216:219], v[104:107], v[68:71], v[216:219]
    s_waitcnt lgkmcnt(4)
    v_mfma_f32_16x16x32_bf16 v[220:223], v[108:111], v[68:71], v[220:223]
    s_waitcnt lgkmcnt(3)
    v_mfma_f32_16x16x32_bf16 v[216:219], v[112:115], v[72:75], v[216:219]
    s_waitcnt lgkmcnt(2)
    v_mfma_f32_16x16x32_bf16 v[220:223], v[116:119], v[72:75], v[220:223]
    s_waitcnt lgkmcnt(1)
    v_mfma_f32_16x16x32_bf16 v[216:219], v[120:123], v[76:79], v[216:219]
    s_waitcnt lgkmcnt(0)
    v_mfma_f32_16x16x32_bf16 v[220:223], v[124:127], v[76:79], v[220:223]
    s_barrier
    v_add_u32 v20, 114688, v10
    v_add_u32 v21, 114688, v11
    v_add_u32 v22, 126976, v10
    v_add_u32 v23, 126976, v11
    ds_read_b128 v[80:83], v20 offset:0
    ds_read_b128 v[84:87], v20 offset:6144
    ds_read_b128 v[88:91], v21 offset:0
    ds_read_b128 v[92:95], v21 offset:6144
    ds_read_b128 v[96:99], v20 offset:128
    ds_read_b128 v[100:103], v20 offset:6272
    ds_read_b128 v[104:107], v21 offset:128
    ds_read_b128 v[108:111], v21 offset:6272
    ds_read_b128 v[112:115], v20 offset:256
    ds_read_b128 v[116:119], v20 offset:6400
    ds_read_b128 v[120:123], v21 offset:256
    ds_read_b128 v[124:127], v21 offset:6400
    s_waitcnt lgkmcnt(11)
    v_mfma_f32_16x16x32_bf16 v[224:227], v[80:83], v[56:59], 0
    ds_read_b128 v[80:83], v22 offset:0
    v_max3_f32 v24, v24, v208, v209
    s_waitcnt lgkmcnt(11)
    v_mfma_f32_16x16x32_bf16 v[228:231], v[84:87], v[56:59], 0
    ds_read_b128 v[84:87], v22 offset:6144
    v_max3_f32 v24, v24, v210, v211
    s_waitcnt lgkmcnt(11)
    v_mfma_f32_16x16x32_bf16 v[224:227], v[88:91], v[60:63], v[224:227]
    ds_read_b128 v[88:91], v23 offset:0
    v_max3_f32 v24, v24, v212, v213
    s_waitcnt lgkmcnt(11)
    v_mfma_f32_16x16x32_bf16 v[228:231], v[92:95], v[60:63], v[228:231]
    ds_read_b128 v[92:95], v23 offset:6144
    v_max3_f32 v24, v24, v214, v215
    s_waitcnt lgkmcnt(11)
    v_mfma_f32_16x16x32_bf16 v[224:227], v[96:99], v[64:67], v[224:227]
    ds_read_b128 v[96:99], v22 offset:128
    v_max3_f32 v24, v24, v216, v217
    s_waitcnt lgkmcnt(11)
    v_mfma_f32_16x16x32_bf16 v[228:231], v[100:103], v[64:67], v[228:231]
    ds_read_b128 v[100:103], v22 offset:6272
    v_max3_f32 v24, v24, v218, v219
    s_waitcnt lgkmcnt(11)
    v_mfma_f32_16x16x32_bf16 v[224:227], v[104:107], v[68:71], v[224:227]
    ds_read_b128 v[104:107], v23 offset:128
    v_max3_f32 v24, v24, v220, v221
    s_waitcnt lgkmcnt(11)
    v_mfma_f32_16x16x32_bf16 v[228:231], v[108:111], v[68:71], v[228:231]
    ds_read_b128 v[108:111], v23 offset:6272
    v_max3_f32 v24, v24, v222, v223
    s_waitcnt lgkmcnt(11)
    v_mfma_f32_16x16x32_bf16 v[224:227], v[112:115], v[72:75], v[224:227]
    ds_read_b128 v[112:115], v22 offset:256
    s_waitcnt lgkmcnt(11)
    v_mfma_f32_16x16x32_bf16 v[228:231], v[116:119], v[72:75], v[228:231]
    ds_read_b128 v[116:119], v22 offset:6400
    s_waitcnt lgkmcnt(11)
    v_mfma_f32_16x16x32_bf16 v[224:227], v[120:123], v[76:79], v[224:227]
    ds_read_b128 v[120:123], v23 offset:256
    s_waitcnt lgkmcnt(11)
    v_mfma_f32_16x16x32_bf16 v[228:231], v[124:127], v[76:79], v[228:231]
    ds_read_b128 v[124:127], v23 offset:6400
    s_waitcnt lgkmcnt(11)
    v_mfma_f32_16x16x32_bf16 v[232:235], v[80:83], v[56:59], 0
    s_waitcnt lgkmcnt(10)
    v_mfma_f32_16x16x32_bf16 v[236:239], v[84:87], v[56:59], 0
    s_waitcnt lgkmcnt(9)
    v_mfma_f32_16x16x32_bf16 v[232:235], v[88:91], v[60:63], v[232:235]
    s_waitcnt lgkmcnt(8)
    v_mfma_f32_16x16x32_bf16 v[236:239], v[92:95], v[60:63], v[236:239]
    s_waitcnt lgkmcnt(7)
    v_mfma_f32_16x16x32_bf16 v[232:235], v[96:99], v[64:67], v[232:235]
    s_waitcnt lgkmcnt(6)
    v_mfma_f32_16x16x32_bf16 v[236:239], v[100:103], v[64:67], v[236:239]
    s_waitcnt lgkmcnt(5)
    v_mfma_f32_16x16x32_bf16 v[232:235], v[104:107], v[68:71], v[232:235]
    s_waitcnt lgkmcnt(4)
    v_mfma_f32_16x16x32_bf16 v[236:239], v[108:111], v[68:71], v[236:239]
    s_waitcnt lgkmcnt(3)
    v_mfma_f32_16x16x32_bf16 v[232:235], v[112:115], v[72:75], v[232:235]
    s_waitcnt lgkmcnt(2)
    v_mfma_f32_16x16x32_bf16 v[236:239], v[116:119], v[72:75], v[236:239]
    s_waitcnt lgkmcnt(1)
    v_mfma_f32_16x16x32_bf16 v[232:235], v[120:123], v[76:79], v[232:235]
    s_waitcnt lgkmcnt(0)
    v_mfma_f32_16x16x32_bf16 v[236:239], v[124:127], v[76:79], v[236:239]
    s_barrier
    v_add_u32 v20, 139264, v10
    v_add_u32 v21, 139264, v11
    v_add_u32 v22, 151552, v10
    v_add_u32 v23, 151552, v11
    ds_read_b128 v[80:83], v20 offset:0
    ds_read_b128 v[84:87], v20 offset:6144
    ds_read_b128 v[88:91], v21 offset:0
    ds_read_b128 v[92:95], v21 offset:6144
    ds_read_b128 v[96:99], v20 offset:128
    ds_read_b128 v[100:103], v20 offset:6272
    ds_read_b128 v[104:107], v21 offset:128
    ds_read_b128 v[108:111], v21 offset:6272
    ds_read_b128 v[112:115], v20 offset:256
    ds_read_b128 v[116:119], v20 offset:6400
    ds_read_b128 v[120:123], v21 offset:256
    ds_read_b128 v[124:127], v21 offset:6400
    s_waitcnt lgkmcnt(11)
    v_mfma_f32_16x16x32_bf16 v[240:243], v[80:83], v[56:59], 0
    ds_read_b128 v[80:83], v22 offset:0
    v_max3_f32 v24, v24, v224, v225
    s_waitcnt lgkmcnt(11)
    v_mfma_f32_16x16x32_bf16 v[244:247], v[84:87], v[56:59], 0
    ds_read_b128 v[84:87], v22 offset:6144
    v_max3_f32 v24, v24, v226, v227
    s_waitcnt lgkmcnt(11)
    v_mfma_f32_16x16x32_bf16 v[240:243], v[88:91], v[60:63], v[240:243]
    ds_read_b128 v[88:91], v23 offset:0
    v_max3_f32 v24, v24, v228, v229
    s_waitcnt lgkmcnt(11)
    v_mfma_f32_16x16x32_bf16 v[244:247], v[92:95], v[60:63], v[244:247]
    ds_read_b128 v[92:95], v23 offset:6144
    v_max3_f32 v24, v24, v230, v231
    s_waitcnt lgkmcnt(11)
    v_mfma_f32_16x16x32_bf16 v[240:243], v[96:99], v[64:67], v[240:243]
    ds_read_b128 v[96:99], v22 offset:128
    v_max3_f32 v24, v24, v232, v233
    s_waitcnt lgkmcnt(11)
    v_mfma_f32_16x16x32_bf16 v[244:247], v[100:103], v[64:67], v[244:247]
    ds_read_b128 v[100:103], v22 offset:6272
    v_max3_f32 v24, v24, v234, v235
    s_waitcnt lgkmcnt(11)
    v_mfma_f32_16x16x32_bf16 v[240:243], v[104:107], v[68:71], v[240:243]
    ds_read_b128 v[104:107], v23 offset:128
    v_max3_f32 v24, v24, v236, v237
    s_waitcnt lgkmcnt(11)
    v_mfma_f32_16x16x32_bf16 v[244:247], v[108:111], v[68:71], v[244:247]
    ds_read_b128 v[108:111], v23 offset:6272
    v_max3_f32 v24, v24, v238, v239
    s_waitcnt lgkmcnt(11)
    v_mfma_f32_16x16x32_bf16 v[240:243], v[112:115], v[72:75], v[240:243]
    ds_read_b128 v[112:115], v22 offset:256
    s_waitcnt lgkmcnt(11)
    v_mfma_f32_16x16x32_bf16 v[244:247], v[116:119], v[72:75], v[244:247]
    ds_read_b128 v[116:119], v22 offset:6400
    s_waitcnt lgkmcnt(11)
    v_mfma_f32_16x16x32_bf16 v[240:243], v[120:123], v[76:79], v[240:243]
    ds_read_b128 v[120:123], v23 offset:256
    s_waitcnt lgkmcnt(11)
    v_mfma_f32_16x16x32_bf16 v[244:247], v[124:127], v[76:79], v[244:247]
    ds_read_b128 v[124:127], v23 offset:6400
    s_waitcnt lgkmcnt(11)
    v_mfma_f32_16x16x32_bf16 v[248:251], v[80:83], v[56:59], 0
    s_waitcnt lgkmcnt(10)
    v_mfma_f32_16x16x32_bf16 v[252:255], v[84:87], v[56:59], 0
    s_waitcnt lgkmcnt(9)
    v_mfma_f32_16x16x32_bf16 v[248:251], v[88:91], v[60:63], v[248:251]
    s_waitcnt lgkmcnt(8)
    v_mfma_f32_16x16x32_bf16 v[252:255], v[92:95], v[60:63], v[252:255]
    s_waitcnt lgkmcnt(7)
    v_mfma_f32_16x16x32_bf16 v[248:251], v[96:99], v[64:67], v[248:251]
    s_waitcnt lgkmcnt(6)
    v_mfma_f32_16x16x32_bf16 v[252:255], v[100:103], v[64:67], v[252:255]
    s_waitcnt lgkmcnt(5)
    v_mfma_f32_16x16x32_bf16 v[248:251], v[104:107], v[68:71], v[248:251]
    s_waitcnt lgkmcnt(4)
    v_mfma_f32_16x16x32_bf16 v[252:255], v[108:111], v[68:71], v[252:255]
    s_waitcnt lgkmcnt(3)
    v_mfma_f32_16x16x32_bf16 v[248:251], v[112:115], v[72:75], v[248:251]
    s_waitcnt lgkmcnt(2)
    v_mfma_f32_16x16x32_bf16 v[252:255], v[116:119], v[72:75], v[252:255]
    s_waitcnt lgkmcnt(1)
    v_mfma_f32_16x16x32_bf16 v[248:251], v[120:123], v[76:79], v[248:251]
    s_waitcnt lgkmcnt(0)
    v_mfma_f32_16x16x32_bf16 v[252:255], v[124:127], v[76:79], v[252:255]
    s_barrier
    v_add_u32 v20, 90112, v12
    v_add_u32 v21, 90112, v13
    v_add_u32 v22, 90112, v14
    v_add_u32 v23, 90112, v15
    v_add_u32 v4, 98304, v12
    v_add_u32 v5, 98304, v13
    v_add_u32 v6, 98304, v14
    v_add_u32 v7, 98304, v15
    ds_read_b64_tr_b16 v[80:81], v20 offset:0
    ds_read_b64_tr_b16 v[82:83], v20 offset:2048
    ds_read_b64_tr_b16 v[84:85], v21 offset:0
    ds_read_b64_tr_b16 v[86:87], v21 offset:2048
    ds_read_b64_tr_b16 v[88:89], v22 offset:0
    ds_read_b64_tr_b16 v[90:91], v22 offset:2048
    ds_read_b64_tr_b16 v[92:93], v23 offset:0
    ds_read_b64_tr_b16 v[94:95], v23 offset:2048
    ds_read_b64_tr_b16 v[96:97], v20 offset:4096
    ds_read_b64_tr_b16 v[98:99], v20 offset:6144
    ds_read_b64_tr_b16 v[100:101], v21 offset:4096
    ds_read_b64_tr_b16 v[102:103], v21 offset:6144
    ds_read_b64_tr_b16 v[104:105], v22 offset:4096
    ds_read_b64_tr_b16 v[106:107], v22 offset:6144
    ds_read_b64_tr_b16 v[108:109], v23 offset:4096
    s_waitcnt lgkmcnt(14)
    ds_read_b64_tr_b16 v[110:111], v23 offset:6144
    s_waitcnt lgkmcnt(14)
    ds_read_b64_tr_b16 v[112:113], v4 offset:0
    s_waitcnt lgkmcnt(14)
    ds_read_b64_tr_b16 v[114:115], v4 offset:2048
    s_waitcnt lgkmcnt(14)
    ds_read_b64_tr_b16 v[116:117], v5 offset:0
    s_waitcnt lgkmcnt(14)
    ds_read_b64_tr_b16 v[118:119], v5 offset:2048
    s_waitcnt lgkmcnt(14)
    ds_read_b64_tr_b16 v[120:121], v6 offset:0
    s_waitcnt lgkmcnt(14)
    ds_read_b64_tr_b16 v[122:123], v6 offset:2048
    s_waitcnt lgkmcnt(14)
    ds_read_b64_tr_b16 v[124:125], v7 offset:0
    s_waitcnt lgkmcnt(14)
    ds_read_b64_tr_b16 v[126:127], v7 offset:2048
    v_max3_f32 v24, v24, v240, v241
    v_max3_f32 v24, v24, v242, v243
    v_max3_f32 v24, v24, v244, v245
    v_max3_f32 v24, v24, v246, v247
    v_max3_f32 v24, v24, v248, v249
    v_max3_f32 v24, v24, v250, v251
    v_max3_f32 v24, v24, v252, v253
    v_max3_f32 v24, v24, v254, v255
    v_mov_b32 v27, v24
    s_nop 1
    v_permlane32_swap_b32 v27, v24
    v_max_f32 v24, v24, v27
    v_mov_b32 v27, v24
    s_nop 1
    v_permlane16_swap_b32 v27, v24
    v_max_f32 v24, v24, v27
    v_mul_f32 v25, s65, v24
    v_fma_f32 v128, v128, s65, -v25
    v_fma_f32 v129, v129, s65, -v25
    v_fma_f32 v130, v130, s65, -v25
    v_fma_f32 v131, v131, s65, -v25
    v_fma_f32 v132, v132, s65, -v25
    v_fma_f32 v133, v133, s65, -v25
    v_fma_f32 v134, v134, s65, -v25
    v_fma_f32 v135, v135, s65, -v25
    v_exp_f32 v128, v128
    v_exp_f32 v129, v129
    v_exp_f32 v130, v130
    v_exp_f32 v131, v131
    v_exp_f32 v132, v132
    v_exp_f32 v133, v133
    v_exp_f32 v134, v134
    v_exp_f32 v135, v135
    v_cvt_pk_bf16_f32 v128, v128, v129
    v_cvt_pk_bf16_f32 v129, v130, v131
    v_cvt_pk_bf16_f32 v130, v132, v133
    v_cvt_pk_bf16_f32 v131, v134, v135
    s_nop 1
    v_mfma_f32_16x16x32_bf16 v[40:43], v[80:83], v[128:131], 0
    s_waitcnt lgkmcnt(14)
    ds_read_b64_tr_b16 v[80:81], v4 offset:4096
    s_waitcnt lgkmcnt(14)
    ds_read_b64_tr_b16 v[82:83], v4 offset:6144
    v_fma_f32 v136, v136, s65, -v25
    v_fma_f32 v137, v137, s65, -v25
    v_fma_f32 v138, v138, s65, -v25
    v_fma_f32 v139, v139, s65, -v25
    v_fma_f32 v140, v140, s65, -v25
    v_mfma_f32_16x16x32_bf16 v[44:47], v[84:87], v[128:131], 0
    s_waitcnt lgkmcnt(14)
    ds_read_b64_tr_b16 v[84:85], v5 offset:4096
    s_waitcnt lgkmcnt(14)
    ds_read_b64_tr_b16 v[86:87], v5 offset:6144
    v_fma_f32 v141, v141, s65, -v25
    v_fma_f32 v142, v142, s65, -v25
    v_fma_f32 v143, v143, s65, -v25
    v_exp_f32 v136, v136
    v_exp_f32 v137, v137
    v_mfma_f32_16x16x32_bf16 v[48:51], v[88:91], v[128:131], 0
    s_waitcnt lgkmcnt(14)
    ds_read_b64_tr_b16 v[88:89], v6 offset:4096
    s_waitcnt lgkmcnt(14)
    ds_read_b64_tr_b16 v[90:91], v6 offset:6144
    v_exp_f32 v138, v138
    v_exp_f32 v139, v139
    v_exp_f32 v140, v140
    v_exp_f32 v141, v141
    v_exp_f32 v142, v142
    v_mfma_f32_16x16x32_bf16 v[52:55], v[92:95], v[128:131], 0
    v_mfma_f32_16x16x32_bf16 v[36:39], v[32:35], v[128:131], 0
    s_waitcnt lgkmcnt(14)
    ds_read_b64_tr_b16 v[92:93], v7 offset:4096
    s_waitcnt lgkmcnt(14)
    ds_read_b64_tr_b16 v[94:95], v7 offset:6144
    v_exp_f32 v143, v143
    v_cvt_pk_bf16_f32 v136, v136, v137
    v_cvt_pk_bf16_f32 v137, v138, v139
    v_cvt_pk_bf16_f32 v138, v140, v141
    v_cvt_pk_bf16_f32 v139, v142, v143
    s_nop 1
    v_mfma_f32_16x16x32_bf16 v[40:43], v[96:99], v[136:139], v[40:43]
    v_fma_f32 v144, v144, s65, -v25
    v_fma_f32 v145, v145, s65, -v25
    v_fma_f32 v146, v146, s65, -v25
    v_fma_f32 v147, v147, s65, -v25
    v_fma_f32 v148, v148, s65, -v25
    v_mfma_f32_16x16x32_bf16 v[44:47], v[100:103], v[136:139], v[44:47]
    v_fma_f32 v149, v149, s65, -v25
    v_fma_f32 v150, v150, s65, -v25
    v_fma_f32 v151, v151, s65, -v25
    v_exp_f32 v144, v144
    v_exp_f32 v145, v145
    v_mfma_f32_16x16x32_bf16 v[48:51], v[104:107], v[136:139], v[48:51]
    v_exp_f32 v146, v146
    v_exp_f32 v147, v147
    v_exp_f32 v148, v148
    v_exp_f32 v149, v149
    v_exp_f32 v150, v150
    v_mfma_f32_16x16x32_bf16 v[52:55], v[108:111], v[136:139], v[52:55]
    v_mfma_f32_16x16x32_bf16 v[36:39], v[32:35], v[136:139], v[36:39]
    v_exp_f32 v151, v151
    v_cvt_pk_bf16_f32 v144, v144, v145
    v_cvt_pk_bf16_f32 v145, v146, v147
    v_cvt_pk_bf16_f32 v146, v148, v149
    v_cvt_pk_bf16_f32 v147, v150, v151
    s_waitcnt lgkmcnt(14)
    s_nop 0
    v_mfma_f32_16x16x32_bf16 v[40:43], v[112:115], v[144:147], v[40:43]
    v_fma_f32 v152, v152, s65, -v25
    v_fma_f32 v153, v153, s65, -v25
    v_fma_f32 v154, v154, s65, -v25
    v_fma_f32 v155, v155, s65, -v25
    v_fma_f32 v156, v156, s65, -v25
    s_waitcnt lgkmcnt(12)
    v_mfma_f32_16x16x32_bf16 v[44:47], v[116:119], v[144:147], v[44:47]
    v_fma_f32 v157, v157, s65, -v25
    v_fma_f32 v158, v158, s65, -v25
    v_fma_f32 v159, v159, s65, -v25
    v_exp_f32 v152, v152
    v_exp_f32 v153, v153
    s_waitcnt lgkmcnt(10)
    v_mfma_f32_16x16x32_bf16 v[48:51], v[120:123], v[144:147], v[48:51]
    v_exp_f32 v154, v154
    v_exp_f32 v155, v155
    v_exp_f32 v156, v156
    v_exp_f32 v157, v157
    v_exp_f32 v158, v158
    s_waitcnt lgkmcnt(8)
    v_mfma_f32_16x16x32_bf16 v[52:55], v[124:127], v[144:147], v[52:55]
    v_mfma_f32_16x16x32_bf16 v[36:39], v[32:35], v[144:147], v[36:39]
    v_exp_f32 v159, v159
    v_cvt_pk_bf16_f32 v152, v152, v153
    v_cvt_pk_bf16_f32 v153, v154, v155
    v_cvt_pk_bf16_f32 v154, v156, v157
    v_cvt_pk_bf16_f32 v155, v158, v159
    s_waitcnt lgkmcnt(6)
    s_nop 0
    v_mfma_f32_16x16x32_bf16 v[40:43], v[80:83], v[152:155], v[40:43]
    v_fma_f32 v160, v160, s65, -v25
    v_fma_f32 v161, v161, s65, -v25
    v_fma_f32 v162, v162, s65, -v25
    v_fma_f32 v163, v163, s65, -v25
    v_fma_f32 v164, v164, s65, -v25
    s_waitcnt lgkmcnt(4)
    v_mfma_f32_16x16x32_bf16 v[44:47], v[84:87], v[152:155], v[44:47]
    v_fma_f32 v165, v165, s65, -v25
    v_fma_f32 v166, v166, s65, -v25
    v_fma_f32 v167, v167, s65, -v25
    v_exp_f32 v160, v160
    v_exp_f32 v161, v161
    s_waitcnt lgkmcnt(2)
    v_mfma_f32_16x16x32_bf16 v[48:51], v[88:91], v[152:155], v[48:51]
    v_exp_f32 v162, v162
    v_exp_f32 v163, v163
    v_exp_f32 v164, v164
    v_exp_f32 v165, v165
    v_exp_f32 v166, v166
    s_waitcnt lgkmcnt(0)
    v_mfma_f32_16x16x32_bf16 v[52:55], v[92:95], v[152:155], v[52:55]
    v_mfma_f32_16x16x32_bf16 v[36:39], v[32:35], v[152:155], v[36:39]
    v_exp_f32 v167, v167
    v_cvt_pk_bf16_f32 v160, v160, v161
    v_cvt_pk_bf16_f32 v161, v162, v163
    v_cvt_pk_bf16_f32 v162, v164, v165
    v_cvt_pk_bf16_f32 v163, v166, v167
    s_barrier
    v_add_u32 v20, 106496, v12
    v_add_u32 v21, 106496, v13
    v_add_u32 v22, 106496, v14
    v_add_u32 v23, 106496, v15
    v_add_u32 v4, 114688, v12
    v_add_u32 v5, 114688, v13
    v_add_u32 v6, 114688, v14
    v_add_u32 v7, 114688, v15
    ds_read_b64_tr_b16 v[80:81], v20 offset:0
    ds_read_b64_tr_b16 v[82:83], v20 offset:2048
    ds_read_b64_tr_b16 v[84:85], v21 offset:0
    ds_read_b64_tr_b16 v[86:87], v21 offset:2048
    ds_read_b64_tr_b16 v[88:89], v22 offset:0
    ds_read_b64_tr_b16 v[90:91], v22 offset:2048
    ds_read_b64_tr_b16 v[92:93], v23 offset:0
    ds_read_b64_tr_b16 v[94:95], v23 offset:2048
    ds_read_b64_tr_b16 v[96:97], v20 offset:4096
    ds_read_b64_tr_b16 v[98:99], v20 offset:6144
    ds_read_b64_tr_b16 v[100:101], v21 offset:4096
    ds_read_b64_tr_b16 v[102:103], v21 offset:6144
    ds_read_b64_tr_b16 v[104:105], v22 offset:4096
    ds_read_b64_tr_b16 v[106:107], v22 offset:6144
    ds_read_b64_tr_b16 v[108:109], v23 offset:4096
    s_waitcnt lgkmcnt(14)
    ds_read_b64_tr_b16 v[110:111], v23 offset:6144
    s_waitcnt lgkmcnt(14)
    ds_read_b64_tr_b16 v[112:113], v4 offset:0
    s_waitcnt lgkmcnt(14)
    ds_read_b64_tr_b16 v[114:115], v4 offset:2048
    s_waitcnt lgkmcnt(14)
    ds_read_b64_tr_b16 v[116:117], v5 offset:0
    s_waitcnt lgkmcnt(14)
    ds_read_b64_tr_b16 v[118:119], v5 offset:2048
    s_waitcnt lgkmcnt(14)
    ds_read_b64_tr_b16 v[120:121], v6 offset:0
    s_waitcnt lgkmcnt(14)
    ds_read_b64_tr_b16 v[122:123], v6 offset:2048
    s_waitcnt lgkmcnt(14)
    ds_read_b64_tr_b16 v[124:125], v7 offset:0
    s_waitcnt lgkmcnt(14)
    ds_read_b64_tr_b16 v[126:127], v7 offset:2048
    v_mfma_f32_16x16x32_bf16 v[40:43], v[80:83], v[160:163], v[40:43]
    s_waitcnt lgkmcnt(14)
    ds_read_b64_tr_b16 v[80:81], v4 offset:4096
    s_waitcnt lgkmcnt(14)
    ds_read_b64_tr_b16 v[82:83], v4 offset:6144
    v_fma_f32 v168, v168, s65, -v25
    v_fma_f32 v169, v169, s65, -v25
    v_fma_f32 v170, v170, s65, -v25
    v_fma_f32 v171, v171, s65, -v25
    v_fma_f32 v172, v172, s65, -v25
    v_mfma_f32_16x16x32_bf16 v[44:47], v[84:87], v[160:163], v[44:47]
    s_waitcnt lgkmcnt(14)
    ds_read_b64_tr_b16 v[84:85], v5 offset:4096
    s_waitcnt lgkmcnt(14)
    ds_read_b64_tr_b16 v[86:87], v5 offset:6144
    v_fma_f32 v173, v173, s65, -v25
    v_fma_f32 v174, v174, s65, -v25
    v_fma_f32 v175, v175, s65, -v25
    v_exp_f32 v168, v168
    v_exp_f32 v169, v169
    v_mfma_f32_16x16x32_bf16 v[48:51], v[88:91], v[160:163], v[48:51]
    s_waitcnt lgkmcnt(14)
    ds_read_b64_tr_b16 v[88:89], v6 offset:4096
    s_waitcnt lgkmcnt(14)
    ds_read_b64_tr_b16 v[90:91], v6 offset:6144
    v_exp_f32 v170, v170
    v_exp_f32 v171, v171
    v_exp_f32 v172, v172
    v_exp_f32 v173, v173
    v_exp_f32 v174, v174
    v_mfma_f32_16x16x32_bf16 v[52:55], v[92:95], v[160:163], v[52:55]
    v_mfma_f32_16x16x32_bf16 v[36:39], v[32:35], v[160:163], v[36:39]
    s_waitcnt lgkmcnt(14)
    ds_read_b64_tr_b16 v[92:93], v7 offset:4096
    s_waitcnt lgkmcnt(14)
    ds_read_b64_tr_b16 v[94:95], v7 offset:6144
    v_exp_f32 v175, v175
    v_cvt_pk_bf16_f32 v168, v168, v169
    v_cvt_pk_bf16_f32 v169, v170, v171
    v_cvt_pk_bf16_f32 v170, v172, v173
    v_cvt_pk_bf16_f32 v171, v174, v175
    s_nop 1
    v_mfma_f32_16x16x32_bf16 v[40:43], v[96:99], v[168:171], v[40:43]
    v_fma_f32 v176, v176, s65, -v25
    v_fma_f32 v177, v177, s65, -v25
    v_fma_f32 v178, v178, s65, -v25
    v_fma_f32 v179, v179, s65, -v25
    v_fma_f32 v180, v180, s65, -v25
    v_mfma_f32_16x16x32_bf16 v[44:47], v[100:103], v[168:171], v[44:47]
    v_fma_f32 v181, v181, s65, -v25
    v_fma_f32 v182, v182, s65, -v25
    v_fma_f32 v183, v183, s65, -v25
    v_exp_f32 v176, v176
    v_exp_f32 v177, v177
    v_mfma_f32_16x16x32_bf16 v[48:51], v[104:107], v[168:171], v[48:51]
    v_exp_f32 v178, v178
    v_exp_f32 v179, v179
    v_exp_f32 v180, v180
    v_exp_f32 v181, v181
    v_exp_f32 v182, v182
    v_mfma_f32_16x16x32_bf16 v[52:55], v[108:111], v[168:171], v[52:55]
    v_mfma_f32_16x16x32_bf16 v[36:39], v[32:35], v[168:171], v[36:39]
    v_exp_f32 v183, v183
    v_cvt_pk_bf16_f32 v176, v176, v177
    v_cvt_pk_bf16_f32 v177, v178, v179
    v_cvt_pk_bf16_f32 v178, v180, v181
    v_cvt_pk_bf16_f32 v179, v182, v183
    s_waitcnt lgkmcnt(14)
    s_nop 0
    v_mfma_f32_16x16x32_bf16 v[40:43], v[112:115], v[176:179], v[40:43]
    v_fma_f32 v184, v184, s65, -v25
    v_fma_f32 v185, v185, s65, -v25
    v_fma_f32 v186, v186, s65, -v25
    v_fma_f32 v187, v187, s65, -v25
    v_fma_f32 v188, v188, s65, -v25
    s_waitcnt lgkmcnt(12)
    v_mfma_f32_16x16x32_bf16 v[44:47], v[116:119], v[176:179], v[44:47]
    v_fma_f32 v189, v189, s65, -v25
    v_fma_f32 v190, v190, s65, -v25
    v_fma_f32 v191, v191, s65, -v25
    v_exp_f32 v184, v184
    v_exp_f32 v185, v185
    s_waitcnt lgkmcnt(10)
    v_mfma_f32_16x16x32_bf16 v[48:51], v[120:123], v[176:179], v[48:51]
    v_exp_f32 v186, v186
    v_exp_f32 v187, v187
    v_exp_f32 v188, v188
    v_exp_f32 v189, v189
    v_exp_f32 v190, v190
    s_waitcnt lgkmcnt(8)
    v_mfma_f32_16x16x32_bf16 v[52:55], v[124:127], v[176:179], v[52:55]
    v_mfma_f32_16x16x32_bf16 v[36:39], v[32:35], v[176:179], v[36:39]
    v_exp_f32 v191, v191
    v_cvt_pk_bf16_f32 v184, v184, v185
    v_cvt_pk_bf16_f32 v185, v186, v187
    v_cvt_pk_bf16_f32 v186, v188, v189
    v_cvt_pk_bf16_f32 v187, v190, v191
    s_waitcnt lgkmcnt(6)
    s_nop 0
    v_mfma_f32_16x16x32_bf16 v[40:43], v[80:83], v[184:187], v[40:43]
    v_fma_f32 v192, v192, s65, -v25
    v_fma_f32 v193, v193, s65, -v25
    v_fma_f32 v194, v194, s65, -v25
    v_fma_f32 v195, v195, s65, -v25
    v_fma_f32 v196, v196, s65, -v25
    s_waitcnt lgkmcnt(4)
    v_mfma_f32_16x16x32_bf16 v[44:47], v[84:87], v[184:187], v[44:47]
    v_fma_f32 v197, v197, s65, -v25
    v_fma_f32 v198, v198, s65, -v25
    v_fma_f32 v199, v199, s65, -v25
    v_exp_f32 v192, v192
    v_exp_f32 v193, v193
    s_waitcnt lgkmcnt(2)
    v_mfma_f32_16x16x32_bf16 v[48:51], v[88:91], v[184:187], v[48:51]
    v_exp_f32 v194, v194
    v_exp_f32 v195, v195
    v_exp_f32 v196, v196
    v_exp_f32 v197, v197
    v_exp_f32 v198, v198
    s_waitcnt lgkmcnt(0)
    v_mfma_f32_16x16x32_bf16 v[52:55], v[92:95], v[184:187], v[52:55]
    v_mfma_f32_16x16x32_bf16 v[36:39], v[32:35], v[184:187], v[36:39]
    v_exp_f32 v199, v199
    v_cvt_pk_bf16_f32 v192, v192, v193
    v_cvt_pk_bf16_f32 v193, v194, v195
    v_cvt_pk_bf16_f32 v194, v196, v197
    v_cvt_pk_bf16_f32 v195, v198, v199
    s_barrier
    v_add_u32 v20, 122880, v12
    v_add_u32 v21, 122880, v13
    v_add_u32 v22, 122880, v14
    v_add_u32 v23, 122880, v15
    v_add_u32 v4, 131072, v12
    v_add_u32 v5, 131072, v13
    v_add_u32 v6, 131072, v14
    v_add_u32 v7, 131072, v15
    ds_read_b64_tr_b16 v[80:81], v20 offset:0
    ds_read_b64_tr_b16 v[82:83], v20 offset:2048
    ds_read_b64_tr_b16 v[84:85], v21 offset:0
    ds_read_b64_tr_b16 v[86:87], v21 offset:2048
    ds_read_b64_tr_b16 v[88:89], v22 offset:0
    ds_read_b64_tr_b16 v[90:91], v22 offset:2048
    ds_read_b64_tr_b16 v[92:93], v23 offset:0
    ds_read_b64_tr_b16 v[94:95], v23 offset:2048
    ds_read_b64_tr_b16 v[96:97], v20 offset:4096
    ds_read_b64_tr_b16 v[98:99], v20 offset:6144
    ds_read_b64_tr_b16 v[100:101], v21 offset:4096
    ds_read_b64_tr_b16 v[102:103], v21 offset:6144
    ds_read_b64_tr_b16 v[104:105], v22 offset:4096
    ds_read_b64_tr_b16 v[106:107], v22 offset:6144
    ds_read_b64_tr_b16 v[108:109], v23 offset:4096
    s_waitcnt lgkmcnt(14)
    ds_read_b64_tr_b16 v[110:111], v23 offset:6144
    s_waitcnt lgkmcnt(14)
    ds_read_b64_tr_b16 v[112:113], v4 offset:0
    s_waitcnt lgkmcnt(14)
    ds_read_b64_tr_b16 v[114:115], v4 offset:2048
    s_waitcnt lgkmcnt(14)
    ds_read_b64_tr_b16 v[116:117], v5 offset:0
    s_waitcnt lgkmcnt(14)
    ds_read_b64_tr_b16 v[118:119], v5 offset:2048
    s_waitcnt lgkmcnt(14)
    ds_read_b64_tr_b16 v[120:121], v6 offset:0
    s_waitcnt lgkmcnt(14)
    ds_read_b64_tr_b16 v[122:123], v6 offset:2048
    s_waitcnt lgkmcnt(14)
    ds_read_b64_tr_b16 v[124:125], v7 offset:0
    s_waitcnt lgkmcnt(14)
    ds_read_b64_tr_b16 v[126:127], v7 offset:2048
    v_mfma_f32_16x16x32_bf16 v[40:43], v[80:83], v[192:195], v[40:43]
    s_waitcnt lgkmcnt(14)
    ds_read_b64_tr_b16 v[80:81], v4 offset:4096
    s_waitcnt lgkmcnt(14)
    ds_read_b64_tr_b16 v[82:83], v4 offset:6144
    v_fma_f32 v200, v200, s65, -v25
    v_fma_f32 v201, v201, s65, -v25
    v_fma_f32 v202, v202, s65, -v25
    v_fma_f32 v203, v203, s65, -v25
    v_fma_f32 v204, v204, s65, -v25
    v_mfma_f32_16x16x32_bf16 v[44:47], v[84:87], v[192:195], v[44:47]
    s_waitcnt lgkmcnt(14)
    ds_read_b64_tr_b16 v[84:85], v5 offset:4096
    s_waitcnt lgkmcnt(14)
    ds_read_b64_tr_b16 v[86:87], v5 offset:6144
    v_fma_f32 v205, v205, s65, -v25
    v_fma_f32 v206, v206, s65, -v25
    v_fma_f32 v207, v207, s65, -v25
    v_exp_f32 v200, v200
    v_exp_f32 v201, v201
    v_mfma_f32_16x16x32_bf16 v[48:51], v[88:91], v[192:195], v[48:51]
    s_waitcnt lgkmcnt(14)
    ds_read_b64_tr_b16 v[88:89], v6 offset:4096
    s_waitcnt lgkmcnt(14)
    ds_read_b64_tr_b16 v[90:91], v6 offset:6144
    v_exp_f32 v202, v202
    v_exp_f32 v203, v203
    v_exp_f32 v204, v204
    v_exp_f32 v205, v205
    v_exp_f32 v206, v206
    v_mfma_f32_16x16x32_bf16 v[52:55], v[92:95], v[192:195], v[52:55]
    v_mfma_f32_16x16x32_bf16 v[36:39], v[32:35], v[192:195], v[36:39]
    s_waitcnt lgkmcnt(14)
    ds_read_b64_tr_b16 v[92:93], v7 offset:4096
    s_waitcnt lgkmcnt(14)
    ds_read_b64_tr_b16 v[94:95], v7 offset:6144
    v_exp_f32 v207, v207
    v_cvt_pk_bf16_f32 v200, v200, v201
    v_cvt_pk_bf16_f32 v201, v202, v203
    v_cvt_pk_bf16_f32 v202, v204, v205
    v_cvt_pk_bf16_f32 v203, v206, v207
    s_nop 1
    v_mfma_f32_16x16x32_bf16 v[40:43], v[96:99], v[200:203], v[40:43]
    v_fma_f32 v208, v208, s65, -v25
    v_fma_f32 v209, v209, s65, -v25
    v_fma_f32 v210, v210, s65, -v25
    v_fma_f32 v211, v211, s65, -v25
    v_fma_f32 v212, v212, s65, -v25
    v_mfma_f32_16x16x32_bf16 v[44:47], v[100:103], v[200:203], v[44:47]
    v_fma_f32 v213, v213, s65, -v25
    v_fma_f32 v214, v214, s65, -v25
    v_fma_f32 v215, v215, s65, -v25
    v_exp_f32 v208, v208
    v_exp_f32 v209, v209
    v_mfma_f32_16x16x32_bf16 v[48:51], v[104:107], v[200:203], v[48:51]
    v_exp_f32 v210, v210
    v_exp_f32 v211, v211
    v_exp_f32 v212, v212
    v_exp_f32 v213, v213
    v_exp_f32 v214, v214
    v_mfma_f32_16x16x32_bf16 v[52:55], v[108:111], v[200:203], v[52:55]
    v_mfma_f32_16x16x32_bf16 v[36:39], v[32:35], v[200:203], v[36:39]
    v_exp_f32 v215, v215
    v_cvt_pk_bf16_f32 v208, v208, v209
    v_cvt_pk_bf16_f32 v209, v210, v211
    v_cvt_pk_bf16_f32 v210, v212, v213
    v_cvt_pk_bf16_f32 v211, v214, v215
    s_waitcnt lgkmcnt(14)
    s_nop 0
    v_mfma_f32_16x16x32_bf16 v[40:43], v[112:115], v[208:211], v[40:43]
    v_fma_f32 v216, v216, s65, -v25
    v_fma_f32 v217, v217, s65, -v25
    v_fma_f32 v218, v218, s65, -v25
    v_fma_f32 v219, v219, s65, -v25
    v_fma_f32 v220, v220, s65, -v25
    s_waitcnt lgkmcnt(12)
    v_mfma_f32_16x16x32_bf16 v[44:47], v[116:119], v[208:211], v[44:47]
    v_fma_f32 v221, v221, s65, -v25
    v_fma_f32 v222, v222, s65, -v25
    v_fma_f32 v223, v223, s65, -v25
    v_exp_f32 v216, v216
    v_exp_f32 v217, v217
    s_waitcnt lgkmcnt(10)
    v_mfma_f32_16x16x32_bf16 v[48:51], v[120:123], v[208:211], v[48:51]
    v_exp_f32 v218, v218
    v_exp_f32 v219, v219
    v_exp_f32 v220, v220
    v_exp_f32 v221, v221
    v_exp_f32 v222, v222
    s_waitcnt lgkmcnt(8)
    v_mfma_f32_16x16x32_bf16 v[52:55], v[124:127], v[208:211], v[52:55]
    v_mfma_f32_16x16x32_bf16 v[36:39], v[32:35], v[208:211], v[36:39]
    v_exp_f32 v223, v223
    v_cvt_pk_bf16_f32 v216, v216, v217
    v_cvt_pk_bf16_f32 v217, v218, v219
    v_cvt_pk_bf16_f32 v218, v220, v221
    v_cvt_pk_bf16_f32 v219, v222, v223
    s_waitcnt lgkmcnt(6)
    s_nop 0
    v_mfma_f32_16x16x32_bf16 v[40:43], v[80:83], v[216:219], v[40:43]
    v_fma_f32 v224, v224, s65, -v25
    v_fma_f32 v225, v225, s65, -v25
    v_fma_f32 v226, v226, s65, -v25
    v_fma_f32 v227, v227, s65, -v25
    v_fma_f32 v228, v228, s65, -v25
    s_waitcnt lgkmcnt(4)
    v_mfma_f32_16x16x32_bf16 v[44:47], v[84:87], v[216:219], v[44:47]
    v_fma_f32 v229, v229, s65, -v25
    v_fma_f32 v230, v230, s65, -v25
    v_fma_f32 v231, v231, s65, -v25
    v_exp_f32 v224, v224
    v_exp_f32 v225, v225
    s_waitcnt lgkmcnt(2)
    v_mfma_f32_16x16x32_bf16 v[48:51], v[88:91], v[216:219], v[48:51]
    v_exp_f32 v226, v226
    v_exp_f32 v227, v227
    v_exp_f32 v228, v228
    v_exp_f32 v229, v229
    v_exp_f32 v230, v230
    s_waitcnt lgkmcnt(0)
    v_mfma_f32_16x16x32_bf16 v[52:55], v[92:95], v[216:219], v[52:55]
    v_mfma_f32_16x16x32_bf16 v[36:39], v[32:35], v[216:219], v[36:39]
    v_exp_f32 v231, v231
    v_cvt_pk_bf16_f32 v224, v224, v225
    v_cvt_pk_bf16_f32 v225, v226, v227
    v_cvt_pk_bf16_f32 v226, v228, v229
    v_cvt_pk_bf16_f32 v227, v230, v231
    s_barrier
    v_add_u32 v20, 139264, v12
    v_add_u32 v21, 139264, v13
    v_add_u32 v22, 139264, v14
    v_add_u32 v23, 139264, v15
    v_add_u32 v4, 147456, v12
    v_add_u32 v5, 147456, v13
    v_add_u32 v6, 147456, v14
    v_add_u32 v7, 147456, v15
    ds_read_b64_tr_b16 v[80:81], v20 offset:0
    ds_read_b64_tr_b16 v[82:83], v20 offset:2048
    ds_read_b64_tr_b16 v[84:85], v21 offset:0
    ds_read_b64_tr_b16 v[86:87], v21 offset:2048
    ds_read_b64_tr_b16 v[88:89], v22 offset:0
    ds_read_b64_tr_b16 v[90:91], v22 offset:2048
    ds_read_b64_tr_b16 v[92:93], v23 offset:0
    ds_read_b64_tr_b16 v[94:95], v23 offset:2048
    ds_read_b64_tr_b16 v[96:97], v20 offset:4096
    ds_read_b64_tr_b16 v[98:99], v20 offset:6144
    ds_read_b64_tr_b16 v[100:101], v21 offset:4096
    ds_read_b64_tr_b16 v[102:103], v21 offset:6144
    ds_read_b64_tr_b16 v[104:105], v22 offset:4096
    ds_read_b64_tr_b16 v[106:107], v22 offset:6144
    ds_read_b64_tr_b16 v[108:109], v23 offset:4096
    s_waitcnt lgkmcnt(14)
    ds_read_b64_tr_b16 v[110:111], v23 offset:6144
    s_waitcnt lgkmcnt(14)
    ds_read_b64_tr_b16 v[112:113], v4 offset:0
    s_waitcnt lgkmcnt(14)
    ds_read_b64_tr_b16 v[114:115], v4 offset:2048
    s_waitcnt lgkmcnt(14)
    ds_read_b64_tr_b16 v[116:117], v5 offset:0
    s_waitcnt lgkmcnt(14)
    ds_read_b64_tr_b16 v[118:119], v5 offset:2048
    s_waitcnt lgkmcnt(14)
    ds_read_b64_tr_b16 v[120:121], v6 offset:0
    s_waitcnt lgkmcnt(14)
    ds_read_b64_tr_b16 v[122:123], v6 offset:2048
    s_waitcnt lgkmcnt(14)
    ds_read_b64_tr_b16 v[124:125], v7 offset:0
    s_waitcnt lgkmcnt(14)
    ds_read_b64_tr_b16 v[126:127], v7 offset:2048
    v_mfma_f32_16x16x32_bf16 v[40:43], v[80:83], v[224:227], v[40:43]
    s_waitcnt lgkmcnt(14)
    ds_read_b64_tr_b16 v[80:81], v4 offset:4096
    s_waitcnt lgkmcnt(14)
    ds_read_b64_tr_b16 v[82:83], v4 offset:6144
    v_fma_f32 v232, v232, s65, -v25
    v_fma_f32 v233, v233, s65, -v25
    v_fma_f32 v234, v234, s65, -v25
    v_fma_f32 v235, v235, s65, -v25
    v_fma_f32 v236, v236, s65, -v25
    v_mfma_f32_16x16x32_bf16 v[44:47], v[84:87], v[224:227], v[44:47]
    s_waitcnt lgkmcnt(14)
    ds_read_b64_tr_b16 v[84:85], v5 offset:4096
    s_waitcnt lgkmcnt(14)
    ds_read_b64_tr_b16 v[86:87], v5 offset:6144
    v_fma_f32 v237, v237, s65, -v25
    v_fma_f32 v238, v238, s65, -v25
    v_fma_f32 v239, v239, s65, -v25
    v_exp_f32 v232, v232
    v_exp_f32 v233, v233
    v_mfma_f32_16x16x32_bf16 v[48:51], v[88:91], v[224:227], v[48:51]
    s_waitcnt lgkmcnt(14)
    ds_read_b64_tr_b16 v[88:89], v6 offset:4096
    s_waitcnt lgkmcnt(14)
    ds_read_b64_tr_b16 v[90:91], v6 offset:6144
    v_exp_f32 v234, v234
    v_exp_f32 v235, v235
    v_exp_f32 v236, v236
    v_exp_f32 v237, v237
    v_exp_f32 v238, v238
    v_mfma_f32_16x16x32_bf16 v[52:55], v[92:95], v[224:227], v[52:55]
    v_mfma_f32_16x16x32_bf16 v[36:39], v[32:35], v[224:227], v[36:39]
    s_waitcnt lgkmcnt(14)
    ds_read_b64_tr_b16 v[92:93], v7 offset:4096
    s_waitcnt lgkmcnt(14)
    ds_read_b64_tr_b16 v[94:95], v7 offset:6144
    v_exp_f32 v239, v239
    v_cvt_pk_bf16_f32 v232, v232, v233
    v_cvt_pk_bf16_f32 v233, v234, v235
    v_cvt_pk_bf16_f32 v234, v236, v237
    v_cvt_pk_bf16_f32 v235, v238, v239
    s_nop 1
    v_mfma_f32_16x16x32_bf16 v[40:43], v[96:99], v[232:235], v[40:43]
    v_fma_f32 v240, v240, s65, -v25
    v_fma_f32 v241, v241, s65, -v25
    v_fma_f32 v242, v242, s65, -v25
    v_fma_f32 v243, v243, s65, -v25
    v_fma_f32 v244, v244, s65, -v25
    v_mfma_f32_16x16x32_bf16 v[44:47], v[100:103], v[232:235], v[44:47]
    v_fma_f32 v245, v245, s65, -v25
    v_fma_f32 v246, v246, s65, -v25
    v_fma_f32 v247, v247, s65, -v25
    v_exp_f32 v240, v240
    v_exp_f32 v241, v241
    v_mfma_f32_16x16x32_bf16 v[48:51], v[104:107], v[232:235], v[48:51]
    v_exp_f32 v242, v242
    v_exp_f32 v243, v243
    v_exp_f32 v244, v244
    v_exp_f32 v245, v245
    v_exp_f32 v246, v246
    v_mfma_f32_16x16x32_bf16 v[52:55], v[108:111], v[232:235], v[52:55]
    v_mfma_f32_16x16x32_bf16 v[36:39], v[32:35], v[232:235], v[36:39]
    v_exp_f32 v247, v247
    v_cvt_pk_bf16_f32 v240, v240, v241
    v_cvt_pk_bf16_f32 v241, v242, v243
    v_cvt_pk_bf16_f32 v242, v244, v245
    v_cvt_pk_bf16_f32 v243, v246, v247
    s_waitcnt lgkmcnt(14)
    s_nop 0
    v_mfma_f32_16x16x32_bf16 v[40:43], v[112:115], v[240:243], v[40:43]
    v_fma_f32 v248, v248, s65, -v25
    v_fma_f32 v249, v249, s65, -v25
    v_fma_f32 v250, v250, s65, -v25
    v_fma_f32 v251, v251, s65, -v25
    v_fma_f32 v252, v252, s65, -v25
    s_waitcnt lgkmcnt(12)
    v_mfma_f32_16x16x32_bf16 v[44:47], v[116:119], v[240:243], v[44:47]
    v_fma_f32 v253, v253, s65, -v25
    v_fma_f32 v254, v254, s65, -v25
    v_fma_f32 v255, v255, s65, -v25
    v_exp_f32 v248, v248
    v_exp_f32 v249, v249
    s_waitcnt lgkmcnt(10)
    v_mfma_f32_16x16x32_bf16 v[48:51], v[120:123], v[240:243], v[48:51]
    v_exp_f32 v250, v250
    v_exp_f32 v251, v251
    v_exp_f32 v252, v252
    v_exp_f32 v253, v253
    v_exp_f32 v254, v254
    s_waitcnt lgkmcnt(8)
    v_mfma_f32_16x16x32_bf16 v[52:55], v[124:127], v[240:243], v[52:55]
    v_mfma_f32_16x16x32_bf16 v[36:39], v[32:35], v[240:243], v[36:39]
    v_exp_f32 v255, v255
    v_cvt_pk_bf16_f32 v248, v248, v249
    v_cvt_pk_bf16_f32 v249, v250, v251
    v_cvt_pk_bf16_f32 v250, v252, v253
    v_cvt_pk_bf16_f32 v251, v254, v255
    s_waitcnt lgkmcnt(6)
    s_nop 0
    v_mfma_f32_16x16x32_bf16 v[40:43], v[80:83], v[248:251], v[40:43]
    s_waitcnt lgkmcnt(4)
    v_mfma_f32_16x16x32_bf16 v[44:47], v[84:87], v[248:251], v[44:47]
    s_waitcnt lgkmcnt(2)
    v_mfma_f32_16x16x32_bf16 v[48:51], v[88:91], v[248:251], v[48:51]
    s_waitcnt lgkmcnt(0)
    v_mfma_f32_16x16x32_bf16 v[52:55], v[92:95], v[248:251], v[52:55]
    v_mfma_f32_16x16x32_bf16 v[36:39], v[32:35], v[248:251], v[36:39]
    s_nop 7
    v_rcp_f32 v26, v36
    s_nop 0
    v_mul_f32 v40, v40, v26
    v_mul_f32 v41, v41, v26
    v_mul_f32 v42, v42, v26
    v_mul_f32 v43, v43, v26
    v_cvt_pk_bf16_f32 v40, v40, v41
    v_cvt_pk_bf16_f32 v41, v42, v43
    ds_write_b64 v16, v[40:41] offset:0
    v_mul_f32 v44, v44, v26
    v_mul_f32 v45, v45, v26
    v_mul_f32 v46, v46, v26
    v_mul_f32 v47, v47, v26
    v_cvt_pk_bf16_f32 v44, v44, v45
    v_cvt_pk_bf16_f32 v45, v46, v47
    ds_write_b64 v17, v[44:45] offset:0
    v_mul_f32 v48, v48, v26
    v_mul_f32 v49, v49, v26
    v_mul_f32 v50, v50, v26
    v_mul_f32 v51, v51, v26
    v_cvt_pk_bf16_f32 v48, v48, v49
    v_cvt_pk_bf16_f32 v49, v50, v51
    ds_write_b64 v18, v[48:49] offset:0
    v_mul_f32 v52, v52, v26
    v_mul_f32 v53, v53, v26
    v_mul_f32 v54, v54, v26
    v_mul_f32 v55, v55, v26
    v_cvt_pk_bf16_f32 v52, v52, v53
    v_cvt_pk_bf16_f32 v53, v54, v55
    ds_write_b64 v19, v[52:53] offset:0
    s_waitcnt lgkmcnt(0)
    s_barrier
    v_add_u32 v20, 155648, v12
    v_add_u32 v21, 155648, v13
    v_add_u32 v22, 155648, v14
    v_add_u32 v23, 155648, v15
    v_add_u32 v4, 90112, v12
    v_add_u32 v5, 90112, v13
    v_add_u32 v6, 90112, v14
    v_add_u32 v7, 90112, v15
    ds_read_b64_tr_b16 v[80:81], v20 offset:0
    ds_read_b64_tr_b16 v[82:83], v20 offset:2048
    ds_read_b64_tr_b16 v[84:85], v21 offset:0
    ds_read_b64_tr_b16 v[86:87], v21 offset:2048
    ds_read_b64_tr_b16 v[88:89], v22 offset:0
    ds_read_b64_tr_b16 v[90:91], v22 offset:2048
    ds_read_b64_tr_b16 v[92:93], v23 offset:0
    ds_read_b64_tr_b16 v[94:95], v23 offset:2048
    ds_read_b64_tr_b16 v[96:97], v20 offset:4096
    ds_read_b64_tr_b16 v[98:99], v20 offset:6144
    ds_read_b64_tr_b16 v[100:101], v21 offset:4096
    ds_read_b64_tr_b16 v[102:103], v21 offset:6144
    ds_read_b64_tr_b16 v[104:105], v22 offset:4096
    ds_read_b64_tr_b16 v[106:107], v22 offset:6144
    ds_read_b64_tr_b16 v[108:109], v23 offset:4096
    s_waitcnt lgkmcnt(14)
    ds_read_b64_tr_b16 v[110:111], v23 offset:6144
    s_waitcnt lgkmcnt(14)
    ds_read_b64_tr_b16 v[112:113], v4 offset:0
    s_waitcnt lgkmcnt(14)
    ds_read_b64_tr_b16 v[114:115], v4 offset:2048
    s_waitcnt lgkmcnt(14)
    ds_read_b64_tr_b16 v[116:117], v5 offset:0
    s_waitcnt lgkmcnt(14)
    ds_read_b64_tr_b16 v[118:119], v5 offset:2048
    s_waitcnt lgkmcnt(14)
    ds_read_b64_tr_b16 v[120:121], v6 offset:0
    s_waitcnt lgkmcnt(14)
    ds_read_b64_tr_b16 v[122:123], v6 offset:2048
    s_waitcnt lgkmcnt(14)
    ds_read_b64_tr_b16 v[124:125], v7 offset:0
    s_waitcnt lgkmcnt(14)
    ds_read_b64_tr_b16 v[126:127], v7 offset:2048
    v_mfma_f32_16x16x32_bf16 v[40:43], v[80:83], v[128:131], 0
    s_waitcnt lgkmcnt(14)
    ds_read_b64_tr_b16 v[80:81], v4 offset:4096
    s_waitcnt lgkmcnt(14)
    ds_read_b64_tr_b16 v[82:83], v4 offset:6144
    v_mfma_f32_16x16x32_bf16 v[44:47], v[84:87], v[128:131], 0
    s_waitcnt lgkmcnt(14)
    ds_read_b64_tr_b16 v[84:85], v5 offset:4096
    s_waitcnt lgkmcnt(14)
    ds_read_b64_tr_b16 v[86:87], v5 offset:6144
    v_mfma_f32_16x16x32_bf16 v[48:51], v[88:91], v[128:131], 0
    s_waitcnt lgkmcnt(14)
    ds_read_b64_tr_b16 v[88:89], v6 offset:4096
    s_waitcnt lgkmcnt(14)
    ds_read_b64_tr_b16 v[90:91], v6 offset:6144
    v_mfma_f32_16x16x32_bf16 v[52:55], v[92:95], v[128:131], 0
    s_waitcnt lgkmcnt(14)
    ds_read_b64_tr_b16 v[92:93], v7 offset:4096
    s_waitcnt lgkmcnt(14)
    ds_read_b64_tr_b16 v[94:95], v7 offset:6144
    v_mfma_f32_16x16x32_bf16 v[40:43], v[96:99], v[136:139], v[40:43]
    v_mfma_f32_16x16x32_bf16 v[44:47], v[100:103], v[136:139], v[44:47]
    v_mfma_f32_16x16x32_bf16 v[48:51], v[104:107], v[136:139], v[48:51]
    v_mfma_f32_16x16x32_bf16 v[52:55], v[108:111], v[136:139], v[52:55]
    s_waitcnt lgkmcnt(14)
    v_mfma_f32_16x16x32_bf16 v[40:43], v[112:115], v[144:147], v[40:43]
    s_waitcnt lgkmcnt(12)
    v_mfma_f32_16x16x32_bf16 v[44:47], v[116:119], v[144:147], v[44:47]
    s_waitcnt lgkmcnt(10)
    v_mfma_f32_16x16x32_bf16 v[48:51], v[120:123], v[144:147], v[48:51]
    s_waitcnt lgkmcnt(8)
    v_mfma_f32_16x16x32_bf16 v[52:55], v[124:127], v[144:147], v[52:55]
    s_waitcnt lgkmcnt(6)
    v_mfma_f32_16x16x32_bf16 v[40:43], v[80:83], v[152:155], v[40:43]
    s_waitcnt lgkmcnt(4)
    v_mfma_f32_16x16x32_bf16 v[44:47], v[84:87], v[152:155], v[44:47]
    s_waitcnt lgkmcnt(2)
    v_mfma_f32_16x16x32_bf16 v[48:51], v[88:91], v[152:155], v[48:51]
    s_waitcnt lgkmcnt(0)
    v_mfma_f32_16x16x32_bf16 v[52:55], v[92:95], v[152:155], v[52:55]
    s_barrier
    v_add_u32 v20, 98304, v12
    v_add_u32 v21, 98304, v13
    v_add_u32 v22, 98304, v14
    v_add_u32 v23, 98304, v15
    v_add_u32 v4, 106496, v12
    v_add_u32 v5, 106496, v13
    v_add_u32 v6, 106496, v14
    v_add_u32 v7, 106496, v15
    ds_read_b64_tr_b16 v[80:81], v20 offset:0
    ds_read_b64_tr_b16 v[82:83], v20 offset:2048
    ds_read_b64_tr_b16 v[84:85], v21 offset:0
    ds_read_b64_tr_b16 v[86:87], v21 offset:2048
    ds_read_b64_tr_b16 v[88:89], v22 offset:0
    ds_read_b64_tr_b16 v[90:91], v22 offset:2048
    ds_read_b64_tr_b16 v[92:93], v23 offset:0
    ds_read_b64_tr_b16 v[94:95], v23 offset:2048
    ds_read_b64_tr_b16 v[96:97], v20 offset:4096
    ds_read_b64_tr_b16 v[98:99], v20 offset:6144
    ds_read_b64_tr_b16 v[100:101], v21 offset:4096
    ds_read_b64_tr_b16 v[102:103], v21 offset:6144
    ds_read_b64_tr_b16 v[104:105], v22 offset:4096
    ds_read_b64_tr_b16 v[106:107], v22 offset:6144
    ds_read_b64_tr_b16 v[108:109], v23 offset:4096
    s_waitcnt lgkmcnt(14)
    ds_read_b64_tr_b16 v[110:111], v23 offset:6144
    s_waitcnt lgkmcnt(14)
    ds_read_b64_tr_b16 v[112:113], v4 offset:0
    s_waitcnt lgkmcnt(14)
    ds_read_b64_tr_b16 v[114:115], v4 offset:2048
    s_waitcnt lgkmcnt(14)
    ds_read_b64_tr_b16 v[116:117], v5 offset:0
    s_waitcnt lgkmcnt(14)
    ds_read_b64_tr_b16 v[118:119], v5 offset:2048
    s_waitcnt lgkmcnt(14)
    ds_read_b64_tr_b16 v[120:121], v6 offset:0
    s_waitcnt lgkmcnt(14)
    ds_read_b64_tr_b16 v[122:123], v6 offset:2048
    s_waitcnt lgkmcnt(14)
    ds_read_b64_tr_b16 v[124:125], v7 offset:0
    s_waitcnt lgkmcnt(14)
    ds_read_b64_tr_b16 v[126:127], v7 offset:2048
    v_mfma_f32_16x16x32_bf16 v[40:43], v[80:83], v[160:163], v[40:43]
    s_waitcnt lgkmcnt(14)
    ds_read_b64_tr_b16 v[80:81], v4 offset:4096
    s_waitcnt lgkmcnt(14)
    ds_read_b64_tr_b16 v[82:83], v4 offset:6144
    v_mfma_f32_16x16x32_bf16 v[44:47], v[84:87], v[160:163], v[44:47]
    s_waitcnt lgkmcnt(14)
    ds_read_b64_tr_b16 v[84:85], v5 offset:4096
    s_waitcnt lgkmcnt(14)
    ds_read_b64_tr_b16 v[86:87], v5 offset:6144
    v_mfma_f32_16x16x32_bf16 v[48:51], v[88:91], v[160:163], v[48:51]
    s_waitcnt lgkmcnt(14)
    ds_read_b64_tr_b16 v[88:89], v6 offset:4096
    s_waitcnt lgkmcnt(14)
    ds_read_b64_tr_b16 v[90:91], v6 offset:6144
    v_mfma_f32_16x16x32_bf16 v[52:55], v[92:95], v[160:163], v[52:55]
    s_waitcnt lgkmcnt(14)
    ds_read_b64_tr_b16 v[92:93], v7 offset:4096
    s_waitcnt lgkmcnt(14)
    ds_read_b64_tr_b16 v[94:95], v7 offset:6144
    v_mfma_f32_16x16x32_bf16 v[40:43], v[96:99], v[168:171], v[40:43]
    v_mfma_f32_16x16x32_bf16 v[44:47], v[100:103], v[168:171], v[44:47]
    v_mfma_f32_16x16x32_bf16 v[48:51], v[104:107], v[168:171], v[48:51]
    v_mfma_f32_16x16x32_bf16 v[52:55], v[108:111], v[168:171], v[52:55]
    s_waitcnt lgkmcnt(14)
    v_mfma_f32_16x16x32_bf16 v[40:43], v[112:115], v[176:179], v[40:43]
    s_waitcnt lgkmcnt(12)
    v_mfma_f32_16x16x32_bf16 v[44:47], v[116:119], v[176:179], v[44:47]
    s_waitcnt lgkmcnt(10)
    v_mfma_f32_16x16x32_bf16 v[48:51], v[120:123], v[176:179], v[48:51]
    s_waitcnt lgkmcnt(8)
    v_mfma_f32_16x16x32_bf16 v[52:55], v[124:127], v[176:179], v[52:55]
    s_waitcnt lgkmcnt(6)
    v_mfma_f32_16x16x32_bf16 v[40:43], v[80:83], v[184:187], v[40:43]
    s_waitcnt lgkmcnt(4)
    v_mfma_f32_16x16x32_bf16 v[44:47], v[84:87], v[184:187], v[44:47]
    s_waitcnt lgkmcnt(2)
    v_mfma_f32_16x16x32_bf16 v[48:51], v[88:91], v[184:187], v[48:51]
    s_waitcnt lgkmcnt(0)
    v_mfma_f32_16x16x32_bf16 v[52:55], v[92:95], v[184:187], v[52:55]
    s_barrier
    v_add_u32 v20, 114688, v12
    v_add_u32 v21, 114688, v13
    v_add_u32 v22, 114688, v14
    v_add_u32 v23, 114688, v15
    v_add_u32 v4, 122880, v12
    v_add_u32 v5, 122880, v13
    v_add_u32 v6, 122880, v14
    v_add_u32 v7, 122880, v15
    ds_read_b64_tr_b16 v[80:81], v20 offset:0
    ds_read_b64_tr_b16 v[82:83], v20 offset:2048
    ds_read_b64_tr_b16 v[84:85], v21 offset:0
    ds_read_b64_tr_b16 v[86:87], v21 offset:2048
    ds_read_b64_tr_b16 v[88:89], v22 offset:0
    ds_read_b64_tr_b16 v[90:91], v22 offset:2048
    ds_read_b64_tr_b16 v[92:93], v23 offset:0
    ds_read_b64_tr_b16 v[94:95], v23 offset:2048
    ds_read_b64_tr_b16 v[96:97], v20 offset:4096
    ds_read_b64_tr_b16 v[98:99], v20 offset:6144
    ds_read_b64_tr_b16 v[100:101], v21 offset:4096
    ds_read_b64_tr_b16 v[102:103], v21 offset:6144
    ds_read_b64_tr_b16 v[104:105], v22 offset:4096
    ds_read_b64_tr_b16 v[106:107], v22 offset:6144
    ds_read_b64_tr_b16 v[108:109], v23 offset:4096
    s_waitcnt lgkmcnt(14)
    ds_read_b64_tr_b16 v[110:111], v23 offset:6144
    s_waitcnt lgkmcnt(14)
    ds_read_b64_tr_b16 v[112:113], v4 offset:0
    s_waitcnt lgkmcnt(14)
    ds_read_b64_tr_b16 v[114:115], v4 offset:2048
    s_waitcnt lgkmcnt(14)
    ds_read_b64_tr_b16 v[116:117], v5 offset:0
    s_waitcnt lgkmcnt(14)
    ds_read_b64_tr_b16 v[118:119], v5 offset:2048
    s_waitcnt lgkmcnt(14)
    ds_read_b64_tr_b16 v[120:121], v6 offset:0
    s_waitcnt lgkmcnt(14)
    ds_read_b64_tr_b16 v[122:123], v6 offset:2048
    s_waitcnt lgkmcnt(14)
    ds_read_b64_tr_b16 v[124:125], v7 offset:0
    s_waitcnt lgkmcnt(14)
    ds_read_b64_tr_b16 v[126:127], v7 offset:2048
    v_mfma_f32_16x16x32_bf16 v[40:43], v[80:83], v[192:195], v[40:43]
    s_waitcnt lgkmcnt(14)
    ds_read_b64_tr_b16 v[80:81], v4 offset:4096
    s_waitcnt lgkmcnt(14)
    ds_read_b64_tr_b16 v[82:83], v4 offset:6144
    v_mfma_f32_16x16x32_bf16 v[44:47], v[84:87], v[192:195], v[44:47]
    s_waitcnt lgkmcnt(14)
    ds_read_b64_tr_b16 v[84:85], v5 offset:4096
    s_waitcnt lgkmcnt(14)
    ds_read_b64_tr_b16 v[86:87], v5 offset:6144
    v_mfma_f32_16x16x32_bf16 v[48:51], v[88:91], v[192:195], v[48:51]
    s_waitcnt lgkmcnt(14)
    ds_read_b64_tr_b16 v[88:89], v6 offset:4096
    s_waitcnt lgkmcnt(14)
    ds_read_b64_tr_b16 v[90:91], v6 offset:6144
    v_mfma_f32_16x16x32_bf16 v[52:55], v[92:95], v[192:195], v[52:55]
    s_waitcnt lgkmcnt(14)
    ds_read_b64_tr_b16 v[92:93], v7 offset:4096
    s_waitcnt lgkmcnt(14)
    ds_read_b64_tr_b16 v[94:95], v7 offset:6144
    v_mfma_f32_16x16x32_bf16 v[40:43], v[96:99], v[200:203], v[40:43]
    v_mfma_f32_16x16x32_bf16 v[44:47], v[100:103], v[200:203], v[44:47]
    v_mfma_f32_16x16x32_bf16 v[48:51], v[104:107], v[200:203], v[48:51]
    v_mfma_f32_16x16x32_bf16 v[52:55], v[108:111], v[200:203], v[52:55]
    s_waitcnt lgkmcnt(14)
    v_mfma_f32_16x16x32_bf16 v[40:43], v[112:115], v[208:211], v[40:43]
    s_waitcnt lgkmcnt(12)
    v_mfma_f32_16x16x32_bf16 v[44:47], v[116:119], v[208:211], v[44:47]
    s_waitcnt lgkmcnt(10)
    v_mfma_f32_16x16x32_bf16 v[48:51], v[120:123], v[208:211], v[48:51]
    s_waitcnt lgkmcnt(8)
    v_mfma_f32_16x16x32_bf16 v[52:55], v[124:127], v[208:211], v[52:55]
    s_waitcnt lgkmcnt(6)
    v_mfma_f32_16x16x32_bf16 v[40:43], v[80:83], v[216:219], v[40:43]
    s_waitcnt lgkmcnt(4)
    v_mfma_f32_16x16x32_bf16 v[44:47], v[84:87], v[216:219], v[44:47]
    s_waitcnt lgkmcnt(2)
    v_mfma_f32_16x16x32_bf16 v[48:51], v[88:91], v[216:219], v[48:51]
    s_waitcnt lgkmcnt(0)
    v_mfma_f32_16x16x32_bf16 v[52:55], v[92:95], v[216:219], v[52:55]
    s_barrier
    v_add_u32 v20, 131072, v12
    v_add_u32 v21, 131072, v13
    v_add_u32 v22, 131072, v14
    v_add_u32 v23, 131072, v15
    v_add_u32 v4, 139264, v12
    v_add_u32 v5, 139264, v13
    v_add_u32 v6, 139264, v14
    v_add_u32 v7, 139264, v15
    ds_read_b64_tr_b16 v[80:81], v20 offset:0
    ds_read_b64_tr_b16 v[82:83], v20 offset:2048
    ds_read_b64_tr_b16 v[84:85], v21 offset:0
    ds_read_b64_tr_b16 v[86:87], v21 offset:2048
    ds_read_b64_tr_b16 v[88:89], v22 offset:0
    ds_read_b64_tr_b16 v[90:91], v22 offset:2048
    ds_read_b64_tr_b16 v[92:93], v23 offset:0
    ds_read_b64_tr_b16 v[94:95], v23 offset:2048
    ds_read_b64_tr_b16 v[96:97], v20 offset:4096
    ds_read_b64_tr_b16 v[98:99], v20 offset:6144
    ds_read_b64_tr_b16 v[100:101], v21 offset:4096
    ds_read_b64_tr_b16 v[102:103], v21 offset:6144
    ds_read_b64_tr_b16 v[104:105], v22 offset:4096
    ds_read_b64_tr_b16 v[106:107], v22 offset:6144
    ds_read_b64_tr_b16 v[108:109], v23 offset:4096
    s_waitcnt lgkmcnt(14)
    ds_read_b64_tr_b16 v[110:111], v23 offset:6144
    s_waitcnt lgkmcnt(14)
    ds_read_b64_tr_b16 v[112:113], v4 offset:0
    s_waitcnt lgkmcnt(14)
    ds_read_b64_tr_b16 v[114:115], v4 offset:2048
    s_waitcnt lgkmcnt(14)
    ds_read_b64_tr_b16 v[116:117], v5 offset:0
    s_waitcnt lgkmcnt(14)
    ds_read_b64_tr_b16 v[118:119], v5 offset:2048
    s_waitcnt lgkmcnt(14)
    ds_read_b64_tr_b16 v[120:121], v6 offset:0
    s_waitcnt lgkmcnt(14)
    ds_read_b64_tr_b16 v[122:123], v6 offset:2048
    s_waitcnt lgkmcnt(14)
    ds_read_b64_tr_b16 v[124:125], v7 offset:0
    s_waitcnt lgkmcnt(14)
    ds_read_b64_tr_b16 v[126:127], v7 offset:2048
    v_mfma_f32_16x16x32_bf16 v[40:43], v[80:83], v[224:227], v[40:43]
    s_waitcnt lgkmcnt(14)
    ds_read_b64_tr_b16 v[80:81], v4 offset:4096
    s_waitcnt lgkmcnt(14)
    ds_read_b64_tr_b16 v[82:83], v4 offset:6144
    v_mfma_f32_16x16x32_bf16 v[44:47], v[84:87], v[224:227], v[44:47]
    s_waitcnt lgkmcnt(14)
    ds_read_b64_tr_b16 v[84:85], v5 offset:4096
    s_waitcnt lgkmcnt(14)
    ds_read_b64_tr_b16 v[86:87], v5 offset:6144
    v_mfma_f32_16x16x32_bf16 v[48:51], v[88:91], v[224:227], v[48:51]
    s_waitcnt lgkmcnt(14)
    ds_read_b64_tr_b16 v[88:89], v6 offset:4096
    s_waitcnt lgkmcnt(14)
    ds_read_b64_tr_b16 v[90:91], v6 offset:6144
    v_mfma_f32_16x16x32_bf16 v[52:55], v[92:95], v[224:227], v[52:55]
    s_waitcnt lgkmcnt(14)
    ds_read_b64_tr_b16 v[92:93], v7 offset:4096
    s_waitcnt lgkmcnt(14)
    ds_read_b64_tr_b16 v[94:95], v7 offset:6144
    v_mfma_f32_16x16x32_bf16 v[40:43], v[96:99], v[232:235], v[40:43]
    v_mfma_f32_16x16x32_bf16 v[44:47], v[100:103], v[232:235], v[44:47]
    v_mfma_f32_16x16x32_bf16 v[48:51], v[104:107], v[232:235], v[48:51]
    v_mfma_f32_16x16x32_bf16 v[52:55], v[108:111], v[232:235], v[52:55]
    s_waitcnt lgkmcnt(14)
    v_mfma_f32_16x16x32_bf16 v[40:43], v[112:115], v[240:243], v[40:43]
    s_waitcnt lgkmcnt(12)
    v_mfma_f32_16x16x32_bf16 v[44:47], v[116:119], v[240:243], v[44:47]
    s_waitcnt lgkmcnt(10)
    v_mfma_f32_16x16x32_bf16 v[48:51], v[120:123], v[240:243], v[48:51]
    s_waitcnt lgkmcnt(8)
    v_mfma_f32_16x16x32_bf16 v[52:55], v[124:127], v[240:243], v[52:55]
    s_waitcnt lgkmcnt(6)
    v_mfma_f32_16x16x32_bf16 v[40:43], v[80:83], v[248:251], v[40:43]
    s_waitcnt lgkmcnt(4)
    v_mfma_f32_16x16x32_bf16 v[44:47], v[84:87], v[248:251], v[44:47]
    s_waitcnt lgkmcnt(2)
    v_mfma_f32_16x16x32_bf16 v[48:51], v[88:91], v[248:251], v[48:51]
    s_waitcnt lgkmcnt(0)
    v_mfma_f32_16x16x32_bf16 v[52:55], v[92:95], v[248:251], v[52:55]
    s_nop 1
    v_mul_f32 v40, v40, v26
    v_mul_f32 v41, v41, v26
    v_mul_f32 v42, v42, v26
    v_mul_f32 v43, v43, v26
    v_cvt_pk_bf16_f32 v40, v40, v41
    v_cvt_pk_bf16_f32 v41, v42, v43
    ds_write_b64 v16, v[40:41] offset:0
    v_mul_f32 v44, v44, v26
    v_mul_f32 v45, v45, v26
    v_mul_f32 v46, v46, v26
    v_mul_f32 v47, v47, v26
    v_cvt_pk_bf16_f32 v44, v44, v45
    v_cvt_pk_bf16_f32 v45, v46, v47
    ds_write_b64 v17, v[44:45] offset:0
    v_mul_f32 v48, v48, v26
    v_mul_f32 v49, v49, v26
    v_mul_f32 v50, v50, v26
    v_mul_f32 v51, v51, v26
    v_cvt_pk_bf16_f32 v48, v48, v49
    v_cvt_pk_bf16_f32 v49, v50, v51
    ds_write_b64 v18, v[48:49] offset:0
    v_mul_f32 v52, v52, v26
    v_mul_f32 v53, v53, v26
    v_mul_f32 v54, v54, v26
    v_mul_f32 v55, v55, v26
    v_cvt_pk_bf16_f32 v52, v52, v53
    v_cvt_pk_bf16_f32 v53, v54, v55
    ds_write_b64 v19, v[52:53] offset:0
    s_waitcnt lgkmcnt(0)
    s_barrier
    v_add_u32 v20, 147456, v12
    v_add_u32 v21, 147456, v13
    v_add_u32 v22, 147456, v14
    v_add_u32 v23, 147456, v15
    v_add_u32 v4, 155648, v12
    v_add_u32 v5, 155648, v13
    v_add_u32 v6, 155648, v14
    v_add_u32 v7, 155648, v15
    ds_read_b64_tr_b16 v[80:81], v20 offset:0
    ds_read_b64_tr_b16 v[82:83], v20 offset:2048
    ds_read_b64_tr_b16 v[84:85], v21 offset:0
    ds_read_b64_tr_b16 v[86:87], v21 offset:2048
    ds_read_b64_tr_b16 v[88:89], v22 offset:0
    ds_read_b64_tr_b16 v[90:91], v22 offset:2048
    ds_read_b64_tr_b16 v[92:93], v23 offset:0
    ds_read_b64_tr_b16 v[94:95], v23 offset:2048
    ds_read_b64_tr_b16 v[96:97], v20 offset:4096
    ds_read_b64_tr_b16 v[98:99], v20 offset:6144
    ds_read_b64_tr_b16 v[100:101], v21 offset:4096
    ds_read_b64_tr_b16 v[102:103], v21 offset:6144
    ds_read_b64_tr_b16 v[104:105], v22 offset:4096
    ds_read_b64_tr_b16 v[106:107], v22 offset:6144
    ds_read_b64_tr_b16 v[108:109], v23 offset:4096
    s_waitcnt lgkmcnt(14)
    ds_read_b64_tr_b16 v[110:111], v23 offset:6144
    s_waitcnt lgkmcnt(14)
    ds_read_b64_tr_b16 v[112:113], v4 offset:0
    s_waitcnt lgkmcnt(14)
    ds_read_b64_tr_b16 v[114:115], v4 offset:2048
    s_waitcnt lgkmcnt(14)
    ds_read_b64_tr_b16 v[116:117], v5 offset:0
    s_waitcnt lgkmcnt(14)
    ds_read_b64_tr_b16 v[118:119], v5 offset:2048
    s_waitcnt lgkmcnt(14)
    ds_read_b64_tr_b16 v[120:121], v6 offset:0
    s_waitcnt lgkmcnt(14)
    ds_read_b64_tr_b16 v[122:123], v6 offset:2048
    s_waitcnt lgkmcnt(14)
    ds_read_b64_tr_b16 v[124:125], v7 offset:0
    s_waitcnt lgkmcnt(14)
    ds_read_b64_tr_b16 v[126:127], v7 offset:2048
    v_mfma_f32_16x16x32_bf16 v[40:43], v[80:83], v[128:131], 0
    s_waitcnt lgkmcnt(14)
    ds_read_b64_tr_b16 v[80:81], v4 offset:4096
    s_waitcnt lgkmcnt(14)
    ds_read_b64_tr_b16 v[82:83], v4 offset:6144
    v_mfma_f32_16x16x32_bf16 v[44:47], v[84:87], v[128:131], 0
    s_waitcnt lgkmcnt(14)
    ds_read_b64_tr_b16 v[84:85], v5 offset:4096
    s_waitcnt lgkmcnt(14)
    ds_read_b64_tr_b16 v[86:87], v5 offset:6144
    v_mfma_f32_16x16x32_bf16 v[48:51], v[88:91], v[128:131], 0
    s_waitcnt lgkmcnt(14)
    ds_read_b64_tr_b16 v[88:89], v6 offset:4096
    s_waitcnt lgkmcnt(14)
    ds_read_b64_tr_b16 v[90:91], v6 offset:6144
    v_mfma_f32_16x16x32_bf16 v[52:55], v[92:95], v[128:131], 0
    s_waitcnt lgkmcnt(14)
    ds_read_b64_tr_b16 v[92:93], v7 offset:4096
    s_waitcnt lgkmcnt(14)
    ds_read_b64_tr_b16 v[94:95], v7 offset:6144
    v_mfma_f32_16x16x32_bf16 v[40:43], v[96:99], v[136:139], v[40:43]
    v_mfma_f32_16x16x32_bf16 v[44:47], v[100:103], v[136:139], v[44:47]
    v_mfma_f32_16x16x32_bf16 v[48:51], v[104:107], v[136:139], v[48:51]
    v_mfma_f32_16x16x32_bf16 v[52:55], v[108:111], v[136:139], v[52:55]
    s_waitcnt lgkmcnt(14)
    v_mfma_f32_16x16x32_bf16 v[40:43], v[112:115], v[144:147], v[40:43]
    s_waitcnt lgkmcnt(12)
    v_mfma_f32_16x16x32_bf16 v[44:47], v[116:119], v[144:147], v[44:47]
    s_waitcnt lgkmcnt(10)
    v_mfma_f32_16x16x32_bf16 v[48:51], v[120:123], v[144:147], v[48:51]
    s_waitcnt lgkmcnt(8)
    v_mfma_f32_16x16x32_bf16 v[52:55], v[124:127], v[144:147], v[52:55]
    s_waitcnt lgkmcnt(6)
    v_mfma_f32_16x16x32_bf16 v[40:43], v[80:83], v[152:155], v[40:43]
    s_waitcnt lgkmcnt(4)
    v_mfma_f32_16x16x32_bf16 v[44:47], v[84:87], v[152:155], v[44:47]
    s_waitcnt lgkmcnt(2)
    v_mfma_f32_16x16x32_bf16 v[48:51], v[88:91], v[152:155], v[48:51]
    s_waitcnt lgkmcnt(0)
    v_mfma_f32_16x16x32_bf16 v[52:55], v[92:95], v[152:155], v[52:55]
    s_barrier
    v_add_u32 v20, 90112, v12
    v_add_u32 v21, 90112, v13
    v_add_u32 v22, 90112, v14
    v_add_u32 v23, 90112, v15
    v_add_u32 v4, 98304, v12
    v_add_u32 v5, 98304, v13
    v_add_u32 v6, 98304, v14
    v_add_u32 v7, 98304, v15
    ds_read_b64_tr_b16 v[80:81], v20 offset:0
    ds_read_b64_tr_b16 v[82:83], v20 offset:2048
    ds_read_b64_tr_b16 v[84:85], v21 offset:0
    ds_read_b64_tr_b16 v[86:87], v21 offset:2048
    ds_read_b64_tr_b16 v[88:89], v22 offset:0
    ds_read_b64_tr_b16 v[90:91], v22 offset:2048
    ds_read_b64_tr_b16 v[92:93], v23 offset:0
    ds_read_b64_tr_b16 v[94:95], v23 offset:2048
    ds_read_b64_tr_b16 v[96:97], v20 offset:4096
    ds_read_b64_tr_b16 v[98:99], v20 offset:6144
    ds_read_b64_tr_b16 v[100:101], v21 offset:4096
    ds_read_b64_tr_b16 v[102:103], v21 offset:6144
    ds_read_b64_tr_b16 v[104:105], v22 offset:4096
    ds_read_b64_tr_b16 v[106:107], v22 offset:6144
    ds_read_b64_tr_b16 v[108:109], v23 offset:4096
    s_waitcnt lgkmcnt(14)
    ds_read_b64_tr_b16 v[110:111], v23 offset:6144
    s_waitcnt lgkmcnt(14)
    ds_read_b64_tr_b16 v[112:113], v4 offset:0
    s_waitcnt lgkmcnt(14)
    ds_read_b64_tr_b16 v[114:115], v4 offset:2048
    s_waitcnt lgkmcnt(14)
    ds_read_b64_tr_b16 v[116:117], v5 offset:0
    s_waitcnt lgkmcnt(14)
    ds_read_b64_tr_b16 v[118:119], v5 offset:2048
    s_waitcnt lgkmcnt(14)
    ds_read_b64_tr_b16 v[120:121], v6 offset:0
    s_waitcnt lgkmcnt(14)
    ds_read_b64_tr_b16 v[122:123], v6 offset:2048
    s_waitcnt lgkmcnt(14)
    ds_read_b64_tr_b16 v[124:125], v7 offset:0
    s_waitcnt lgkmcnt(14)
    ds_read_b64_tr_b16 v[126:127], v7 offset:2048
    v_mfma_f32_16x16x32_bf16 v[40:43], v[80:83], v[160:163], v[40:43]
    s_waitcnt lgkmcnt(14)
    ds_read_b64_tr_b16 v[80:81], v4 offset:4096
    s_waitcnt lgkmcnt(14)
    ds_read_b64_tr_b16 v[82:83], v4 offset:6144
    v_mfma_f32_16x16x32_bf16 v[44:47], v[84:87], v[160:163], v[44:47]
    s_waitcnt lgkmcnt(14)
    ds_read_b64_tr_b16 v[84:85], v5 offset:4096
    s_waitcnt lgkmcnt(14)
    ds_read_b64_tr_b16 v[86:87], v5 offset:6144
    v_mfma_f32_16x16x32_bf16 v[48:51], v[88:91], v[160:163], v[48:51]
    s_waitcnt lgkmcnt(14)
    ds_read_b64_tr_b16 v[88:89], v6 offset:4096
    s_waitcnt lgkmcnt(14)
    ds_read_b64_tr_b16 v[90:91], v6 offset:6144
    v_mfma_f32_16x16x32_bf16 v[52:55], v[92:95], v[160:163], v[52:55]
    s_waitcnt lgkmcnt(14)
    ds_read_b64_tr_b16 v[92:93], v7 offset:4096
    s_waitcnt lgkmcnt(14)
    ds_read_b64_tr_b16 v[94:95], v7 offset:6144
    v_mfma_f32_16x16x32_bf16 v[40:43], v[96:99], v[168:171], v[40:43]
    v_mfma_f32_16x16x32_bf16 v[44:47], v[100:103], v[168:171], v[44:47]
    v_mfma_f32_16x16x32_bf16 v[48:51], v[104:107], v[168:171], v[48:51]
    v_mfma_f32_16x16x32_bf16 v[52:55], v[108:111], v[168:171], v[52:55]
    s_waitcnt lgkmcnt(14)
    v_mfma_f32_16x16x32_bf16 v[40:43], v[112:115], v[176:179], v[40:43]
    s_waitcnt lgkmcnt(12)
    v_mfma_f32_16x16x32_bf16 v[44:47], v[116:119], v[176:179], v[44:47]
    s_waitcnt lgkmcnt(10)
    v_mfma_f32_16x16x32_bf16 v[48:51], v[120:123], v[176:179], v[48:51]
    s_waitcnt lgkmcnt(8)
    v_mfma_f32_16x16x32_bf16 v[52:55], v[124:127], v[176:179], v[52:55]
    s_waitcnt lgkmcnt(6)
    v_mfma_f32_16x16x32_bf16 v[40:43], v[80:83], v[184:187], v[40:43]
    s_waitcnt lgkmcnt(4)
    v_mfma_f32_16x16x32_bf16 v[44:47], v[84:87], v[184:187], v[44:47]
    s_waitcnt lgkmcnt(2)
    v_mfma_f32_16x16x32_bf16 v[48:51], v[88:91], v[184:187], v[48:51]
    s_waitcnt lgkmcnt(0)
    v_mfma_f32_16x16x32_bf16 v[52:55], v[92:95], v[184:187], v[52:55]
    s_barrier
    v_add_u32 v20, 106496, v12
    v_add_u32 v21, 106496, v13
    v_add_u32 v22, 106496, v14
    v_add_u32 v23, 106496, v15
    v_add_u32 v4, 114688, v12
    v_add_u32 v5, 114688, v13
    v_add_u32 v6, 114688, v14
    v_add_u32 v7, 114688, v15
    ds_read_b64_tr_b16 v[80:81], v20 offset:0
    ds_read_b64_tr_b16 v[82:83], v20 offset:2048
    ds_read_b64_tr_b16 v[84:85], v21 offset:0
    ds_read_b64_tr_b16 v[86:87], v21 offset:2048
    ds_read_b64_tr_b16 v[88:89], v22 offset:0
    ds_read_b64_tr_b16 v[90:91], v22 offset:2048
    ds_read_b64_tr_b16 v[92:93], v23 offset:0
    ds_read_b64_tr_b16 v[94:95], v23 offset:2048
    ds_read_b64_tr_b16 v[96:97], v20 offset:4096
    ds_read_b64_tr_b16 v[98:99], v20 offset:6144
    ds_read_b64_tr_b16 v[100:101], v21 offset:4096
    ds_read_b64_tr_b16 v[102:103], v21 offset:6144
    ds_read_b64_tr_b16 v[104:105], v22 offset:4096
    ds_read_b64_tr_b16 v[106:107], v22 offset:6144
    ds_read_b64_tr_b16 v[108:109], v23 offset:4096
    s_waitcnt lgkmcnt(14)
    ds_read_b64_tr_b16 v[110:111], v23 offset:6144
    s_waitcnt lgkmcnt(14)
    ds_read_b64_tr_b16 v[112:113], v4 offset:0
    s_waitcnt lgkmcnt(14)
    ds_read_b64_tr_b16 v[114:115], v4 offset:2048
    s_waitcnt lgkmcnt(14)
    ds_read_b64_tr_b16 v[116:117], v5 offset:0
    s_waitcnt lgkmcnt(14)
    ds_read_b64_tr_b16 v[118:119], v5 offset:2048
    s_waitcnt lgkmcnt(14)
    ds_read_b64_tr_b16 v[120:121], v6 offset:0
    s_waitcnt lgkmcnt(14)
    ds_read_b64_tr_b16 v[122:123], v6 offset:2048
    s_waitcnt lgkmcnt(14)
    ds_read_b64_tr_b16 v[124:125], v7 offset:0
    s_waitcnt lgkmcnt(14)
    ds_read_b64_tr_b16 v[126:127], v7 offset:2048
    v_mfma_f32_16x16x32_bf16 v[40:43], v[80:83], v[192:195], v[40:43]
    s_waitcnt lgkmcnt(14)
    ds_read_b64_tr_b16 v[80:81], v4 offset:4096
    s_waitcnt lgkmcnt(14)
    ds_read_b64_tr_b16 v[82:83], v4 offset:6144
    v_mfma_f32_16x16x32_bf16 v[44:47], v[84:87], v[192:195], v[44:47]
    s_waitcnt lgkmcnt(14)
    ds_read_b64_tr_b16 v[84:85], v5 offset:4096
    s_waitcnt lgkmcnt(14)
    ds_read_b64_tr_b16 v[86:87], v5 offset:6144
    v_mfma_f32_16x16x32_bf16 v[48:51], v[88:91], v[192:195], v[48:51]
    s_waitcnt lgkmcnt(14)
    ds_read_b64_tr_b16 v[88:89], v6 offset:4096
    s_waitcnt lgkmcnt(14)
    ds_read_b64_tr_b16 v[90:91], v6 offset:6144
    v_mfma_f32_16x16x32_bf16 v[52:55], v[92:95], v[192:195], v[52:55]
    s_waitcnt lgkmcnt(14)
    ds_read_b64_tr_b16 v[92:93], v7 offset:4096
    s_waitcnt lgkmcnt(14)
    ds_read_b64_tr_b16 v[94:95], v7 offset:6144
    v_mfma_f32_16x16x32_bf16 v[40:43], v[96:99], v[200:203], v[40:43]
    v_mfma_f32_16x16x32_bf16 v[44:47], v[100:103], v[200:203], v[44:47]
    v_mfma_f32_16x16x32_bf16 v[48:51], v[104:107], v[200:203], v[48:51]
    v_mfma_f32_16x16x32_bf16 v[52:55], v[108:111], v[200:203], v[52:55]
    s_waitcnt lgkmcnt(14)
    v_mfma_f32_16x16x32_bf16 v[40:43], v[112:115], v[208:211], v[40:43]
    s_waitcnt lgkmcnt(12)
    v_mfma_f32_16x16x32_bf16 v[44:47], v[116:119], v[208:211], v[44:47]
    s_waitcnt lgkmcnt(10)
    v_mfma_f32_16x16x32_bf16 v[48:51], v[120:123], v[208:211], v[48:51]
    s_waitcnt lgkmcnt(8)
    v_mfma_f32_16x16x32_bf16 v[52:55], v[124:127], v[208:211], v[52:55]
    s_waitcnt lgkmcnt(6)
    v_mfma_f32_16x16x32_bf16 v[40:43], v[80:83], v[216:219], v[40:43]
    s_waitcnt lgkmcnt(4)
    v_mfma_f32_16x16x32_bf16 v[44:47], v[84:87], v[216:219], v[44:47]
    s_waitcnt lgkmcnt(2)
    v_mfma_f32_16x16x32_bf16 v[48:51], v[88:91], v[216:219], v[48:51]
    s_waitcnt lgkmcnt(0)
    v_mfma_f32_16x16x32_bf16 v[52:55], v[92:95], v[216:219], v[52:55]
    s_barrier
    v_add_u32 v20, 122880, v12
    v_add_u32 v21, 122880, v13
    v_add_u32 v22, 122880, v14
    v_add_u32 v23, 122880, v15
    v_add_u32 v4, 131072, v12
    v_add_u32 v5, 131072, v13
    v_add_u32 v6, 131072, v14
    v_add_u32 v7, 131072, v15
    ds_read_b64_tr_b16 v[80:81], v20 offset:0
    ds_read_b64_tr_b16 v[82:83], v20 offset:2048
    ds_read_b64_tr_b16 v[84:85], v21 offset:0
    ds_read_b64_tr_b16 v[86:87], v21 offset:2048
    ds_read_b64_tr_b16 v[88:89], v22 offset:0
    ds_read_b64_tr_b16 v[90:91], v22 offset:2048
    ds_read_b64_tr_b16 v[92:93], v23 offset:0
    ds_read_b64_tr_b16 v[94:95], v23 offset:2048
    ds_read_b64_tr_b16 v[96:97], v20 offset:4096
    ds_read_b64_tr_b16 v[98:99], v20 offset:6144
    ds_read_b64_tr_b16 v[100:101], v21 offset:4096
    ds_read_b64_tr_b16 v[102:103], v21 offset:6144
    ds_read_b64_tr_b16 v[104:105], v22 offset:4096
    ds_read_b64_tr_b16 v[106:107], v22 offset:6144
    ds_read_b64_tr_b16 v[108:109], v23 offset:4096
    s_waitcnt lgkmcnt(14)
    ds_read_b64_tr_b16 v[110:111], v23 offset:6144
    s_waitcnt lgkmcnt(14)
    ds_read_b64_tr_b16 v[112:113], v4 offset:0
    s_waitcnt lgkmcnt(14)
    ds_read_b64_tr_b16 v[114:115], v4 offset:2048
    s_waitcnt lgkmcnt(14)
    ds_read_b64_tr_b16 v[116:117], v5 offset:0
    s_waitcnt lgkmcnt(14)
    ds_read_b64_tr_b16 v[118:119], v5 offset:2048
    s_waitcnt lgkmcnt(14)
    ds_read_b64_tr_b16 v[120:121], v6 offset:0
    s_waitcnt lgkmcnt(14)
    ds_read_b64_tr_b16 v[122:123], v6 offset:2048
    s_waitcnt lgkmcnt(14)
    ds_read_b64_tr_b16 v[124:125], v7 offset:0
    s_waitcnt lgkmcnt(14)
    ds_read_b64_tr_b16 v[126:127], v7 offset:2048
    v_mfma_f32_16x16x32_bf16 v[40:43], v[80:83], v[224:227], v[40:43]
    s_waitcnt lgkmcnt(14)
    ds_read_b64_tr_b16 v[80:81], v4 offset:4096
    s_waitcnt lgkmcnt(14)
    ds_read_b64_tr_b16 v[82:83], v4 offset:6144
    v_mfma_f32_16x16x32_bf16 v[44:47], v[84:87], v[224:227], v[44:47]
    s_waitcnt lgkmcnt(14)
    ds_read_b64_tr_b16 v[84:85], v5 offset:4096
    s_waitcnt lgkmcnt(14)
    ds_read_b64_tr_b16 v[86:87], v5 offset:6144
    v_mfma_f32_16x16x32_bf16 v[48:51], v[88:91], v[224:227], v[48:51]
    s_waitcnt lgkmcnt(14)
    ds_read_b64_tr_b16 v[88:89], v6 offset:4096
    s_waitcnt lgkmcnt(14)
    ds_read_b64_tr_b16 v[90:91], v6 offset:6144
    v_mfma_f32_16x16x32_bf16 v[52:55], v[92:95], v[224:227], v[52:55]
    s_waitcnt lgkmcnt(14)
    ds_read_b64_tr_b16 v[92:93], v7 offset:4096
    s_waitcnt lgkmcnt(14)
    ds_read_b64_tr_b16 v[94:95], v7 offset:6144
    v_mfma_f32_16x16x32_bf16 v[40:43], v[96:99], v[232:235], v[40:43]
    v_mfma_f32_16x16x32_bf16 v[44:47], v[100:103], v[232:235], v[44:47]
    v_mfma_f32_16x16x32_bf16 v[48:51], v[104:107], v[232:235], v[48:51]
    v_mfma_f32_16x16x32_bf16 v[52:55], v[108:111], v[232:235], v[52:55]
    s_waitcnt lgkmcnt(14)
    v_mfma_f32_16x16x32_bf16 v[40:43], v[112:115], v[240:243], v[40:43]
    s_waitcnt lgkmcnt(12)
    v_mfma_f32_16x16x32_bf16 v[44:47], v[116:119], v[240:243], v[44:47]
    s_waitcnt lgkmcnt(10)
    v_mfma_f32_16x16x32_bf16 v[48:51], v[120:123], v[240:243], v[48:51]
    s_waitcnt lgkmcnt(8)
    v_mfma_f32_16x16x32_bf16 v[52:55], v[124:127], v[240:243], v[52:55]
    s_waitcnt lgkmcnt(6)
    v_mfma_f32_16x16x32_bf16 v[40:43], v[80:83], v[248:251], v[40:43]
    s_waitcnt lgkmcnt(4)
    v_mfma_f32_16x16x32_bf16 v[44:47], v[84:87], v[248:251], v[44:47]
    s_waitcnt lgkmcnt(2)
    v_mfma_f32_16x16x32_bf16 v[48:51], v[88:91], v[248:251], v[48:51]
    s_waitcnt lgkmcnt(0)
    v_mfma_f32_16x16x32_bf16 v[52:55], v[92:95], v[248:251], v[52:55]
    s_nop 1
    v_mul_f32 v40, v40, v26
    v_mul_f32 v41, v41, v26
    v_mul_f32 v42, v42, v26
    v_mul_f32 v43, v43, v26
    v_cvt_pk_bf16_f32 v40, v40, v41
    v_cvt_pk_bf16_f32 v41, v42, v43
    ds_write_b64 v16, v[40:41] offset:0
    v_mul_f32 v44, v44, v26
    v_mul_f32 v45, v45, v26
    v_mul_f32 v46, v46, v26
    v_mul_f32 v47, v47, v26
    v_cvt_pk_bf16_f32 v44, v44, v45
    v_cvt_pk_bf16_f32 v45, v46, v47
    ds_write_b64 v17, v[44:45] offset:0
    v_mul_f32 v48, v48, v26
    v_mul_f32 v49, v49, v26
    v_mul_f32 v50, v50, v26
    v_mul_f32 v51, v51, v26
    v_cvt_pk_bf16_f32 v48, v48, v49
    v_cvt_pk_bf16_f32 v49, v50, v51
    ds_write_b64 v18, v[48:49] offset:0
    v_mul_f32 v52, v52, v26
    v_mul_f32 v53, v53, v26
    v_mul_f32 v54, v54, v26
    v_mul_f32 v55, v55, v26
    v_cvt_pk_bf16_f32 v52, v52, v53
    v_cvt_pk_bf16_f32 v53, v54, v55
    ds_write_b64 v19, v[52:53] offset:0
    s_waitcnt lgkmcnt(0)
    s_barrier
    s_endpgm
L_exit:
    s_endpgm
.globl gqa_reduce_kernel
.p2align 8
.type gqa_reduce_kernel,@function
gqa_reduce_kernel:
    s_cmp_ge_u32 s2, 320
    s_cbranch_scc1 L_rexit
    s_load_dwordx2 s[4:5], s[0:1], 40
    s_load_dwordx2 s[6:7], s[0:1], 56
    v_lshrrev_b32 v1, 6, v0
    v_and_b32 v0, 63, v0
    v_readfirstlane_b32 s8, v1
    s_lshl_b32 s9, s2, 2
    s_nop 2
    s_add_u32 s9, s9, s8
    s_mul_hi_u32 s10, s9, 53687092
    s_mul_i32 s11, s10, 80
    s_sub_u32 s11, s9, s11
    s_mul_i32 s12, s10, 1310720
    s_lshl_b32 s13, s11, 10
    s_add_u32 s12, s12, s13
    v_lshlrev_b32 v2, 4, v0
    s_waitcnt lgkmcnt(0)
    s_add_u32 s16, s6, s12
    s_addc_u32 s17, s7, 0
    s_and_b32 s17, s17, 0xffff
    s_mov_b32 s18, 1229824
    s_mov_b32 s19, 0x20000
    s_mov_b32 s24, 0
    s_mov_b32 s25, 81920
    s_mov_b32 s26, 163840
    s_mov_b32 s27, 245760
    s_mov_b32 s28, 327680
    s_mov_b32 s29, 409600
    s_mov_b32 s30, 491520
    s_mov_b32 s31, 573440
    s_mov_b32 s32, 655360
    s_mov_b32 s33, 737280
    s_mov_b32 s34, 819200
    s_mov_b32 s35, 901120
    s_mov_b32 s36, 983040
    s_mov_b32 s37, 1064960
    s_mov_b32 s38, 1146880
    s_mov_b32 s39, 1228800
    buffer_load_dwordx4 v[8:11], v2, s[16:19], s24 offen
    buffer_load_dwordx4 v[12:15], v2, s[16:19], s25 offen
    buffer_load_dwordx4 v[16:19], v2, s[16:19], s26 offen
    buffer_load_dwordx4 v[20:23], v2, s[16:19], s27 offen
    buffer_load_dwordx4 v[24:27], v2, s[16:19], s28 offen
    buffer_load_dwordx4 v[28:31], v2, s[16:19], s29 offen
    buffer_load_dwordx4 v[32:35], v2, s[16:19], s30 offen
    buffer_load_dwordx4 v[36:39], v2, s[16:19], s31 offen
    buffer_load_dwordx4 v[40:43], v2, s[16:19], s32 offen
    buffer_load_dwordx4 v[44:47], v2, s[16:19], s33 offen
    buffer_load_dwordx4 v[48:51], v2, s[16:19], s34 offen
    buffer_load_dwordx4 v[52:55], v2, s[16:19], s35 offen
    buffer_load_dwordx4 v[56:59], v2, s[16:19], s36 offen
    buffer_load_dwordx4 v[60:63], v2, s[16:19], s37 offen
    buffer_load_dwordx4 v[64:67], v2, s[16:19], s38 offen
    buffer_load_dwordx4 v[68:71], v2, s[16:19], s39 offen
    s_mul_hi_u32 s20, s11, 214748365
    s_mul_i32 s21, s20, 20
    s_sub_u32 s21, s11, s21
    s_and_b32 s22, s20, 1
    s_lshr_b32 s23, s20, 1
    s_mul_i32 s23, s23, 320
    s_lshl_b32 s21, s21, 4
    s_add_u32 s23, s23, s21
    s_lshl_b32 s22, s22, 5
    s_lshl_b32 s40, s10, 6
    s_add_u32 s22, s22, s40
    s_mul_i32 s22, s22, 1280
    s_lshl_b32 s23, s23, 1
    s_add_u32 s22, s22, s23
    v_and_b32 v3, 31, v0
    v_mul_u32_u24 v3, 1280, v3
    v_lshrrev_b32 v4, 5, v0
    v_lshlrev_b32 v4, 4, v4
    v_add_u32 v3, v3, v4
    s_mov_b32 s44, s4
    s_and_b32 s45, s5, 0xffff
    s_mov_b32 s46, 1310720
    s_mov_b32 s47, 0x20000
    s_waitcnt vmcnt(15)
    v_lshlrev_b32 v72, 16, v8
    v_and_b32 v73, 0xffff0000, v8
    v_lshlrev_b32 v74, 16, v9
    v_and_b32 v75, 0xffff0000, v9
    v_lshlrev_b32 v76, 16, v10
    v_and_b32 v77, 0xffff0000, v10
    v_lshlrev_b32 v78, 16, v11
    v_and_b32 v79, 0xffff0000, v11
    s_waitcnt vmcnt(14)
    v_lshlrev_b32 v5, 16, v12
    v_and_b32 v6, 0xffff0000, v12
    v_add_f32 v72, v72, v5
    v_add_f32 v73, v73, v6
    v_lshlrev_b32 v5, 16, v13
    v_and_b32 v6, 0xffff0000, v13
    v_add_f32 v74, v74, v5
    v_add_f32 v75, v75, v6
    v_lshlrev_b32 v5, 16, v14
    v_and_b32 v6, 0xffff0000, v14
    v_add_f32 v76, v76, v5
    v_add_f32 v77, v77, v6
    v_lshlrev_b32 v5, 16, v15
    v_and_b32 v6, 0xffff0000, v15
    v_add_f32 v78, v78, v5
    v_add_f32 v79, v79, v6
    s_waitcnt vmcnt(13)
    v_lshlrev_b32 v5, 16, v16
    v_and_b32 v6, 0xffff0000, v16
    v_add_f32 v72, v72, v5
    v_add_f32 v73, v73, v6
    v_lshlrev_b32 v5, 16, v17
    v_and_b32 v6, 0xffff0000, v17
    v_add_f32 v74, v74, v5
    v_add_f32 v75, v75, v6
    v_lshlrev_b32 v5, 16, v18
    v_and_b32 v6, 0xffff0000, v18
    v_add_f32 v76, v76, v5
    v_add_f32 v77, v77, v6
    v_lshlrev_b32 v5, 16, v19
    v_and_b32 v6, 0xffff0000, v19
    v_add_f32 v78, v78, v5
    v_add_f32 v79, v79, v6
    s_waitcnt vmcnt(12)
    v_lshlrev_b32 v5, 16, v20
    v_and_b32 v6, 0xffff0000, v20
    v_add_f32 v72, v72, v5
    v_add_f32 v73, v73, v6
    v_lshlrev_b32 v5, 16, v21
    v_and_b32 v6, 0xffff0000, v21
    v_add_f32 v74, v74, v5
    v_add_f32 v75, v75, v6
    v_lshlrev_b32 v5, 16, v22
    v_and_b32 v6, 0xffff0000, v22
    v_add_f32 v76, v76, v5
    v_add_f32 v77, v77, v6
    v_lshlrev_b32 v5, 16, v23
    v_and_b32 v6, 0xffff0000, v23
    v_add_f32 v78, v78, v5
    v_add_f32 v79, v79, v6
    s_waitcnt vmcnt(11)
    v_lshlrev_b32 v5, 16, v24
    v_and_b32 v6, 0xffff0000, v24
    v_add_f32 v72, v72, v5
    v_add_f32 v73, v73, v6
    v_lshlrev_b32 v5, 16, v25
    v_and_b32 v6, 0xffff0000, v25
    v_add_f32 v74, v74, v5
    v_add_f32 v75, v75, v6
    v_lshlrev_b32 v5, 16, v26
    v_and_b32 v6, 0xffff0000, v26
    v_add_f32 v76, v76, v5
    v_add_f32 v77, v77, v6
    v_lshlrev_b32 v5, 16, v27
    v_and_b32 v6, 0xffff0000, v27
    v_add_f32 v78, v78, v5
    v_add_f32 v79, v79, v6
    s_waitcnt vmcnt(10)
    v_lshlrev_b32 v5, 16, v28
    v_and_b32 v6, 0xffff0000, v28
    v_add_f32 v72, v72, v5
    v_add_f32 v73, v73, v6
    v_lshlrev_b32 v5, 16, v29
    v_and_b32 v6, 0xffff0000, v29
    v_add_f32 v74, v74, v5
    v_add_f32 v75, v75, v6
    v_lshlrev_b32 v5, 16, v30
    v_and_b32 v6, 0xffff0000, v30
    v_add_f32 v76, v76, v5
    v_add_f32 v77, v77, v6
    v_lshlrev_b32 v5, 16, v31
    v_and_b32 v6, 0xffff0000, v31
    v_add_f32 v78, v78, v5
    v_add_f32 v79, v79, v6
    s_waitcnt vmcnt(9)
    v_lshlrev_b32 v5, 16, v32
    v_and_b32 v6, 0xffff0000, v32
    v_add_f32 v72, v72, v5
    v_add_f32 v73, v73, v6
    v_lshlrev_b32 v5, 16, v33
    v_and_b32 v6, 0xffff0000, v33
    v_add_f32 v74, v74, v5
    v_add_f32 v75, v75, v6
    v_lshlrev_b32 v5, 16, v34
    v_and_b32 v6, 0xffff0000, v34
    v_add_f32 v76, v76, v5
    v_add_f32 v77, v77, v6
    v_lshlrev_b32 v5, 16, v35
    v_and_b32 v6, 0xffff0000, v35
    v_add_f32 v78, v78, v5
    v_add_f32 v79, v79, v6
    s_waitcnt vmcnt(8)
    v_lshlrev_b32 v5, 16, v36
    v_and_b32 v6, 0xffff0000, v36
    v_add_f32 v72, v72, v5
    v_add_f32 v73, v73, v6
    v_lshlrev_b32 v5, 16, v37
    v_and_b32 v6, 0xffff0000, v37
    v_add_f32 v74, v74, v5
    v_add_f32 v75, v75, v6
    v_lshlrev_b32 v5, 16, v38
    v_and_b32 v6, 0xffff0000, v38
    v_add_f32 v76, v76, v5
    v_add_f32 v77, v77, v6
    v_lshlrev_b32 v5, 16, v39
    v_and_b32 v6, 0xffff0000, v39
    v_add_f32 v78, v78, v5
    v_add_f32 v79, v79, v6
    s_waitcnt vmcnt(7)
    v_lshlrev_b32 v5, 16, v40
    v_and_b32 v6, 0xffff0000, v40
    v_add_f32 v72, v72, v5
    v_add_f32 v73, v73, v6
    v_lshlrev_b32 v5, 16, v41
    v_and_b32 v6, 0xffff0000, v41
    v_add_f32 v74, v74, v5
    v_add_f32 v75, v75, v6
    v_lshlrev_b32 v5, 16, v42
    v_and_b32 v6, 0xffff0000, v42
    v_add_f32 v76, v76, v5
    v_add_f32 v77, v77, v6
    v_lshlrev_b32 v5, 16, v43
    v_and_b32 v6, 0xffff0000, v43
    v_add_f32 v78, v78, v5
    v_add_f32 v79, v79, v6
    s_waitcnt vmcnt(6)
    v_lshlrev_b32 v5, 16, v44
    v_and_b32 v6, 0xffff0000, v44
    v_add_f32 v72, v72, v5
    v_add_f32 v73, v73, v6
    v_lshlrev_b32 v5, 16, v45
    v_and_b32 v6, 0xffff0000, v45
    v_add_f32 v74, v74, v5
    v_add_f32 v75, v75, v6
    v_lshlrev_b32 v5, 16, v46
    v_and_b32 v6, 0xffff0000, v46
    v_add_f32 v76, v76, v5
    v_add_f32 v77, v77, v6
    v_lshlrev_b32 v5, 16, v47
    v_and_b32 v6, 0xffff0000, v47
    v_add_f32 v78, v78, v5
    v_add_f32 v79, v79, v6
    s_waitcnt vmcnt(5)
    v_lshlrev_b32 v5, 16, v48
    v_and_b32 v6, 0xffff0000, v48
    v_add_f32 v72, v72, v5
    v_add_f32 v73, v73, v6
    v_lshlrev_b32 v5, 16, v49
    v_and_b32 v6, 0xffff0000, v49
    v_add_f32 v74, v74, v5
    v_add_f32 v75, v75, v6
    v_lshlrev_b32 v5, 16, v50
    v_and_b32 v6, 0xffff0000, v50
    v_add_f32 v76, v76, v5
    v_add_f32 v77, v77, v6
    v_lshlrev_b32 v5, 16, v51
    v_and_b32 v6, 0xffff0000, v51
    v_add_f32 v78, v78, v5
    v_add_f32 v79, v79, v6
    s_waitcnt vmcnt(4)
    v_lshlrev_b32 v5, 16, v52
    v_and_b32 v6, 0xffff0000, v52
    v_add_f32 v72, v72, v5
    v_add_f32 v73, v73, v6
    v_lshlrev_b32 v5, 16, v53
    v_and_b32 v6, 0xffff0000, v53
    v_add_f32 v74, v74, v5
    v_add_f32 v75, v75, v6
    v_lshlrev_b32 v5, 16, v54
    v_and_b32 v6, 0xffff0000, v54
    v_add_f32 v76, v76, v5
    v_add_f32 v77, v77, v6
    v_lshlrev_b32 v5, 16, v55
    v_and_b32 v6, 0xffff0000, v55
    v_add_f32 v78, v78, v5
    v_add_f32 v79, v79, v6
    s_waitcnt vmcnt(3)
    v_lshlrev_b32 v5, 16, v56
    v_and_b32 v6, 0xffff0000, v56
    v_add_f32 v72, v72, v5
    v_add_f32 v73, v73, v6
    v_lshlrev_b32 v5, 16, v57
    v_and_b32 v6, 0xffff0000, v57
    v_add_f32 v74, v74, v5
    v_add_f32 v75, v75, v6
    v_lshlrev_b32 v5, 16, v58
    v_and_b32 v6, 0xffff0000, v58
    v_add_f32 v76, v76, v5
    v_add_f32 v77, v77, v6
    v_lshlrev_b32 v5, 16, v59
    v_and_b32 v6, 0xffff0000, v59
    v_add_f32 v78, v78, v5
    v_add_f32 v79, v79, v6
    s_waitcnt vmcnt(2)
    v_lshlrev_b32 v5, 16, v60
    v_and_b32 v6, 0xffff0000, v60
    v_add_f32 v72, v72, v5
    v_add_f32 v73, v73, v6
    v_lshlrev_b32 v5, 16, v61
    v_and_b32 v6, 0xffff0000, v61
    v_add_f32 v74, v74, v5
    v_add_f32 v75, v75, v6
    v_lshlrev_b32 v5, 16, v62
    v_and_b32 v6, 0xffff0000, v62
    v_add_f32 v76, v76, v5
    v_add_f32 v77, v77, v6
    v_lshlrev_b32 v5, 16, v63
    v_and_b32 v6, 0xffff0000, v63
    v_add_f32 v78, v78, v5
    v_add_f32 v79, v79, v6
    s_waitcnt vmcnt(1)
    v_lshlrev_b32 v5, 16, v64
    v_and_b32 v6, 0xffff0000, v64
    v_add_f32 v72, v72, v5
    v_add_f32 v73, v73, v6
    v_lshlrev_b32 v5, 16, v65
    v_and_b32 v6, 0xffff0000, v65
    v_add_f32 v74, v74, v5
    v_add_f32 v75, v75, v6
    v_lshlrev_b32 v5, 16, v66
    v_and_b32 v6, 0xffff0000, v66
    v_add_f32 v76, v76, v5
    v_add_f32 v77, v77, v6
    v_lshlrev_b32 v5, 16, v67
    v_and_b32 v6, 0xffff0000, v67
    v_add_f32 v78, v78, v5
    v_add_f32 v79, v79, v6
    s_waitcnt vmcnt(0)
    v_lshlrev_b32 v5, 16, v68
    v_and_b32 v6, 0xffff0000, v68
    v_add_f32 v72, v72, v5
    v_add_f32 v73, v73, v6
    v_lshlrev_b32 v5, 16, v69
    v_and_b32 v6, 0xffff0000, v69
    v_add_f32 v74, v74, v5
    v_add_f32 v75, v75, v6
    v_lshlrev_b32 v5, 16, v70
    v_and_b32 v6, 0xffff0000, v70
    v_add_f32 v76, v76, v5
    v_add_f32 v77, v77, v6
    v_lshlrev_b32 v5, 16, v71
    v_and_b32 v6, 0xffff0000, v71
    v_add_f32 v78, v78, v5
    v_add_f32 v79, v79, v6
    v_cvt_pk_bf16_f32 v80, v72, v73
    v_cvt_pk_bf16_f32 v81, v74, v75
    v_cvt_pk_bf16_f32 v82, v76, v77
    v_cvt_pk_bf16_f32 v83, v78, v79
    buffer_store_dwordx4 v[80:83], v3, s[44:47], s22 offen
L_rexit:
    s_endpgm
.section .rodata,"a"
.p2align 6
.amdhsa_kernel standalone__gqa_block_cached__near_ridge_kernel
  .amdhsa_next_free_vgpr 256
  .amdhsa_next_free_sgpr 100
  .amdhsa_accum_offset 256
  .amdhsa_group_segment_fixed_size 0
  .amdhsa_kernarg_size 64
  .amdhsa_user_sgpr_count 2
  .amdhsa_user_sgpr_kernarg_segment_ptr 1
  .amdhsa_system_sgpr_workgroup_id_x 1
  .amdhsa_float_denorm_mode_32 3
.end_amdhsa_kernel
.p2align 6
.amdhsa_kernel gqa_reduce_kernel
  .amdhsa_next_free_vgpr 88
  .amdhsa_next_free_sgpr 100
  .amdhsa_accum_offset 88
  .amdhsa_group_segment_fixed_size 0
  .amdhsa_kernarg_size 64
  .amdhsa_user_sgpr_count 2
  .amdhsa_user_sgpr_kernarg_segment_ptr 1
  .amdhsa_system_sgpr_workgroup_id_x 1
  .amdhsa_float_denorm_mode_32 3
.end_amdhsa_kernel
```
